```python
import torch

def _softmax(x, axis=-1):
    return torch.softmax(x, dim=axis)
def _gelu(x):
    return torch.nn.functional.gelu(x, approximate="tanh")
def _silu(x):
    return torch.nn.functional.silu(x)
def _sigmoid(x):
    return torch.sigmoid(x)
def _layernorm(x, axis=-1, eps=1e-5):
    m = x.mean(dim=axis, keepdim=True)
    v = x.var(dim=axis, keepdim=True, unbiased=False)
    return (x - m) / torch.sqrt(v + eps)
def _scatter_add(tgt, idx, src, axis=0):
    return tgt.clone().index_add_(axis, idx, src)
def _segment_sum(src, seg, n):
    out = torch.zeros((n,) + src.shape[1:], dtype=src.dtype)
    return out.index_add_(0, seg, src)
def _pad(x, pw):
    flat = tuple(v for pair in reversed(pw) for v in pair)
    return torch.nn.functional.pad(x, flat)

kernel_name = 'recurrent_scan__sliding_local_dilated__geglu_ffn__prompt'

def setup_inputs():

    _w = (lambda a: (lambda t: t.to(torch.bfloat16) if t.is_floating_point() else t)(torch.as_tensor(a)))
    def _A_setup():
        B, S, D = 1, 2048, 576
        return {
            "x": _w((lambda *s: torch.randn(*s, dtype=torch.bfloat16) * 0.05)(B, S, D)),
            "wqkv": _w((lambda *s: torch.randn(*s, dtype=torch.bfloat16) * 0.05)(D, 3 * D)),
            "wo": _w((lambda *s: torch.randn(*s, dtype=torch.bfloat16) * 0.05)(D, D)),
        }
    _A_in = _A_setup()

    def _B_setup():
        B, S, D, F = 1, 2048, 576, 4608
        return {
            "x": _w((lambda *s: torch.randn(*s, dtype=torch.bfloat16) * 0.05)(B, S, D)),
            "w_gate": _w((lambda *s: torch.randn(*s, dtype=torch.bfloat16) * 0.05)(D, F)),
            "w_up": _w((lambda *s: torch.randn(*s, dtype=torch.bfloat16) * 0.05)(D, F)),
            "w_down": _w((lambda *s: torch.randn(*s, dtype=torch.bfloat16) * 0.05)(F, D)),
        }
    _B_in = _B_setup()

    return {
        "A_x": _A_in["x"],
        "A_wqkv": _A_in["wqkv"],
        "A_wo": _A_in["wo"],
        "B_x": _B_in["x"],
        "B_w_gate": _B_in["w_gate"],
        "B_w_up": _B_in["w_up"],
        "B_w_down": _B_in["w_down"],
    }

def reference(A_x, A_wqkv, A_wo, B_x, B_w_gate, B_w_up, B_w_down):
    def _A_ref(x, wqkv, wo):
        B, S, D = x.shape
        H = 32; Dh = D // H
        W, dil = 8, 2
        qkv = (lambda x, *d: x.permute(*d))((x @ wqkv).reshape(B, S, 3, H, Dh), 2, 0, 3, 1, 4)
        q, k, v = qkv[0], qkv[1], qkv[2]
        scale = Dh ** -0.5
        pos = torch.arange(S)
        off = torch.arange(W) * dil
        idx = pos[:, None] - off[None, :]
        mask = idx >= 0
        idx_c = torch.where(mask, idx, 0).reshape(-1)
        kg = k[:, :, idx_c, :].reshape(B, H, S, W, Dh)
        vg = v[:, :, idx_c, :].reshape(B, H, S, W, Dh)
        logits = torch.einsum("bhsd,bhswd->bhsw", q, kg) * scale
        logits = torch.where(mask[None, None, :, :], logits, -1e9)
        attn = _softmax(logits, axis=-1)
        o = torch.einsum("bhsw,bhswd->bhsd", attn, vg)
        return (lambda x, *d: x.permute(*d))(o, 0, 2, 1, 3).reshape(B, S, D) @ wo

    def _B_ref(x, w_gate, w_up, w_down):
        return (_gelu(x @ w_gate) * (x @ w_up)) @ w_down

    x = A_x
    xn = _layernorm(x, axis=-1)
    s = _A_ref(xn, A_wqkv, A_wo)
    g = _silu(_B_ref(xn, B_w_gate, B_w_up, B_w_down))
    return x + s * g
```

```asm
; @launch grid=(256,1,1) block=(256,1,1) lds=163840
.amdgcn_target "amdgcn-amd-amdhsa--gfx950"
.text
.globl recurrent_scan__sliding_local_dilated__geglu_ffn__prompt_kernel
.p2align 8
.type recurrent_scan__sliding_local_dilated__geglu_ffn__prompt_kernel,@function
recurrent_scan__sliding_local_dilated__geglu_ffn__prompt_kernel:
    s_cmp_ge_u32 s2, 256
    s_cbranch_scc1 L_k1_done
    s_load_dwordx2 s[4:5], s[0:1], 8
    s_load_dwordx4 s[8:11], s[0:1], 32
    s_load_dwordx2 s[6:7], s[0:1], 72
    s_load_dwordx2 s[64:65], s[0:1], 48
    s_load_dwordx2 s[66:67], s[0:1], 16
    s_load_dwordx2 s[60:61], s[0:1], 0
    s_load_dwordx2 s[78:79], s[0:1], 64
    s_memrealtime s[24:25]
    v_lshrrev_b32 v16, 6, v0
    s_nop 0
    v_readfirstlane_b32 s28, v16
    v_and_b32 v0, 63, v0
    v_lshlrev_b32 v9, 4, v0
    s_getpc_b64 s[56:57]
L_pc_recurrent_scan__sliding_local_dilated__geglu_ffn__prompt_kernel:
    s_sub_u32 s56, s56, L_pc_recurrent_scan__sliding_local_dilated__geglu_ffn__prompt_kernel-recurrent_scan__sliding_local_dilated__geglu_ffn__prompt_kernel
    s_subb_u32 s57, s57, 0
    s_and_b32 s57, s57, 0xffff
    s_mov_b32 s58, L_k1_done-recurrent_scan__sliding_local_dilated__geglu_ffn__prompt_kernel
    s_mov_b32 s59, 0x00020000
    s_lshr_b32 s45, s2, 3
    s_lshl_b32 s45, s45, 2
    s_add_u32 s45, s45, s28
    s_lshl_b32 s45, s45, 10
    buffer_load_dwordx4 v[240:243], v9, s[56:59], s45 offen
    s_and_b32 s34, s2, 1
    s_lshl_b32 s34, s34, 2
    s_bfe_u32 s35, s2, 0x20001
    s_add_u32 s34, s34, s35
    s_and_b32 s2, s2, 0xf8
    s_add_u32 s2, s2, s34
    s_lshr_b32 s35, s2, 3
    s_lshr_b32 s3, s35, 2
    s_and_b32 s35, s35, 3
    s_lshl_b32 s34, s34, 2
    s_add_u32 s34, s34, s35
    s_mov_b32 s101, s34
    s_cmp_lt_u32 s34, 16
    s_cbranch_scc0 L_k1_c1
    s_mov_b32 s30, 5
    s_mov_b32 s29, 1
    s_mul_i32 s32, s34, 5
    s_mov_b32 s31, s34
    s_branch L_k1_cdone
L_k1_c1:
    s_mov_b32 s30, 4
    s_sub_u32 s35, s34, 16
    s_lshl_b32 s32, s35, 2
    s_add_u32 s32, s32, 80
    s_cmp_lt_u32 s34, 22
    s_cbranch_scc0 L_k1_c2
    s_mov_b32 s29, 3
    s_mul_i32 s31, s35, 3
    s_add_u32 s31, s31, 16
    s_branch L_k1_cdone
L_k1_c2:
    s_mov_b32 s29, 2
    s_sub_u32 s35, s34, 22
    s_lshl_b32 s31, s35, 1
    s_add_u32 s31, s31, 34
L_k1_cdone:
    s_and_b32 s34, s32, 1
    s_add_u32 s33, s32, s34
    s_lshl_b32 s44, s33, 6
    s_lshl_b32 s35, s3, 2
    s_add_u32 s35, s35, s28
    s_mul_i32 s43, s35, 73728
    s_lshl_b32 s38, s28, 10
    v_lshrrev_b32 v16, 3, v0
    v_bfe_u32 v17, v0, 1, 2
    v_and_b32 v18, 3, v16
    v_xor_b32 v17, v17, v18
    v_lshlrev_b32 v17, 5, v17
    v_xor_b32 v18, s28, v0
    v_and_b32 v18, 1, v18
    v_lshl_add_u32 v17, v18, 4, v17
    s_lshl_b32 s34, s28, 3
    v_add_u32 v16, s34, v16
    s_movk_i32 s34, 9216
    v_mad_u32_u24 v254, v16, s34, v17
    s_lshl_b32 s56, s3, 8
    s_lshl_b32 s57, s101, 3
    s_add_u32 s56, s56, s57
    s_lshl_b32 s57, s28, 1
    s_add_u32 s56, s56, s57
    v_lshrrev_b32 v67, 5, v0
    v_add_u32 v67, s56, v67
    v_and_b32 v66, 31, v0
    s_bfe_u32 s57, s56, 0x10003
    s_and_b32 s58, s56, -16
    s_add_u32 s57, s57, s58
    v_and_b32 v68, 7, v67
    v_lshl_add_u32 v68, v68, 1, s57
    v_mul_u32_u24 v68, 1152, v68
    v_lshl_add_u32 v68, v66, 4, v68
    v_cmp_gt_u32 s[26:27], 8, v66
    v_mov_b32 v88, 0
    v_mov_b32 v89, 0
    v_mov_b32 v90, 0
    v_mov_b32 v91, 0
    v_mov_b32 v124, 0
    v_lshlrev_b32 v125, 3, v0
    s_waitcnt lgkmcnt(0)
    s_mov_b32 s60, s60
    s_mov_b32 s61, s61
    s_and_b32 s61, s61, 0xffff
    s_mov_b32 s62, 0x00240000
    s_mov_b32 s63, 0x00020000
    buffer_load_dwordx4 v[80:83], v68, s[60:63], 0 offen
    buffer_load_dwordx4 v[84:87], v68, s[60:63], 0 offen offset:512
    s_mov_b64 exec, s[26:27]
    buffer_load_dwordx4 v[88:91], v68, s[60:63], 0 offen offset:1024
    s_mov_b64 exec, -1
    s_mov_b32 s16, s78
    s_mov_b32 s17, s79
    s_and_b32 s17, s17, 0xffff
    s_mov_b32 s18, 0x00000100
    s_mov_b32 s19, 0x00020000
    s_add_u32 s56, s2, s28
    s_cmp_lg_u32 s56, 0
    s_cbranch_scc1 L_k1_notok
    s_or_b32 s24, s24, 1
    v_mov_b32 v126, s24
    v_mov_b32 v127, s25
    s_mov_b64 exec, 0xffff
    buffer_store_dwordx2 v[126:127], v125, s[16:19], 0 offen sc0 sc1
    s_mov_b64 exec, -1
L_k1_notok:
    s_add_u32 s52, s44, 128
    s_add_u32 s56, s8, s52
    s_bfe_u32 s56, s56, 0x30007
    s_cmp_eq_u32 s56, 3
    s_cselect_b32 s56, s44, s52
    s_cselect_b32 s44, s52, s44
    s_mov_b32 s52, s56
    s_mov_b32 s12, s6
    s_mov_b32 s13, s7
    s_and_b32 s13, s13, 0xffff
    s_mov_b32 s14, 0x00240000
    s_mov_b32 s15, 0x00020000
    s_mov_b32 s84, s8
    s_mov_b32 s85, s9
    s_and_b32 s85, s85, 0xffff
    s_mov_b32 s86, 0x00510000
    s_mov_b32 s87, 0x00020000
    s_mov_b32 s88, s10
    s_mov_b32 s89, s11
    s_and_b32 s89, s89, 0xffff
    s_mov_b32 s90, 0x00510000
    s_mov_b32 s91, 0x00020000
    s_mul_i32 s77, s3, 9
    s_lshr_b32 s77, s77, 2
    s_mul_i32 s78, s77, 294912
    s_add_u32 s78, s78, s44
    s_lshl_b32 s79, s77, 12
    s_add_u32 s79, s79, s38
    s_cmp_ge_u32 s77, 9
    s_cselect_b32 s35, 36864, 0
    s_add_u32 s79, s79, s35
    s_mov_b32 m0, s79
    s_add_u32 s77, s77, 1
    buffer_load_dwordx4 v254, s[84:87], s78 offen lds
    s_add_u32 m0, s79, 36864
    s_cmp_eq_u32 s77, 9
    buffer_load_dwordx4 v254, s[88:91], s78 offen lds
    s_cselect_b32 s35, 36864, 0
    s_add_u32 s79, s79, s35
    s_add_u32 s79, s79, 4096
    s_add_u32 s78, s78, 294912
    s_cmp_eq_u32 s77, 18
    s_cselect_b32 s77, 0, s77
    s_cselect_b32 s78, s44, s78
    s_cselect_b32 s79, s38, s79
    s_mov_b32 m0, s79
    s_add_u32 s77, s77, 1
    buffer_load_dwordx4 v254, s[84:87], s78 offen lds
    s_add_u32 m0, s79, 36864
    s_cmp_eq_u32 s77, 9
    buffer_load_dwordx4 v254, s[88:91], s78 offen lds
    s_cselect_b32 s35, 36864, 0
    s_add_u32 s79, s79, s35
    s_add_u32 s79, s79, 4096
    s_add_u32 s78, s78, 294912
    s_cmp_eq_u32 s77, 18
    s_cselect_b32 s77, 0, s77
    s_cselect_b32 s78, s44, s78
    s_cselect_b32 s79, s38, s79
    s_mov_b32 m0, s79
    s_add_u32 s77, s77, 1
    buffer_load_dwordx4 v254, s[84:87], s78 offen lds
    s_add_u32 m0, s79, 36864
    s_cmp_eq_u32 s77, 9
    buffer_load_dwordx4 v254, s[88:91], s78 offen lds
    s_cselect_b32 s35, 36864, 0
    s_add_u32 s79, s79, s35
    s_add_u32 s79, s79, 4096
    s_add_u32 s78, s78, 294912
    s_cmp_eq_u32 s77, 18
    s_cselect_b32 s77, 0, s77
    s_cselect_b32 s78, s44, s78
    s_cselect_b32 s79, s38, s79
    s_lshl_b32 s35, s3, 2
    s_add_u32 s35, s35, s28
    s_mul_i32 s39, s35, 162
    s_mul_i32 s41, s35, 512
    s_add_u32 s34, s32, 4
    s_cmp_eq_u32 s33, s32
    s_cselect_b32 s34, s34, s32
    s_lshr_b32 s33, s101, 2
    s_mul_i32 s33, s33, 36
    s_add_u32 s40, s39, s33
    s_and_b32 s33, s101, 3
    s_add_u32 s40, s40, s33
    s_add_u32 s40, s40, 32
    s_lshl_b32 s40, s40, 12
    s_lshr_b32 s33, s101, 3
    s_mul_i32 s33, s33, 36
    s_add_u32 s39, s39, s33
    s_and_b32 s33, s101, 7
    s_add_u32 s39, s39, s33
    s_lshl_b32 s39, s39, 12
    s_mov_b32 s33, 32768
    s_lshl_b32 s32, s34, 6
    s_lshl_b32 s31, s31, 6
    s_lshl_b32 s42, s31, 11
    s_add_u32 s41, s41, s42
    s_add_u32 s42, s41, 65536
    s_mov_b32 s36, 221184
    s_mov_b32 s37, 589824
    s_add_u32 s46, s52, 64
    s_mov_b32 s47, s46
    s_mov_b32 s50, s37
    s_mov_b32 s53, 0
    s_mov_b32 s80, s4
    s_mov_b32 s81, s5
    s_and_b32 s81, s81, 0xffff
    s_mov_b32 s82, 0x001e6000
    s_mov_b32 s83, 0x00020000
    s_add_u32 s20, s6, 0x00900000
    s_addc_u32 s21, s7, 0
    s_and_b32 s21, s21, 0xffff
    s_mov_b32 s22, 0x01440000
    s_mov_b32 s23, 0x00020000
    s_mov_b32 s68, s64
    s_mov_b32 s69, s65
    s_and_b32 s69, s69, 0xffff
    s_mov_b32 s70, 0x00510000
    s_mov_b32 s71, 0x00020000
    s_mov_b32 s72, s66
    s_mov_b32 s73, s67
    s_and_b32 s73, s73, 0xffff
    s_mov_b32 s74, 0x000a2000
    s_mov_b32 s75, 0x00020000
    s_and_b32 s56, s2, 1
    s_lshl_b32 s56, s56, 5
    s_lshr_b32 s57, s2, 3
    s_add_u32 s56, s56, s57
    s_lshl_b32 s56, s56, 2
    s_add_u32 s56, s56, s28
    s_mul_hi_u32 s57, s56, 715827883
    s_bfe_u32 s58, s2, 0x20001
    s_lshl_b32 s59, s58, 3
    s_and_b32 s34, s57, 7
    s_add_u32 s59, s59, s34
    s_mul_i32 s34, s59, 5
    s_lshl_b32 s35, s59, 2
    s_add_u32 s35, s35, 16
    s_cmp_lt_u32 s59, 16
    s_cselect_b32 s59, s34, s35
    s_and_b32 s34, s59, 1
    s_add_u32 s59, s59, s34
    s_lshl_b32 s34, s59, 6
    s_add_u32 s34, s34, s84
    s_add_u32 s34, s34, 128
    s_bfe_u32 s34, s34, 0x30007
    s_cmp_eq_u32 s34, 3
    s_cselect_b32 s34, 2, 0
    s_lshr_b32 s35, s57, 3
    s_xor_b32 s34, s34, s35
    s_add_u32 s59, s59, s34
    s_lshl_b32 s34, s58, 2
    s_add_u32 s34, s34, s57
    s_sub_u32 s34, s34, 32
    s_mul_i32 s34, s34, 5
    s_bitcmp1_b32 s34, 0
    s_cselect_b32 s35, 0, 4
    s_add_u32 s34, s34, s35
    s_cmp_lt_u32 s57, 32
    s_cselect_b32 s59, s59, s34
    s_sub_u32 s59, s59, s57
    s_mul_i32 s59, s59, 6
    s_add_u32 s76, s56, s59
    s_mul_i32 s58, s58, 27
    s_add_u32 s58, s58, s56
    s_add_u32 s58, s58, 648
    s_cmp_lt_u32 s56, 216
    s_cselect_b32 s76, s76, s58
    s_cmp_lt_u32 s56, 243
    s_cselect_b32 s76, s76, 1000
    s_cmp_lt_u32 s76, 864
    s_cselect_b32 s68, s68, s72
    s_cselect_b32 s69, s69, s73
    s_cselect_b32 s70, s70, s74
    s_cselect_b32 s34, 0, 864
    v_lshrrev_b32 v16, 2, v0
    s_lshl_b32 s35, s28, 4
    v_add_u32 v16, s35, v16
    v_and_b32 v17, 3, v0
    v_lshrrev_b32 v18, 5, v0
    v_xor_b32 v17, v17, v18
    v_lshlrev_b32 v17, 4, v17
    s_movk_i32 s35, 3456
    v_mad_u32_u24 v5, v16, s35, v17
    s_movk_i32 s35, 9216
    v_mad_u32_u24 v6, v16, s35, v17
    v_mov_b32 v252, v6
    s_add_u32 s35, s31, 64
    s_add_u32 s54, s31, 128
    s_cmp_eq_u32 s30, 5
    s_cselect_b32 s60, s84, s80
    s_cselect_b32 s72, s88, s80
    s_cselect_b32 s61, s85, s81
    s_cselect_b32 s73, s89, s81
    s_cselect_b32 s62, s86, s82
    s_cselect_b32 s74, s90, s82
    s_mov_b32 s63, 0x00020000
    s_mov_b32 s75, 0x00020000
    s_cselect_b32 s48, s32, s31
    s_cselect_b32 s49, s32, s35
    s_cselect_b32 s51, s37, s36
    s_cselect_b32 s54, s31, s54
    s_cselect_b64 vcc, -1, 0
    s_cmp_eq_u32 s29, 2
    s_cselect_b32 s55, 0, 1990656
    v_cndmask_b32 v253, v5, v6, vcc
    v_lshrrev_b32 v16, 5, v0
    v_lshlrev_b32 v1, 9, v16
    v_bfe_u32 v17, v0, 2, 2
    v_lshl_add_u32 v1, v17, 6, v1
    v_bfe_u32 v18, v0, 4, 1
    v_lshl_add_u32 v1, v18, 5, v1
    v_and_b32 v19, 3, v0
    v_lshl_add_u32 v1, v19, 3, v1
    v_add_u32 v2, 36864, v1
    v_add_u32 v3, 73728, v1
    v_add_u32 v4, 110592, v1
    v_lshlrev_b32 v20, 10, v16
    v_lshl_add_u32 v20, v17, 7, v20
    v_lshl_add_u32 v20, v19, 3, v20
    v_add_u32 v21, 0, v18
    v_xor_b32 v21, v21, v17
    v_lshl_add_u32 v12, v21, 5, v20
    v_add_u32 v13, 36864, v12
    v_add_u32 v21, 2, v18
    v_xor_b32 v21, v21, v17
    v_lshl_add_u32 v14, v21, 5, v20
    v_add_u32 v15, 36864, v14
    v_lshlrev_b32 v7, 10, v18
    v_lshl_add_u32 v7, v16, 8, v7
    v_and_b32 v16, 15, v0
    v_lshl_add_u32 v7, v16, 4, v7
    v_lshrrev_b32 v16, 2, v0
    v_mul_u32_u24 v8, 3456, v16
    v_and_b32 v17, 3, v0
    v_lshl_add_u32 v8, v17, 4, v8
    v_add_u32 v244, 55296, v8
    v_mov_b32 v8, v9
    v_add_u32 v244, 1024, v9
    v_lshrrev_b32 v18, 5, v0
    v_and_b32 v19, 31, v0
    v_lshlrev_b32 v19, 4, v19
    v_lshl_add_u32 v8, v18, 15, v19
    v_and_b32 v19, 7, v0
    v_lshlrev_b32 v19, 4, v19
    v_lshl_add_u32 v19, v18, 15, v19
    v_bfe_u32 v18, v0, 3, 1
    v_lshl_add_u32 v19, v18, 14, v19
    v_bfe_u32 v18, v0, 4, 1
    v_lshl_add_u32 v8, v18, 7, v19
    v_lshrrev_b32 v18, 4, v0
    v_and_b32 v19, 7, v0
    v_lshlrev_b32 v19, 4, v19
    v_lshl_add_u32 v19, v18, 15, v19
    v_bfe_u32 v20, v0, 3, 1
    v_lshl_add_u32 v8, v20, 14, v19
    v_mov_b32 v7, v9
    v_and_b32 v19, 1, v0
    v_lshlrev_b32 v19, 3, v19
    v_and_b32 v20, 1, v18
    v_lshl_add_u32 v19, v20, 4, v19
    v_bfe_u32 v20, v0, 1, 1
    v_bfe_u32 v21, v0, 2, 2
    v_lshl_add_u32 v1, v20, 5, v19
    v_lshl_add_u32 v1, v21, 6, v1
    v_lshl_add_u32 v1, v18, 9, v1
    v_add_u32 v2, 36864, v1
    v_add_u32 v3, 73728, v1
    v_add_u32 v4, 110592, v1
    v_xor_b32 v32, 16, v1
    v_xor_b32 v33, 16, v2
    v_xor_b32 v34, 16, v3
    v_xor_b32 v35, 16, v4
    v_lshl_add_u32 v19, v21, 7, v19
    v_lshl_add_u32 v19, v18, 10, v19
    v_add_u32 v18, 0, v20
    v_xor_b32 v18, v18, v21
    v_lshl_add_u32 v12, v18, 5, v19
    v_add_u32 v13, 36864, v12
    v_xor_b32 v36, 16, v12
    v_xor_b32 v37, 16, v13
    v_add_u32 v18, 2, v20
    v_xor_b32 v18, v18, v21
    v_lshl_add_u32 v14, v18, 5, v19
    v_add_u32 v15, 36864, v14
    v_xor_b32 v38, 16, v14
    v_xor_b32 v39, 16, v15
    s_lshl_b32 s34, s28, 12
    s_add_u32 s34, s34, 147456
    v_bfe_u32 v18, v16, 2, 2
    v_xor_b32 v17, v17, v18
    v_lshlrev_b32 v17, 4, v17
    v_lshl_add_u32 v245, v16, 6, v17
    v_add_u32 v245, s34, v245
    v_and_b32 v16, 31, v0
    v_bfe_u32 v18, v16, 2, 2
    v_lshrrev_b32 v17, 5, v0
    v_lshlrev_b32 v17, 3, v17
    v_lshl_add_u32 v17, v16, 6, v17
    v_add_u32 v17, s34, v17
    v_xor_b32 v19, 0, v18
    v_lshl_add_u32 v246, v19, 4, v17
    v_xor_b32 v19, 1, v18
    v_lshl_add_u32 v247, v19, 4, v17
    v_xor_b32 v19, 2, v18
    v_lshl_add_u32 v248, v19, 4, v17
    v_xor_b32 v19, 3, v18
    v_lshl_add_u32 v249, v19, 4, v17
    v_mov_b32 v248, 159744
    v_mov_b32 v10, 0xc0135761
    v_mov_b32 v11, 0xbdd2d3e8
    s_add_u32 s64, s6, 0x01f10000
    s_addc_u32 s65, s7, 0
    s_and_b32 s65, s65, 0xffff
    s_mov_b32 s66, 0x000c0000
    s_mov_b32 s67, 0x00020000
    v_and_b32 v70, 7, v67
    v_lshlrev_b32 v69, 7, v66
    v_lshl_add_u32 v69, v70, 4, v69
    v_add_u32 v69, 147456, v69
    s_add_u32 s56, s38, 147456
    v_add_u32 v70, s56, v9
    v_bfe_u32 v71, v0, 3, 2
    v_lshlrev_b32 v71, 8, v71
    v_lshrrev_b32 v79, 5, v0
    v_lshl_add_u32 v71, v79, 11, v71
    v_and_b32 v79, 7, v0
    v_lshl_add_u32 v71, v79, 4, v71
    s_lshr_b32 s56, s101, 2
    s_lshl_b32 s57, s3, 3
    s_add_u32 s56, s56, s57
    s_mul_i32 s56, s56, 36864
    s_and_b32 s57, s101, 1
    s_lshl_b32 s57, s57, 7
    s_add_u32 s56, s56, s57
    s_and_b32 s57, s101, 2
    s_lshl_b32 s57, s57, 9
    s_add_u32 s56, s56, s57
    s_lshl_b32 s57, s28, 12
    s_add_u32 s56, s56, s57
    v_add_u32 v71, s56, v71
    v_mov_b32 v72, 0
    v_mov_b32 v73, 0
    s_waitcnt vmcnt(6)
    buffer_load_dwordx2 v[126:127], v124, s[16:19], 0 offen sc1
    v_lshlrev_b32 v96, 16, v80
    v_and_b32 v97, 0xffff0000, v80
    v_add_f32 v72, v72, v96
    v_add_f32 v73, v73, v97
    v_lshlrev_b32 v98, 16, v81
    v_and_b32 v99, 0xffff0000, v81
    v_add_f32 v72, v72, v98
    v_add_f32 v73, v73, v99
    v_lshlrev_b32 v100, 16, v82
    v_and_b32 v101, 0xffff0000, v82
    v_add_f32 v72, v72, v100
    v_add_f32 v73, v73, v101
    v_lshlrev_b32 v102, 16, v83
    v_and_b32 v103, 0xffff0000, v83
    v_add_f32 v72, v72, v102
    v_add_f32 v73, v73, v103
    v_lshlrev_b32 v104, 16, v84
    v_and_b32 v105, 0xffff0000, v84
    v_add_f32 v72, v72, v104
    v_add_f32 v73, v73, v105
    v_lshlrev_b32 v106, 16, v85
    v_and_b32 v107, 0xffff0000, v85
    v_add_f32 v72, v72, v106
    v_add_f32 v73, v73, v107
    v_lshlrev_b32 v108, 16, v86
    v_and_b32 v109, 0xffff0000, v86
    v_add_f32 v72, v72, v108
    v_add_f32 v73, v73, v109
    v_lshlrev_b32 v110, 16, v87
    v_and_b32 v111, 0xffff0000, v87
    v_add_f32 v72, v72, v110
    v_add_f32 v73, v73, v111
    v_lshlrev_b32 v112, 16, v88
    v_and_b32 v113, 0xffff0000, v88
    v_add_f32 v72, v72, v112
    v_add_f32 v73, v73, v113
    v_lshlrev_b32 v114, 16, v89
    v_and_b32 v115, 0xffff0000, v89
    v_add_f32 v72, v72, v114
    v_add_f32 v73, v73, v115
    v_lshlrev_b32 v116, 16, v90
    v_and_b32 v117, 0xffff0000, v90
    v_add_f32 v72, v72, v116
    v_add_f32 v73, v73, v117
    v_lshlrev_b32 v118, 16, v91
    v_and_b32 v119, 0xffff0000, v91
    v_add_f32 v72, v72, v118
    v_add_f32 v73, v73, v119
    v_add_f32 v72, v72, v73
    s_nop 1
    v_add_f32_dpp v72, v72, v72 quad_perm:[1,0,3,2] row_mask:0xf bank_mask:0xf
    s_nop 1
    v_add_f32_dpp v72, v72, v72 quad_perm:[2,3,0,1] row_mask:0xf bank_mask:0xf
    s_nop 1
    v_add_f32_dpp v72, v72, v72 row_half_mirror row_mask:0xf bank_mask:0xf
    s_nop 1
    v_add_f32_dpp v72, v72, v72 row_mirror row_mask:0xf bank_mask:0xf
    s_nop 0
    ds_swizzle_b32 v78, v72 offset:0x401F
    s_waitcnt lgkmcnt(0)
    v_add_f32 v72, v72, v78
    v_mul_f32 v72, 0x3ae38e39, v72
    v_mov_b32 v74, 0
    v_mov_b32 v75, 0
    v_sub_f32 v76, v96, v72
    v_sub_f32 v77, v97, v72
    v_fmac_f32 v74, v76, v76
    v_fmac_f32 v75, v77, v77
    v_sub_f32 v76, v98, v72
    v_sub_f32 v77, v99, v72
    v_fmac_f32 v74, v76, v76
    v_fmac_f32 v75, v77, v77
    v_sub_f32 v76, v100, v72
    v_sub_f32 v77, v101, v72
    v_fmac_f32 v74, v76, v76
    v_fmac_f32 v75, v77, v77
    v_sub_f32 v76, v102, v72
    v_sub_f32 v77, v103, v72
    v_fmac_f32 v74, v76, v76
    v_fmac_f32 v75, v77, v77
    v_sub_f32 v76, v104, v72
    v_sub_f32 v77, v105, v72
    v_fmac_f32 v74, v76, v76
    v_fmac_f32 v75, v77, v77
    v_sub_f32 v76, v106, v72
    v_sub_f32 v77, v107, v72
    v_fmac_f32 v74, v76, v76
    v_fmac_f32 v75, v77, v77
    v_sub_f32 v76, v108, v72
    v_sub_f32 v77, v109, v72
    v_fmac_f32 v74, v76, v76
    v_fmac_f32 v75, v77, v77
    v_sub_f32 v76, v110, v72
    v_sub_f32 v77, v111, v72
    v_fmac_f32 v74, v76, v76
    v_fmac_f32 v75, v77, v77
    v_sub_f32 v76, v112, v72
    v_sub_f32 v77, v113, v72
    s_mov_b64 exec, s[26:27]
    v_fmac_f32 v74, v76, v76
    v_fmac_f32 v75, v77, v77
    v_sub_f32 v76, v114, v72
    v_sub_f32 v77, v115, v72
    v_fmac_f32 v74, v76, v76
    v_fmac_f32 v75, v77, v77
    v_sub_f32 v76, v116, v72
    v_sub_f32 v77, v117, v72
    v_fmac_f32 v74, v76, v76
    v_fmac_f32 v75, v77, v77
    v_sub_f32 v76, v118, v72
    v_sub_f32 v77, v119, v72
    v_fmac_f32 v74, v76, v76
    v_fmac_f32 v75, v77, v77
    s_mov_b64 exec, -1
    v_add_f32 v74, v74, v75
    s_nop 1
    v_add_f32_dpp v74, v74, v74 quad_perm:[1,0,3,2] row_mask:0xf bank_mask:0xf
    s_nop 1
    v_add_f32_dpp v74, v74, v74 quad_perm:[2,3,0,1] row_mask:0xf bank_mask:0xf
    s_nop 1
    v_add_f32_dpp v74, v74, v74 row_half_mirror row_mask:0xf bank_mask:0xf
    s_nop 1
    v_add_f32_dpp v74, v74, v74 row_mirror row_mask:0xf bank_mask:0xf
    s_nop 0
    ds_swizzle_b32 v78, v74 offset:0x401F
    s_waitcnt lgkmcnt(0)
    v_add_f32 v74, v74, v78
    v_mul_f32 v74, 0x3ae38e39, v74
    v_cvt_pk_bf16_f32 v72, v72, v74
    v_and_b32 v74, 0xffff0000, v72
    v_lshlrev_b32 v72, 16, v72
    v_add_f32 v74, 0x3727c5ac, v74
    v_cvt_pk_bf16_f32 v74, v74, v74
    v_lshlrev_b32 v74, 16, v74
    v_sqrt_f32 v74, v74
    s_nop 0
    v_cvt_pk_bf16_f32 v74, v74, v74
    v_lshlrev_b32 v74, 16, v74
    v_rcp_f32 v74, v74
    s_nop 0
    s_movk_i32 s56, 16384
    s_mov_b32 s57, 32768
    v_sub_f32 v76, v96, v72
    v_sub_f32 v77, v97, v72
    v_cvt_pk_bf16_f32 v76, 0, v76
    v_cvt_pk_bf16_f32 v77, 0, v77
    v_mul_f32 v76, v76, v74
    v_mul_f32 v77, v77, v74
    v_cvt_pk_bf16_f32 v80, v76, v77
    v_sub_f32 v76, v98, v72
    v_sub_f32 v77, v99, v72
    v_cvt_pk_bf16_f32 v76, 0, v76
    v_cvt_pk_bf16_f32 v77, 0, v77
    v_mul_f32 v76, v76, v74
    v_mul_f32 v77, v77, v74
    v_cvt_pk_bf16_f32 v81, v76, v77
    v_sub_f32 v76, v100, v72
    v_sub_f32 v77, v101, v72
    v_cvt_pk_bf16_f32 v76, 0, v76
    v_cvt_pk_bf16_f32 v77, 0, v77
    v_mul_f32 v76, v76, v74
    v_mul_f32 v77, v77, v74
    v_cvt_pk_bf16_f32 v82, v76, v77
    v_sub_f32 v76, v102, v72
    v_sub_f32 v77, v103, v72
    v_cvt_pk_bf16_f32 v76, 0, v76
    v_cvt_pk_bf16_f32 v77, 0, v77
    v_mul_f32 v76, v76, v74
    v_mul_f32 v77, v77, v74
    v_cvt_pk_bf16_f32 v83, v76, v77
    ds_write_b128 v69, v[80:83] offset:0
    v_sub_f32 v76, v104, v72
    v_sub_f32 v77, v105, v72
    v_cvt_pk_bf16_f32 v76, 0, v76
    v_cvt_pk_bf16_f32 v77, 0, v77
    v_mul_f32 v76, v76, v74
    v_mul_f32 v77, v77, v74
    v_cvt_pk_bf16_f32 v84, v76, v77
    v_sub_f32 v76, v106, v72
    v_sub_f32 v77, v107, v72
    v_cvt_pk_bf16_f32 v76, 0, v76
    v_cvt_pk_bf16_f32 v77, 0, v77
    v_mul_f32 v76, v76, v74
    v_mul_f32 v77, v77, v74
    v_cvt_pk_bf16_f32 v85, v76, v77
    v_sub_f32 v76, v108, v72
    v_sub_f32 v77, v109, v72
    v_cvt_pk_bf16_f32 v76, 0, v76
    v_cvt_pk_bf16_f32 v77, 0, v77
    v_mul_f32 v76, v76, v74
    v_mul_f32 v77, v77, v74
    v_cvt_pk_bf16_f32 v86, v76, v77
    v_sub_f32 v76, v110, v72
    v_sub_f32 v77, v111, v72
    v_cvt_pk_bf16_f32 v76, 0, v76
    v_cvt_pk_bf16_f32 v77, 0, v77
    v_mul_f32 v76, v76, v74
    v_mul_f32 v77, v77, v74
    v_cvt_pk_bf16_f32 v87, v76, v77
    ds_write_b128 v69, v[84:87] offset:4096
    v_sub_f32 v76, v112, v72
    v_sub_f32 v77, v113, v72
    v_cvt_pk_bf16_f32 v76, 0, v76
    v_cvt_pk_bf16_f32 v77, 0, v77
    v_mul_f32 v76, v76, v74
    v_mul_f32 v77, v77, v74
    v_cvt_pk_bf16_f32 v88, v76, v77
    v_sub_f32 v76, v114, v72
    v_sub_f32 v77, v115, v72
    v_cvt_pk_bf16_f32 v76, 0, v76
    v_cvt_pk_bf16_f32 v77, 0, v77
    v_mul_f32 v76, v76, v74
    v_mul_f32 v77, v77, v74
    v_cvt_pk_bf16_f32 v89, v76, v77
    v_sub_f32 v76, v116, v72
    v_sub_f32 v77, v117, v72
    v_cvt_pk_bf16_f32 v76, 0, v76
    v_cvt_pk_bf16_f32 v77, 0, v77
    v_mul_f32 v76, v76, v74
    v_mul_f32 v77, v77, v74
    v_cvt_pk_bf16_f32 v90, v76, v77
    v_sub_f32 v76, v118, v72
    v_sub_f32 v77, v119, v72
    v_cvt_pk_bf16_f32 v76, 0, v76
    v_cvt_pk_bf16_f32 v77, 0, v77
    v_mul_f32 v76, v76, v74
    v_mul_f32 v77, v77, v74
    v_cvt_pk_bf16_f32 v91, v76, v77
    s_mov_b64 exec, s[26:27]
    ds_write_b128 v69, v[88:91] offset:8192
    s_mov_b64 exec, -1
    s_waitcnt lgkmcnt(0)
    s_barrier
    ds_read_b128 v[80:83], v70 offset:0
    ds_read_b128 v[84:87], v70 offset:4096
    ds_read_b128 v[88:91], v70 offset:8192
    s_cmp_lg_u32 s28, 0
    s_waitcnt lgkmcnt(0)
    s_cbranch_scc1 L_k1_st2
    buffer_store_dwordx4 v[88:91], v71, s[12:15], s57 offen sc0 sc1
L_k1_st2:
    buffer_store_dwordx4 v[80:83], v71, s[12:15], 0 offen sc0 sc1
    buffer_store_dwordx4 v[84:87], v71, s[12:15], s56 offen sc0 sc1
    s_mov_b32 m0, s79
    s_add_u32 s77, s77, 1
    buffer_load_dwordx4 v254, s[84:87], s78 offen lds
    s_add_u32 m0, s79, 36864
    s_cmp_eq_u32 s77, 9
    buffer_load_dwordx4 v254, s[88:91], s78 offen lds
    s_cselect_b32 s35, 36864, 0
    s_add_u32 s79, s79, s35
    s_add_u32 s79, s79, 4096
    s_add_u32 s78, s78, 294912
    s_cmp_eq_u32 s77, 18
    s_cselect_b32 s77, 0, s77
    s_cselect_b32 s78, s44, s78
    s_cselect_b32 s79, s38, s79
    s_mov_b32 m0, s79
    s_add_u32 s77, s77, 1
    buffer_load_dwordx4 v254, s[84:87], s78 offen lds
    s_add_u32 m0, s79, 36864
    s_cmp_eq_u32 s77, 9
    buffer_load_dwordx4 v254, s[88:91], s78 offen lds
    s_cselect_b32 s35, 36864, 0
    s_add_u32 s79, s79, s35
    s_add_u32 s79, s79, 4096
    s_add_u32 s78, s78, 294912
    s_cmp_eq_u32 s77, 18
    s_cselect_b32 s77, 0, s77
    s_cselect_b32 s78, s44, s78
    s_cselect_b32 s79, s38, s79
    s_waitcnt vmcnt(4)
    s_barrier
    s_cmp_lg_u32 s28, 0
    s_cbranch_scc1 L_k1_noflag
L_k1_tok:
    v_readfirstlane_b32 s24, v126
    v_readfirstlane_b32 s25, v127
    s_cmp_lg_u32 s24, 0
    s_cbranch_scc1 L_k1_tokok
    buffer_load_dwordx2 v[126:127], v124, s[16:19], 0 offen sc1
    s_waitcnt vmcnt(0)
    s_branch L_k1_tok
L_k1_tokok:
    s_lshl_b32 s56, s3, 5
    s_add_u32 s56, s56, s101
    s_lshl_b32 s56, s56, 7
    s_mov_b64 exec, 0xffff
    buffer_store_dwordx2 v[126:127], v125, s[64:67], s56 offen sc0 sc1
    s_mov_b64 exec, -1
    ds_write_b64 v248, v[126:127]
L_k1_noflag:
    s_mov_b32 m0, s79
    s_add_u32 s77, s77, 1
    buffer_load_dwordx4 v254, s[84:87], s78 offen lds
    s_add_u32 m0, s79, 36864
    s_cmp_eq_u32 s77, 9
    buffer_load_dwordx4 v254, s[88:91], s78 offen lds
    s_cselect_b32 s35, 36864, 0
    s_add_u32 s79, s79, s35
    s_add_u32 s79, s79, 4096
    s_add_u32 s78, s78, 294912
    s_cmp_eq_u32 s77, 18
    s_cselect_b32 s77, 0, s77
    s_cselect_b32 s78, s44, s78
    s_cselect_b32 s79, s38, s79
    s_mov_b32 m0, s79
    s_add_u32 s77, s77, 1
    buffer_load_dwordx4 v254, s[84:87], s78 offen lds
    s_add_u32 m0, s79, 36864
    s_cmp_eq_u32 s77, 9
    buffer_load_dwordx4 v254, s[88:91], s78 offen lds
    s_cselect_b32 s35, 36864, 0
    s_add_u32 s79, s79, s35
    s_add_u32 s79, s79, 4096
    s_add_u32 s78, s78, 294912
    s_cmp_eq_u32 s77, 18
    s_cselect_b32 s77, 0, s77
    s_cselect_b32 s78, s44, s78
    s_cselect_b32 s79, s38, s79
    s_mov_b32 m0, s79
    s_add_u32 s77, s77, 1
    buffer_load_dwordx4 v254, s[84:87], s78 offen lds
    s_add_u32 m0, s79, 36864
    s_cmp_eq_u32 s77, 9
    buffer_load_dwordx4 v254, s[88:91], s78 offen lds
    s_cselect_b32 s35, 36864, 0
    s_add_u32 s79, s79, s35
    s_add_u32 s79, s79, 4096
    s_add_u32 s78, s78, 294912
    s_cmp_eq_u32 s77, 18
    s_cselect_b32 s77, 0, s77
    s_cselect_b32 s78, s44, s78
    s_cselect_b32 s79, s38, s79
    s_mov_b32 m0, s79
    s_add_u32 s77, s77, 1
    buffer_load_dwordx4 v254, s[84:87], s78 offen lds
    s_add_u32 m0, s79, 36864
    s_cmp_eq_u32 s77, 9
    buffer_load_dwordx4 v254, s[88:91], s78 offen lds
    s_cselect_b32 s35, 36864, 0
    s_add_u32 s79, s79, s35
    s_add_u32 s79, s79, 4096
    s_add_u32 s78, s78, 294912
    s_cmp_eq_u32 s77, 18
    s_cselect_b32 s77, 0, s77
    s_cselect_b32 s78, s44, s78
    s_cselect_b32 s79, s38, s79
    s_mov_b32 m0, s79
    s_add_u32 s77, s77, 1
    buffer_load_dwordx4 v254, s[84:87], s78 offen lds
    s_add_u32 m0, s79, 36864
    s_cmp_eq_u32 s77, 9
    buffer_load_dwordx4 v254, s[88:91], s78 offen lds
    s_cselect_b32 s35, 36864, 0
    s_add_u32 s79, s79, s35
    s_add_u32 s79, s79, 4096
    s_add_u32 s78, s78, 294912
    s_cmp_eq_u32 s77, 18
    s_cselect_b32 s77, 0, s77
    s_cselect_b32 s78, s44, s78
    s_cselect_b32 s79, s38, s79
    s_mov_b32 m0, s79
    s_add_u32 s77, s77, 1
    buffer_load_dwordx4 v254, s[84:87], s78 offen lds
    s_add_u32 m0, s79, 36864
    s_cmp_eq_u32 s77, 9
    buffer_load_dwordx4 v254, s[88:91], s78 offen lds
    s_cselect_b32 s35, 36864, 0
    s_add_u32 s79, s79, s35
    s_add_u32 s79, s79, 4096
    s_add_u32 s78, s78, 294912
    s_cmp_eq_u32 s77, 18
    s_cselect_b32 s77, 0, s77
    s_cselect_b32 s78, s44, s78
    s_cselect_b32 s79, s38, s79
    s_mov_b32 m0, s79
    s_add_u32 s77, s77, 1
    buffer_load_dwordx4 v254, s[84:87], s78 offen lds
    s_add_u32 m0, s79, 36864
    s_cmp_eq_u32 s77, 9
    buffer_load_dwordx4 v254, s[88:91], s78 offen lds
    s_cselect_b32 s35, 36864, 0
    s_add_u32 s79, s79, s35
    s_add_u32 s79, s79, 4096
    s_add_u32 s78, s78, 294912
    s_cmp_eq_u32 s77, 18
    s_cselect_b32 s77, 0, s77
    s_cselect_b32 s78, s44, s78
    s_cselect_b32 s79, s38, s79
    s_mov_b32 m0, s79
    s_add_u32 s77, s77, 1
    buffer_load_dwordx4 v254, s[84:87], s78 offen lds
    s_add_u32 m0, s79, 36864
    s_cmp_eq_u32 s77, 9
    buffer_load_dwordx4 v254, s[88:91], s78 offen lds
    s_cselect_b32 s35, 36864, 0
    s_add_u32 s79, s79, s35
    s_add_u32 s79, s79, 4096
    s_add_u32 s78, s78, 294912
    s_cmp_eq_u32 s77, 18
    s_cselect_b32 s77, 0, s77
    s_cselect_b32 s78, s44, s78
    s_cselect_b32 s79, s38, s79
    s_mov_b32 m0, s79
    s_add_u32 s77, s77, 1
    buffer_load_dwordx4 v254, s[84:87], s78 offen lds
    s_add_u32 m0, s79, 36864
    s_cmp_eq_u32 s77, 9
    buffer_load_dwordx4 v254, s[88:91], s78 offen lds
    s_cselect_b32 s35, 36864, 0
    s_add_u32 s79, s79, s35
    s_add_u32 s79, s79, 4096
    s_add_u32 s78, s78, 294912
    s_cmp_eq_u32 s77, 18
    s_cselect_b32 s77, 0, s77
    s_cselect_b32 s78, s44, s78
    s_cselect_b32 s79, s38, s79
    s_mov_b32 m0, s79
    s_add_u32 s77, s77, 1
    buffer_load_dwordx4 v254, s[84:87], s78 offen lds
    s_add_u32 m0, s79, 36864
    s_cmp_eq_u32 s77, 9
    buffer_load_dwordx4 v254, s[88:91], s78 offen lds
    s_cselect_b32 s35, 36864, 0
    s_add_u32 s79, s79, s35
    s_add_u32 s79, s79, 4096
    s_add_u32 s78, s78, 294912
    s_cmp_eq_u32 s77, 18
    s_cselect_b32 s77, 0, s77
    s_cselect_b32 s78, s44, s78
    s_cselect_b32 s79, s38, s79
    s_mov_b32 m0, s79
    s_add_u32 s77, s77, 1
    buffer_load_dwordx4 v254, s[84:87], s78 offen lds
    s_add_u32 m0, s79, 36864
    s_cmp_eq_u32 s77, 9
    buffer_load_dwordx4 v254, s[88:91], s78 offen lds
    s_cselect_b32 s35, 36864, 0
    s_add_u32 s79, s79, s35
    s_add_u32 s79, s79, 4096
    s_add_u32 s78, s78, 294912
    s_cmp_eq_u32 s77, 18
    s_cselect_b32 s77, 0, s77
    s_cselect_b32 s78, s44, s78
    s_cselect_b32 s79, s38, s79
    s_mov_b32 m0, s79
    s_add_u32 s77, s77, 1
    buffer_load_dwordx4 v254, s[84:87], s78 offen lds
    s_add_u32 m0, s79, 36864
    s_cmp_eq_u32 s77, 9
    buffer_load_dwordx4 v254, s[88:91], s78 offen lds
    s_cselect_b32 s35, 36864, 0
    s_add_u32 s79, s79, s35
    s_add_u32 s79, s79, 4096
    s_add_u32 s78, s78, 294912
    s_cmp_eq_u32 s77, 18
    s_cselect_b32 s77, 0, s77
    s_cselect_b32 s78, s44, s78
    s_cselect_b32 s79, s38, s79
    s_mov_b32 m0, s79
    s_add_u32 s77, s77, 1
    buffer_load_dwordx4 v254, s[84:87], s78 offen lds
    s_add_u32 m0, s79, 36864
    s_cmp_eq_u32 s77, 9
    buffer_load_dwordx4 v254, s[88:91], s78 offen lds
    s_cselect_b32 s35, 36864, 0
    s_add_u32 s79, s79, s35
    s_add_u32 s79, s79, 4096
    s_add_u32 s78, s78, 294912
    s_cmp_eq_u32 s77, 18
    s_cselect_b32 s77, 0, s77
    s_cselect_b32 s78, s44, s78
    s_cselect_b32 s79, s38, s79
    v_and_b32 v16, 31, v0
    v_lshlrev_b32 v16, 7, v16
    s_lshl_b32 s56, s3, 12
    s_cmp_lg_u32 s28, 0
    s_cbranch_scc1 L_k1_polled
L_k1_poll:
    buffer_load_dwordx2 v[18:19], v16, s[64:67], s56 offen sc1
    s_waitcnt vmcnt(0)
    v_xor_b32 v18, s24, v18
    v_xor_b32 v19, s25, v19
    v_or_b32 v18, v18, v19
    v_cmp_ne_u32 vcc, 0, v18
    s_nop 3
    s_cmp_eq_u64 vcc, 0
    s_cbranch_scc1 L_k1_polled
    s_sleep 1
    s_branch L_k1_poll
L_k1_polled:
    s_waitcnt vmcnt(0) lgkmcnt(0)
    s_barrier
    ds_read_b64 v[244:245], v248
    s_add_u32 s45, s43, 0
    buffer_load_dwordx4 a[0:3], v9, s[12:15], s45 offen
    s_add_u32 s45, s43, 36864
    buffer_load_dwordx4 a[144:147], v9, s[12:15], s45 offen
    s_add_u32 s45, s43, 1024
    buffer_load_dwordx4 a[4:7], v9, s[12:15], s45 offen
    s_add_u32 s45, s43, 37888
    buffer_load_dwordx4 a[148:151], v9, s[12:15], s45 offen
    s_add_u32 s45, s43, 2048
    buffer_load_dwordx4 a[8:11], v9, s[12:15], s45 offen
    s_add_u32 s45, s43, 38912
    buffer_load_dwordx4 a[152:155], v9, s[12:15], s45 offen
    s_add_u32 s45, s43, 3072
    buffer_load_dwordx4 a[12:15], v9, s[12:15], s45 offen
    s_add_u32 s45, s43, 39936
    buffer_load_dwordx4 a[156:159], v9, s[12:15], s45 offen
    s_add_u32 s45, s43, 4096
    buffer_load_dwordx4 a[16:19], v9, s[12:15], s45 offen
    s_add_u32 s45, s43, 40960
    buffer_load_dwordx4 a[160:163], v9, s[12:15], s45 offen
    s_add_u32 s45, s43, 5120
    buffer_load_dwordx4 a[20:23], v9, s[12:15], s45 offen
    s_add_u32 s45, s43, 41984
    buffer_load_dwordx4 a[164:167], v9, s[12:15], s45 offen
    s_waitcnt lgkmcnt(0)
    v_readfirstlane_b32 s4, v244
    v_readfirstlane_b32 s5, v245
    s_mov_b32 s24, s8
    s_mov_b32 s25, s9
    s_and_b32 s25, s25, 0xffff
    s_mov_b32 s26, 0x00510000
    s_mov_b32 s27, 0x00020000
    s_add_u32 s16, s6, 0x00240000
    s_addc_u32 s17, s7, 0
    s_and_b32 s17, s17, 0xffff
    s_mov_b32 s18, 0x006c0000
    s_mov_b32 s19, 0x00020000
    s_mul_hi_u32 s9, s76, 1431655766
    s_mul_i32 s10, s9, 3
    s_sub_u32 s10, s76, s10
    s_lshr_b32 s11, s9, 1
    s_mul_hi_u32 s56, s11, 858993460
    s_mul_i32 s57, s56, 5
    s_and_b32 s58, s57, 1
    s_add_u32 s57, s57, s58
    s_sub_u32 s58, s11, 80
    s_lshr_b32 s59, s58, 2
    s_add_u32 s59, s59, 16
    s_and_b32 s58, s11, -4
    s_cmp_lt_u32 s11, 80
    s_cselect_b32 s56, s56, s59
    s_cselect_b32 s57, s57, s58
    s_sub_u32 s58, s11, s57
    s_lshl_b32 s57, s57, 6
    s_add_u32 s57, s57, s84
    s_add_u32 s57, s57, 128
    s_bfe_u32 s57, s57, 0x30007
    s_cmp_eq_u32 s57, 3
    s_cselect_b32 s57, 2, 0
    s_xor_b32 s57, s57, s58
    s_lshl_b32 s57, s57, 3
    s_lshr_b32 s59, s56, 3
    s_mul_i32 s59, s59, 36
    s_add_u32 s57, s57, s59
    s_and_b32 s59, s56, 7
    s_add_u32 s57, s57, s59
    s_lshr_b32 s59, s56, 2
    s_mul_i32 s59, s59, 36
    s_and_b32 s56, s56, 3
    s_add_u32 s59, s59, s56
    s_add_u32 s59, s59, 32
    s_cmp_lt_u32 s58, 4
    s_cselect_b32 s57, s57, s59
    s_cmp_lt_u32 s11, 144
    s_cselect_b32 s11, s57, s11
    s_mul_i32 s8, s11, 36864
    s_and_b32 s11, s9, 1
    s_lshl_b32 s11, s11, 9
    s_add_u32 s8, s8, s11
    s_mul_i32 s11, s10, 12288
    s_add_u32 s8, s8, s11
    s_cmp_lt_u32 s76, 864
    s_cselect_b32 s11, 0, 5308416
    s_mul_i32 s76, s9, 18432
    s_sub_u32 s76, s76, s11
    s_mul_i32 s10, s10, 384
    s_add_u32 s76, s76, s10
    s_lshl_b32 s9, s28, 12
    s_add_u32 s9, s9, 147456
    v_lshrrev_b32 v248, 3, v0
    v_mul_u32_u24 v248, 1152, v248
    v_and_b32 v249, 7, v0
    v_lshl_add_u32 v254, v249, 4, v248
    v_bfe_u32 v248, v0, 2, 3
    v_lshlrev_b32 v248, 7, v248
    v_lshrrev_b32 v249, 5, v0
    v_lshl_add_u32 v248, v249, 5, v248
    v_and_b32 v247, 3, v0
    v_lshl_add_u32 v248, v247, 3, v248
    v_add_u32 v248, s9, v248
    v_and_b32 v247, 31, v0
    v_lshlrev_b32 v247, 4, v247
    v_lshl_add_u32 v249, v249, 10, v247
    ds_read_b64_tr_b16 v[16:17], v12 offset:0
    ds_read_b64_tr_b16 v[18:19], v12 offset:512
    ds_read_b64_tr_b16 v[20:21], v13 offset:0
    ds_read_b64_tr_b16 v[22:23], v13 offset:512
    s_waitcnt vmcnt(8)
    s_waitcnt lgkmcnt(0)
    v_mfma_f32_16x16x32_bf16 v[64:67], v[16:19], a[0:3], 0
    s_add_u32 s45, s43, 6144
    ds_read_b64_tr_b16 v[24:25], v36 offset:0
    v_mfma_f32_16x16x32_bf16 v[96:99], v[20:23], a[0:3], 0
    ds_read_b64_tr_b16 v[26:27], v36 offset:512
    buffer_load_dwordx4 a[24:27], v9, s[12:15], s45 offen
    v_mfma_f32_16x16x32_bf16 v[72:75], v[16:19], a[4:7], 0
    ds_read_b64_tr_b16 v[28:29], v37 offset:0
    v_mfma_f32_16x16x32_bf16 v[104:107], v[20:23], a[4:7], 0
    ds_read_b64_tr_b16 v[30:31], v37 offset:512
    v_mfma_f32_16x16x32_bf16 v[80:83], v[16:19], a[144:147], 0
    s_add_u32 s45, s43, 43008
    v_mfma_f32_16x16x32_bf16 v[112:115], v[20:23], a[144:147], 0
    buffer_load_dwordx4 a[168:171], v9, s[12:15], s45 offen
    v_mfma_f32_16x16x32_bf16 v[88:91], v[16:19], a[148:151], 0
    v_mfma_f32_16x16x32_bf16 v[120:123], v[20:23], a[148:151], 0
    s_waitcnt lgkmcnt(0)
    v_mfma_f32_16x16x32_bf16 v[68:71], v[24:27], a[0:3], 0
    s_add_u32 s45, s43, 7168
    ds_read_b64_tr_b16 v[16:17], v12 offset:4096
    v_mfma_f32_16x16x32_bf16 v[100:103], v[28:31], a[0:3], 0
    ds_read_b64_tr_b16 v[18:19], v12 offset:4608
    buffer_load_dwordx4 a[28:31], v9, s[12:15], s45 offen
    v_mfma_f32_16x16x32_bf16 v[76:79], v[24:27], a[4:7], 0
    ds_read_b64_tr_b16 v[20:21], v13 offset:4096
    v_mfma_f32_16x16x32_bf16 v[108:111], v[28:31], a[4:7], 0
    ds_read_b64_tr_b16 v[22:23], v13 offset:4608
    v_mfma_f32_16x16x32_bf16 v[84:87], v[24:27], a[144:147], 0
    s_add_u32 s45, s43, 44032
    ds_read_b64_tr_b16 v[48:49], v14 offset:0
    v_mfma_f32_16x16x32_bf16 v[116:119], v[28:31], a[144:147], 0
    ds_read_b64_tr_b16 v[50:51], v14 offset:512
    buffer_load_dwordx4 a[172:175], v9, s[12:15], s45 offen
    v_mfma_f32_16x16x32_bf16 v[92:95], v[24:27], a[148:151], 0
    ds_read_b64_tr_b16 v[52:53], v15 offset:0
    v_mfma_f32_16x16x32_bf16 v[124:127], v[28:31], a[148:151], 0
    ds_read_b64_tr_b16 v[54:55], v15 offset:512
    s_waitcnt lgkmcnt(4)
    s_waitcnt vmcnt(8)
    v_mfma_f32_16x16x32_bf16 v[64:67], v[16:19], a[8:11], v[64:67]
    s_add_u32 s45, s43, 8192
    ds_read_b64_tr_b16 v[24:25], v36 offset:4096
    v_mfma_f32_16x16x32_bf16 v[96:99], v[20:23], a[8:11], v[96:99]
    ds_read_b64_tr_b16 v[26:27], v36 offset:4608
    buffer_load_dwordx4 a[32:35], v9, s[12:15], s45 offen
    v_mfma_f32_16x16x32_bf16 v[72:75], v[16:19], a[12:15], v[72:75]
    v_mfma_f32_16x16x32_bf16 v[104:107], v[20:23], a[12:15], v[104:107]
    v_mfma_f32_16x16x32_bf16 v[80:83], v[16:19], a[152:155], v[80:83]
    s_add_u32 s45, s43, 45056
    v_mfma_f32_16x16x32_bf16 v[112:115], v[20:23], a[152:155], v[112:115]
    buffer_load_dwordx4 a[176:179], v9, s[12:15], s45 offen
    v_mfma_f32_16x16x32_bf16 v[88:91], v[16:19], a[156:159], v[88:91]
    v_mfma_f32_16x16x32_bf16 v[120:123], v[20:23], a[156:159], v[120:123]
    s_waitcnt lgkmcnt(2)
    v_mfma_f32_16x16x32_bf16 v[128:131], v[48:51], a[0:3], 0
    s_add_u32 s45, s43, 9216
    ds_read_b64_tr_b16 v[28:29], v37 offset:4096
    v_mfma_f32_16x16x32_bf16 v[160:163], v[52:55], a[0:3], 0
    ds_read_b64_tr_b16 v[30:31], v37 offset:4608
    buffer_load_dwordx4 a[36:39], v9, s[12:15], s45 offen
    v_mfma_f32_16x16x32_bf16 v[136:139], v[48:51], a[4:7], 0
    v_mfma_f32_16x16x32_bf16 v[168:171], v[52:55], a[4:7], 0
    v_mfma_f32_16x16x32_bf16 v[144:147], v[48:51], a[144:147], 0
    s_add_u32 s45, s43, 46080
    v_mfma_f32_16x16x32_bf16 v[176:179], v[52:55], a[144:147], 0
    buffer_load_dwordx4 a[180:183], v9, s[12:15], s45 offen
    v_mfma_f32_16x16x32_bf16 v[152:155], v[48:51], a[148:151], 0
    v_mfma_f32_16x16x32_bf16 v[184:187], v[52:55], a[148:151], 0
    s_waitcnt lgkmcnt(0)
    v_mfma_f32_16x16x32_bf16 v[68:71], v[24:27], a[8:11], v[68:71]
    s_add_u32 s45, s43, 10240
    ds_read_b64_tr_b16 v[16:17], v12 offset:8192
    v_mfma_f32_16x16x32_bf16 v[100:103], v[28:31], a[8:11], v[100:103]
    ds_read_b64_tr_b16 v[18:19], v12 offset:8704
    buffer_load_dwordx4 a[40:43], v9, s[12:15], s45 offen
    v_mfma_f32_16x16x32_bf16 v[76:79], v[24:27], a[12:15], v[76:79]
    ds_read_b64_tr_b16 v[20:21], v13 offset:8192
    v_mfma_f32_16x16x32_bf16 v[108:111], v[28:31], a[12:15], v[108:111]
    ds_read_b64_tr_b16 v[22:23], v13 offset:8704
    v_mfma_f32_16x16x32_bf16 v[84:87], v[24:27], a[152:155], v[84:87]
    s_add_u32 s45, s43, 47104
    ds_read_b64_tr_b16 v[56:57], v38 offset:0
    v_mfma_f32_16x16x32_bf16 v[116:119], v[28:31], a[152:155], v[116:119]
    ds_read_b64_tr_b16 v[58:59], v38 offset:512
    buffer_load_dwordx4 a[184:187], v9, s[12:15], s45 offen
    v_mfma_f32_16x16x32_bf16 v[92:95], v[24:27], a[156:159], v[92:95]
    ds_read_b64_tr_b16 v[60:61], v39 offset:0
    v_mfma_f32_16x16x32_bf16 v[124:127], v[28:31], a[156:159], v[124:127]
    ds_read_b64_tr_b16 v[62:63], v39 offset:512
    s_waitcnt lgkmcnt(4)
    s_waitcnt vmcnt(10)
    v_mfma_f32_16x16x32_bf16 v[64:67], v[16:19], a[16:19], v[64:67]
    s_add_u32 s45, s43, 11264
    ds_read_b64_tr_b16 v[24:25], v36 offset:8192
    v_mfma_f32_16x16x32_bf16 v[96:99], v[20:23], a[16:19], v[96:99]
    ds_read_b64_tr_b16 v[26:27], v36 offset:8704
    buffer_load_dwordx4 a[44:47], v9, s[12:15], s45 offen
    v_mfma_f32_16x16x32_bf16 v[72:75], v[16:19], a[20:23], v[72:75]
    v_mfma_f32_16x16x32_bf16 v[104:107], v[20:23], a[20:23], v[104:107]
    v_mfma_f32_16x16x32_bf16 v[80:83], v[16:19], a[160:163], v[80:83]
    s_add_u32 s45, s43, 48128
    v_mfma_f32_16x16x32_bf16 v[112:115], v[20:23], a[160:163], v[112:115]
    buffer_load_dwordx4 a[188:191], v9, s[12:15], s45 offen
    v_mfma_f32_16x16x32_bf16 v[88:91], v[16:19], a[164:167], v[88:91]
    v_mfma_f32_16x16x32_bf16 v[120:123], v[20:23], a[164:167], v[120:123]
    s_waitcnt lgkmcnt(2)
    v_mfma_f32_16x16x32_bf16 v[132:135], v[56:59], a[0:3], 0
    s_add_u32 s45, s43, 12288
    ds_read_b64_tr_b16 v[28:29], v37 offset:8192
    v_mfma_f32_16x16x32_bf16 v[164:167], v[60:63], a[0:3], 0
    ds_read_b64_tr_b16 v[30:31], v37 offset:8704
    buffer_load_dwordx4 a[48:51], v9, s[12:15], s45 offen
    v_mfma_f32_16x16x32_bf16 v[140:143], v[56:59], a[4:7], 0
    v_mfma_f32_16x16x32_bf16 v[172:175], v[60:63], a[4:7], 0
    v_mfma_f32_16x16x32_bf16 v[148:151], v[56:59], a[144:147], 0
    s_add_u32 s45, s43, 49152
    v_mfma_f32_16x16x32_bf16 v[180:183], v[60:63], a[144:147], 0
    buffer_load_dwordx4 a[192:195], v9, s[12:15], s45 offen
    v_mfma_f32_16x16x32_bf16 v[156:159], v[56:59], a[148:151], 0
    v_mfma_f32_16x16x32_bf16 v[188:191], v[60:63], a[148:151], 0
    s_waitcnt lgkmcnt(0)
    v_mfma_f32_16x16x32_bf16 v[68:71], v[24:27], a[16:19], v[68:71]
    s_add_u32 s45, s43, 13312
    ds_read_b64_tr_b16 v[16:17], v12 offset:12288
    v_mfma_f32_16x16x32_bf16 v[100:103], v[28:31], a[16:19], v[100:103]
    ds_read_b64_tr_b16 v[18:19], v12 offset:12800
    buffer_load_dwordx4 a[52:55], v9, s[12:15], s45 offen
    v_mfma_f32_16x16x32_bf16 v[76:79], v[24:27], a[20:23], v[76:79]
    ds_read_b64_tr_b16 v[20:21], v13 offset:12288
    v_mfma_f32_16x16x32_bf16 v[108:111], v[28:31], a[20:23], v[108:111]
    ds_read_b64_tr_b16 v[22:23], v13 offset:12800
    v_mfma_f32_16x16x32_bf16 v[84:87], v[24:27], a[160:163], v[84:87]
    s_add_u32 s45, s43, 50176
    ds_read_b64_tr_b16 v[48:49], v14 offset:4096
    v_mfma_f32_16x16x32_bf16 v[116:119], v[28:31], a[160:163], v[116:119]
    ds_read_b64_tr_b16 v[50:51], v14 offset:4608
    buffer_load_dwordx4 a[196:199], v9, s[12:15], s45 offen
    v_mfma_f32_16x16x32_bf16 v[92:95], v[24:27], a[164:167], v[92:95]
    ds_read_b64_tr_b16 v[52:53], v15 offset:4096
    v_mfma_f32_16x16x32_bf16 v[124:127], v[28:31], a[164:167], v[124:127]
    ds_read_b64_tr_b16 v[54:55], v15 offset:4608
    s_waitcnt lgkmcnt(4)
    s_waitcnt vmcnt(12)
    v_mfma_f32_16x16x32_bf16 v[64:67], v[16:19], a[24:27], v[64:67]
    s_add_u32 s45, s43, 14336
    ds_read_b64_tr_b16 v[24:25], v36 offset:12288
    v_mfma_f32_16x16x32_bf16 v[96:99], v[20:23], a[24:27], v[96:99]
    ds_read_b64_tr_b16 v[26:27], v36 offset:12800
    buffer_load_dwordx4 a[56:59], v9, s[12:15], s45 offen
    v_mfma_f32_16x16x32_bf16 v[72:75], v[16:19], a[28:31], v[72:75]
    v_mfma_f32_16x16x32_bf16 v[104:107], v[20:23], a[28:31], v[104:107]
    v_mfma_f32_16x16x32_bf16 v[80:83], v[16:19], a[168:171], v[80:83]
    s_add_u32 s45, s43, 51200
    v_mfma_f32_16x16x32_bf16 v[112:115], v[20:23], a[168:171], v[112:115]
    buffer_load_dwordx4 a[200:203], v9, s[12:15], s45 offen
    v_mfma_f32_16x16x32_bf16 v[88:91], v[16:19], a[172:175], v[88:91]
    v_mfma_f32_16x16x32_bf16 v[120:123], v[20:23], a[172:175], v[120:123]
    s_waitcnt lgkmcnt(2)
    v_mfma_f32_16x16x32_bf16 v[128:131], v[48:51], a[8:11], v[128:131]
    s_add_u32 s45, s43, 15360
    ds_read_b64_tr_b16 v[28:29], v37 offset:12288
    v_mfma_f32_16x16x32_bf16 v[160:163], v[52:55], a[8:11], v[160:163]
    ds_read_b64_tr_b16 v[30:31], v37 offset:12800
    buffer_load_dwordx4 a[60:63], v9, s[12:15], s45 offen
    v_mfma_f32_16x16x32_bf16 v[136:139], v[48:51], a[12:15], v[136:139]
    v_mfma_f32_16x16x32_bf16 v[168:171], v[52:55], a[12:15], v[168:171]
    v_mfma_f32_16x16x32_bf16 v[144:147], v[48:51], a[152:155], v[144:147]
    s_add_u32 s45, s43, 52224
    v_mfma_f32_16x16x32_bf16 v[176:179], v[52:55], a[152:155], v[176:179]
    buffer_load_dwordx4 a[204:207], v9, s[12:15], s45 offen
    v_mfma_f32_16x16x32_bf16 v[152:155], v[48:51], a[156:159], v[152:155]
    v_mfma_f32_16x16x32_bf16 v[184:187], v[52:55], a[156:159], v[184:187]
    s_waitcnt lgkmcnt(0)
    v_mfma_f32_16x16x32_bf16 v[68:71], v[24:27], a[24:27], v[68:71]
    s_add_u32 s45, s43, 16384
    ds_read_b64_tr_b16 v[16:17], v12 offset:16384
    v_mfma_f32_16x16x32_bf16 v[100:103], v[28:31], a[24:27], v[100:103]
    ds_read_b64_tr_b16 v[18:19], v12 offset:16896
    buffer_load_dwordx4 a[64:67], v9, s[12:15], s45 offen
    v_mfma_f32_16x16x32_bf16 v[76:79], v[24:27], a[28:31], v[76:79]
    ds_read_b64_tr_b16 v[20:21], v13 offset:16384
    v_mfma_f32_16x16x32_bf16 v[108:111], v[28:31], a[28:31], v[108:111]
    ds_read_b64_tr_b16 v[22:23], v13 offset:16896
    v_mfma_f32_16x16x32_bf16 v[84:87], v[24:27], a[168:171], v[84:87]
    s_add_u32 s45, s43, 53248
    ds_read_b64_tr_b16 v[56:57], v38 offset:4096
    v_mfma_f32_16x16x32_bf16 v[116:119], v[28:31], a[168:171], v[116:119]
    ds_read_b64_tr_b16 v[58:59], v38 offset:4608
    buffer_load_dwordx4 a[208:211], v9, s[12:15], s45 offen
    v_mfma_f32_16x16x32_bf16 v[92:95], v[24:27], a[172:175], v[92:95]
    ds_read_b64_tr_b16 v[60:61], v39 offset:4096
    v_mfma_f32_16x16x32_bf16 v[124:127], v[28:31], a[172:175], v[124:127]
    ds_read_b64_tr_b16 v[62:63], v39 offset:4608
    s_waitcnt lgkmcnt(4)
    s_waitcnt vmcnt(14)
    v_mfma_f32_16x16x32_bf16 v[64:67], v[16:19], a[32:35], v[64:67]
    s_add_u32 s45, s43, 17408
    ds_read_b64_tr_b16 v[24:25], v36 offset:16384
    v_mfma_f32_16x16x32_bf16 v[96:99], v[20:23], a[32:35], v[96:99]
    ds_read_b64_tr_b16 v[26:27], v36 offset:16896
    buffer_load_dwordx4 a[68:71], v9, s[12:15], s45 offen
    v_mfma_f32_16x16x32_bf16 v[72:75], v[16:19], a[36:39], v[72:75]
    v_mfma_f32_16x16x32_bf16 v[104:107], v[20:23], a[36:39], v[104:107]
    v_mfma_f32_16x16x32_bf16 v[80:83], v[16:19], a[176:179], v[80:83]
    s_add_u32 s45, s43, 54272
    v_mfma_f32_16x16x32_bf16 v[112:115], v[20:23], a[176:179], v[112:115]
    buffer_load_dwordx4 a[212:215], v9, s[12:15], s45 offen
    v_mfma_f32_16x16x32_bf16 v[88:91], v[16:19], a[180:183], v[88:91]
    v_mfma_f32_16x16x32_bf16 v[120:123], v[20:23], a[180:183], v[120:123]
    s_waitcnt lgkmcnt(2)
    v_mfma_f32_16x16x32_bf16 v[132:135], v[56:59], a[8:11], v[132:135]
    s_add_u32 s45, s43, 18432
    ds_read_b64_tr_b16 v[28:29], v37 offset:16384
    v_mfma_f32_16x16x32_bf16 v[164:167], v[60:63], a[8:11], v[164:167]
    ds_read_b64_tr_b16 v[30:31], v37 offset:16896
    buffer_load_dwordx4 a[72:75], v9, s[12:15], s45 offen
    v_mfma_f32_16x16x32_bf16 v[140:143], v[56:59], a[12:15], v[140:143]
    v_mfma_f32_16x16x32_bf16 v[172:175], v[60:63], a[12:15], v[172:175]
    v_mfma_f32_16x16x32_bf16 v[148:151], v[56:59], a[152:155], v[148:151]
    s_add_u32 s45, s43, 55296
    v_mfma_f32_16x16x32_bf16 v[180:183], v[60:63], a[152:155], v[180:183]
    buffer_load_dwordx4 a[216:219], v9, s[12:15], s45 offen
    v_mfma_f32_16x16x32_bf16 v[156:159], v[56:59], a[156:159], v[156:159]
    v_mfma_f32_16x16x32_bf16 v[188:191], v[60:63], a[156:159], v[188:191]
    s_waitcnt lgkmcnt(0)
    v_mfma_f32_16x16x32_bf16 v[68:71], v[24:27], a[32:35], v[68:71]
    s_add_u32 s45, s43, 19456
    ds_read_b64_tr_b16 v[16:17], v12 offset:20480
    v_mfma_f32_16x16x32_bf16 v[100:103], v[28:31], a[32:35], v[100:103]
    ds_read_b64_tr_b16 v[18:19], v12 offset:20992
    buffer_load_dwordx4 a[76:79], v9, s[12:15], s45 offen
    v_mfma_f32_16x16x32_bf16 v[76:79], v[24:27], a[36:39], v[76:79]
    ds_read_b64_tr_b16 v[20:21], v13 offset:20480
    v_mfma_f32_16x16x32_bf16 v[108:111], v[28:31], a[36:39], v[108:111]
    ds_read_b64_tr_b16 v[22:23], v13 offset:20992
    v_mfma_f32_16x16x32_bf16 v[84:87], v[24:27], a[176:179], v[84:87]
    s_add_u32 s45, s43, 56320
    v_mfma_f32_16x16x32_bf16 v[116:119], v[28:31], a[176:179], v[116:119]
    buffer_load_dwordx4 a[220:223], v9, s[12:15], s45 offen
    v_mfma_f32_16x16x32_bf16 v[92:95], v[24:27], a[180:183], v[92:95]
    v_mfma_f32_16x16x32_bf16 v[124:127], v[28:31], a[180:183], v[124:127]
    s_waitcnt lgkmcnt(0)
    s_waitcnt vmcnt(16)
    v_mfma_f32_16x16x32_bf16 v[64:67], v[16:19], a[40:43], v[64:67]
    s_add_u32 s45, s43, 20480
    ds_read_b64_tr_b16 v[24:25], v36 offset:20480
    v_mfma_f32_16x16x32_bf16 v[96:99], v[20:23], a[40:43], v[96:99]
    ds_read_b64_tr_b16 v[26:27], v36 offset:20992
    buffer_load_dwordx4 a[80:83], v9, s[12:15], s45 offen
    v_mfma_f32_16x16x32_bf16 v[72:75], v[16:19], a[44:47], v[72:75]
    ds_read_b64_tr_b16 v[28:29], v37 offset:20480
    v_mfma_f32_16x16x32_bf16 v[104:107], v[20:23], a[44:47], v[104:107]
    ds_read_b64_tr_b16 v[30:31], v37 offset:20992
    v_mfma_f32_16x16x32_bf16 v[80:83], v[16:19], a[184:187], v[80:83]
    s_add_u32 s45, s43, 57344
    ds_read_b64_tr_b16 v[48:49], v14 offset:8192
    v_mfma_f32_16x16x32_bf16 v[112:115], v[20:23], a[184:187], v[112:115]
    ds_read_b64_tr_b16 v[50:51], v14 offset:8704
    buffer_load_dwordx4 a[224:227], v9, s[12:15], s45 offen
    v_mfma_f32_16x16x32_bf16 v[88:91], v[16:19], a[188:191], v[88:91]
    ds_read_b64_tr_b16 v[52:53], v15 offset:8192
    v_mfma_f32_16x16x32_bf16 v[120:123], v[20:23], a[188:191], v[120:123]
    ds_read_b64_tr_b16 v[54:55], v15 offset:8704
    s_waitcnt lgkmcnt(4)
    v_mfma_f32_16x16x32_bf16 v[68:71], v[24:27], a[40:43], v[68:71]
    s_add_u32 s45, s43, 21504
    ds_read_b64_tr_b16 v[16:17], v12 offset:24576
    v_mfma_f32_16x16x32_bf16 v[100:103], v[28:31], a[40:43], v[100:103]
    ds_read_b64_tr_b16 v[18:19], v12 offset:25088
    buffer_load_dwordx4 a[84:87], v9, s[12:15], s45 offen
    v_mfma_f32_16x16x32_bf16 v[76:79], v[24:27], a[44:47], v[76:79]
    v_mfma_f32_16x16x32_bf16 v[108:111], v[28:31], a[44:47], v[108:111]
    v_mfma_f32_16x16x32_bf16 v[84:87], v[24:27], a[184:187], v[84:87]
    s_add_u32 s45, s43, 58368
    v_mfma_f32_16x16x32_bf16 v[116:119], v[28:31], a[184:187], v[116:119]
    buffer_load_dwordx4 a[228:231], v9, s[12:15], s45 offen
    v_mfma_f32_16x16x32_bf16 v[92:95], v[24:27], a[188:191], v[92:95]
    v_mfma_f32_16x16x32_bf16 v[124:127], v[28:31], a[188:191], v[124:127]
    s_waitcnt lgkmcnt(2)
    v_mfma_f32_16x16x32_bf16 v[128:131], v[48:51], a[16:19], v[128:131]
    s_add_u32 s45, s43, 22528
    ds_read_b64_tr_b16 v[20:21], v13 offset:24576
    v_mfma_f32_16x16x32_bf16 v[160:163], v[52:55], a[16:19], v[160:163]
    ds_read_b64_tr_b16 v[22:23], v13 offset:25088
    buffer_load_dwordx4 a[88:91], v9, s[12:15], s45 offen
    v_mfma_f32_16x16x32_bf16 v[136:139], v[48:51], a[20:23], v[136:139]
    v_mfma_f32_16x16x32_bf16 v[168:171], v[52:55], a[20:23], v[168:171]
    v_mfma_f32_16x16x32_bf16 v[144:147], v[48:51], a[160:163], v[144:147]
    s_add_u32 s45, s43, 59392
    v_mfma_f32_16x16x32_bf16 v[176:179], v[52:55], a[160:163], v[176:179]
    buffer_load_dwordx4 a[232:235], v9, s[12:15], s45 offen
    v_mfma_f32_16x16x32_bf16 v[152:155], v[48:51], a[164:167], v[152:155]
    v_mfma_f32_16x16x32_bf16 v[184:187], v[52:55], a[164:167], v[184:187]
    s_waitcnt lgkmcnt(0)
    s_waitcnt vmcnt(18)
    v_mfma_f32_16x16x32_bf16 v[64:67], v[16:19], a[48:51], v[64:67]
    s_add_u32 s45, s43, 23552
    ds_read_b64_tr_b16 v[24:25], v36 offset:24576
    v_mfma_f32_16x16x32_bf16 v[96:99], v[20:23], a[48:51], v[96:99]
    ds_read_b64_tr_b16 v[26:27], v36 offset:25088
    buffer_load_dwordx4 a[92:95], v9, s[12:15], s45 offen
    v_mfma_f32_16x16x32_bf16 v[72:75], v[16:19], a[52:55], v[72:75]
    ds_read_b64_tr_b16 v[28:29], v37 offset:24576
    v_mfma_f32_16x16x32_bf16 v[104:107], v[20:23], a[52:55], v[104:107]
    ds_read_b64_tr_b16 v[30:31], v37 offset:25088
    v_mfma_f32_16x16x32_bf16 v[80:83], v[16:19], a[192:195], v[80:83]
    s_add_u32 s45, s43, 60416
    ds_read_b64_tr_b16 v[56:57], v38 offset:8192
    v_mfma_f32_16x16x32_bf16 v[112:115], v[20:23], a[192:195], v[112:115]
    ds_read_b64_tr_b16 v[58:59], v38 offset:8704
    buffer_load_dwordx4 a[236:239], v9, s[12:15], s45 offen
    v_mfma_f32_16x16x32_bf16 v[88:91], v[16:19], a[196:199], v[88:91]
    ds_read_b64_tr_b16 v[60:61], v39 offset:8192
    v_mfma_f32_16x16x32_bf16 v[120:123], v[20:23], a[196:199], v[120:123]
    ds_read_b64_tr_b16 v[62:63], v39 offset:8704
    s_waitcnt lgkmcnt(4)
    v_mfma_f32_16x16x32_bf16 v[68:71], v[24:27], a[48:51], v[68:71]
    s_add_u32 s45, s43, 24576
    ds_read_b64_tr_b16 v[16:17], v12 offset:28672
    v_mfma_f32_16x16x32_bf16 v[100:103], v[28:31], a[48:51], v[100:103]
    ds_read_b64_tr_b16 v[18:19], v12 offset:29184
    buffer_load_dwordx4 a[96:99], v9, s[12:15], s45 offen
    v_mfma_f32_16x16x32_bf16 v[76:79], v[24:27], a[52:55], v[76:79]
    v_mfma_f32_16x16x32_bf16 v[108:111], v[28:31], a[52:55], v[108:111]
    v_mfma_f32_16x16x32_bf16 v[84:87], v[24:27], a[192:195], v[84:87]
    s_add_u32 s45, s43, 61440
    v_mfma_f32_16x16x32_bf16 v[116:119], v[28:31], a[192:195], v[116:119]
    buffer_load_dwordx4 a[240:243], v9, s[12:15], s45 offen
    v_mfma_f32_16x16x32_bf16 v[92:95], v[24:27], a[196:199], v[92:95]
    v_mfma_f32_16x16x32_bf16 v[124:127], v[28:31], a[196:199], v[124:127]
    s_waitcnt lgkmcnt(2)
    v_mfma_f32_16x16x32_bf16 v[132:135], v[56:59], a[16:19], v[132:135]
    s_add_u32 s45, s43, 25600
    ds_read_b64_tr_b16 v[20:21], v13 offset:28672
    v_mfma_f32_16x16x32_bf16 v[164:167], v[60:63], a[16:19], v[164:167]
    ds_read_b64_tr_b16 v[22:23], v13 offset:29184
    buffer_load_dwordx4 a[100:103], v9, s[12:15], s45 offen
    v_mfma_f32_16x16x32_bf16 v[140:143], v[56:59], a[20:23], v[140:143]
    v_mfma_f32_16x16x32_bf16 v[172:175], v[60:63], a[20:23], v[172:175]
    v_mfma_f32_16x16x32_bf16 v[148:151], v[56:59], a[160:163], v[148:151]
    s_add_u32 s45, s43, 62464
    v_mfma_f32_16x16x32_bf16 v[180:183], v[60:63], a[160:163], v[180:183]
    buffer_load_dwordx4 a[244:247], v9, s[12:15], s45 offen
    v_mfma_f32_16x16x32_bf16 v[156:159], v[56:59], a[164:167], v[156:159]
    v_mfma_f32_16x16x32_bf16 v[188:191], v[60:63], a[164:167], v[188:191]
    s_waitcnt lgkmcnt(0)
    s_waitcnt vmcnt(20)
    s_lshl_b32 s77, s2, 2
    s_add_u32 s77, s77, s28
    s_lshl_b32 s77, s77, 11
    buffer_load_dwordx4 v[240:243], v9, s[80:83], s77 offen offset:0
    v_mfma_f32_16x16x32_bf16 v[64:67], v[16:19], a[56:59], v[64:67]
    s_add_u32 s45, s43, 26624
    ds_read_b64_tr_b16 v[24:25], v36 offset:28672
    v_mfma_f32_16x16x32_bf16 v[96:99], v[20:23], a[56:59], v[96:99]
    ds_read_b64_tr_b16 v[26:27], v36 offset:29184
    buffer_load_dwordx4 a[104:107], v9, s[12:15], s45 offen
    v_mfma_f32_16x16x32_bf16 v[72:75], v[16:19], a[60:63], v[72:75]
    ds_read_b64_tr_b16 v[28:29], v37 offset:28672
    v_mfma_f32_16x16x32_bf16 v[104:107], v[20:23], a[60:63], v[104:107]
    ds_read_b64_tr_b16 v[30:31], v37 offset:29184
    v_mfma_f32_16x16x32_bf16 v[80:83], v[16:19], a[200:203], v[80:83]
    s_add_u32 s45, s43, 63488
    ds_read_b64_tr_b16 v[48:49], v14 offset:12288
    v_mfma_f32_16x16x32_bf16 v[112:115], v[20:23], a[200:203], v[112:115]
    ds_read_b64_tr_b16 v[50:51], v14 offset:12800
    buffer_load_dwordx4 a[248:251], v9, s[12:15], s45 offen
    v_mfma_f32_16x16x32_bf16 v[88:91], v[16:19], a[204:207], v[88:91]
    ds_read_b64_tr_b16 v[52:53], v15 offset:12288
    v_mfma_f32_16x16x32_bf16 v[120:123], v[20:23], a[204:207], v[120:123]
    ds_read_b64_tr_b16 v[54:55], v15 offset:12800
    s_waitcnt lgkmcnt(4)
    v_mfma_f32_16x16x32_bf16 v[68:71], v[24:27], a[56:59], v[68:71]
    s_add_u32 s45, s43, 27648
    ds_read_b64_tr_b16 v[16:17], v12 offset:32768
    v_mfma_f32_16x16x32_bf16 v[100:103], v[28:31], a[56:59], v[100:103]
    ds_read_b64_tr_b16 v[18:19], v12 offset:33280
    buffer_load_dwordx4 a[108:111], v9, s[12:15], s45 offen
    v_mfma_f32_16x16x32_bf16 v[76:79], v[24:27], a[60:63], v[76:79]
    v_mfma_f32_16x16x32_bf16 v[108:111], v[28:31], a[60:63], v[108:111]
    v_mfma_f32_16x16x32_bf16 v[84:87], v[24:27], a[200:203], v[84:87]
    s_add_u32 s45, s43, 64512
    v_mfma_f32_16x16x32_bf16 v[116:119], v[28:31], a[200:203], v[116:119]
    buffer_load_dwordx4 a[252:255], v9, s[12:15], s45 offen
    v_mfma_f32_16x16x32_bf16 v[92:95], v[24:27], a[204:207], v[92:95]
    v_mfma_f32_16x16x32_bf16 v[124:127], v[28:31], a[204:207], v[124:127]
    s_waitcnt lgkmcnt(2)
    v_mfma_f32_16x16x32_bf16 v[128:131], v[48:51], a[24:27], v[128:131]
    s_add_u32 s45, s43, 28672
    ds_read_b64_tr_b16 v[20:21], v13 offset:32768
    v_mfma_f32_16x16x32_bf16 v[160:163], v[52:55], a[24:27], v[160:163]
    ds_read_b64_tr_b16 v[22:23], v13 offset:33280
    buffer_load_dwordx4 a[112:115], v9, s[12:15], s45 offen
    v_mfma_f32_16x16x32_bf16 v[136:139], v[48:51], a[28:31], v[136:139]
    v_mfma_f32_16x16x32_bf16 v[168:171], v[52:55], a[28:31], v[168:171]
    v_mfma_f32_16x16x32_bf16 v[144:147], v[48:51], a[168:171], v[144:147]
    s_add_u32 s45, s43, 65536
    v_mfma_f32_16x16x32_bf16 v[176:179], v[52:55], a[168:171], v[176:179]
    buffer_load_dwordx4 v[192:195], v9, s[12:15], s45 offen
    v_mfma_f32_16x16x32_bf16 v[152:155], v[48:51], a[172:175], v[152:155]
    v_mfma_f32_16x16x32_bf16 v[184:187], v[52:55], a[172:175], v[184:187]
    s_waitcnt lgkmcnt(0)
    s_waitcnt vmcnt(23)
    v_mfma_f32_16x16x32_bf16 v[64:67], v[16:19], a[64:67], v[64:67]
    s_add_u32 s45, s43, 29696
    ds_read_b64_tr_b16 v[24:25], v36 offset:32768
    v_mfma_f32_16x16x32_bf16 v[96:99], v[20:23], a[64:67], v[96:99]
    ds_read_b64_tr_b16 v[26:27], v36 offset:33280
    buffer_load_dwordx4 a[116:119], v9, s[12:15], s45 offen
    v_mfma_f32_16x16x32_bf16 v[72:75], v[16:19], a[68:71], v[72:75]
    ds_read_b64_tr_b16 v[28:29], v37 offset:32768
    v_mfma_f32_16x16x32_bf16 v[104:107], v[20:23], a[68:71], v[104:107]
    ds_read_b64_tr_b16 v[30:31], v37 offset:33280
    v_mfma_f32_16x16x32_bf16 v[80:83], v[16:19], a[208:211], v[80:83]
    s_add_u32 s45, s43, 66560
    ds_read_b64_tr_b16 v[56:57], v38 offset:12288
    v_mfma_f32_16x16x32_bf16 v[112:115], v[20:23], a[208:211], v[112:115]
    ds_read_b64_tr_b16 v[58:59], v38 offset:12800
    buffer_load_dwordx4 v[196:199], v9, s[12:15], s45 offen
    v_mfma_f32_16x16x32_bf16 v[88:91], v[16:19], a[212:215], v[88:91]
    ds_read_b64_tr_b16 v[60:61], v39 offset:12288
    v_mfma_f32_16x16x32_bf16 v[120:123], v[20:23], a[212:215], v[120:123]
    ds_read_b64_tr_b16 v[62:63], v39 offset:12800
    s_waitcnt lgkmcnt(4)
    v_add_u32 v12, 73728, v12
    v_add_u32 v36, 73728, v36
    v_add_u32 v13, 73728, v13
    v_add_u32 v37, 73728, v37
    v_mfma_f32_16x16x32_bf16 v[68:71], v[24:27], a[64:67], v[68:71]
    s_add_u32 s45, s43, 30720
    ds_read_b64_tr_b16 v[16:17], v12 offset:0
    v_mfma_f32_16x16x32_bf16 v[100:103], v[28:31], a[64:67], v[100:103]
    ds_read_b64_tr_b16 v[18:19], v12 offset:512
    buffer_load_dwordx4 a[120:123], v9, s[12:15], s45 offen
    v_mfma_f32_16x16x32_bf16 v[76:79], v[24:27], a[68:71], v[76:79]
    v_mfma_f32_16x16x32_bf16 v[108:111], v[28:31], a[68:71], v[108:111]
    v_mfma_f32_16x16x32_bf16 v[84:87], v[24:27], a[208:211], v[84:87]
    s_add_u32 s45, s43, 67584
    v_mfma_f32_16x16x32_bf16 v[116:119], v[28:31], a[208:211], v[116:119]
    buffer_load_dwordx4 v[200:203], v9, s[12:15], s45 offen
    v_mfma_f32_16x16x32_bf16 v[92:95], v[24:27], a[212:215], v[92:95]
    v_mfma_f32_16x16x32_bf16 v[124:127], v[28:31], a[212:215], v[124:127]
    s_waitcnt lgkmcnt(2)
    v_mfma_f32_16x16x32_bf16 v[132:135], v[56:59], a[24:27], v[132:135]
    s_add_u32 s45, s43, 31744
    ds_read_b64_tr_b16 v[20:21], v13 offset:0
    v_mfma_f32_16x16x32_bf16 v[164:167], v[60:63], a[24:27], v[164:167]
    ds_read_b64_tr_b16 v[22:23], v13 offset:512
    buffer_load_dwordx4 a[124:127], v9, s[12:15], s45 offen
    v_mfma_f32_16x16x32_bf16 v[140:143], v[56:59], a[28:31], v[140:143]
    v_mfma_f32_16x16x32_bf16 v[172:175], v[60:63], a[28:31], v[172:175]
    v_mfma_f32_16x16x32_bf16 v[148:151], v[56:59], a[168:171], v[148:151]
    s_add_u32 s45, s43, 68608
    v_mfma_f32_16x16x32_bf16 v[180:183], v[60:63], a[168:171], v[180:183]
    buffer_load_dwordx4 v[204:207], v9, s[12:15], s45 offen
    v_mfma_f32_16x16x32_bf16 v[156:159], v[56:59], a[172:175], v[156:159]
    v_mfma_f32_16x16x32_bf16 v[188:191], v[60:63], a[172:175], v[188:191]
    s_waitcnt lgkmcnt(0)
    s_waitcnt vmcnt(25)
    buffer_load_dwordx4 v[240:243], v9, s[80:83], s77 offen offset:1024
    v_mfma_f32_16x16x32_bf16 v[64:67], v[16:19], a[72:75], v[64:67]
    s_add_u32 s45, s43, 32768
    ds_read_b64_tr_b16 v[24:25], v36 offset:0
    v_mfma_f32_16x16x32_bf16 v[96:99], v[20:23], a[72:75], v[96:99]
    ds_read_b64_tr_b16 v[26:27], v36 offset:512
    buffer_load_dwordx4 a[128:131], v9, s[12:15], s45 offen
    v_mfma_f32_16x16x32_bf16 v[72:75], v[16:19], a[76:79], v[72:75]
    ds_read_b64_tr_b16 v[28:29], v37 offset:0
    v_mfma_f32_16x16x32_bf16 v[104:107], v[20:23], a[76:79], v[104:107]
    ds_read_b64_tr_b16 v[30:31], v37 offset:512
    v_mfma_f32_16x16x32_bf16 v[80:83], v[16:19], a[216:219], v[80:83]
    s_add_u32 s45, s43, 69632
    v_mfma_f32_16x16x32_bf16 v[112:115], v[20:23], a[216:219], v[112:115]
    buffer_load_dwordx4 v[208:211], v9, s[12:15], s45 offen
    v_mfma_f32_16x16x32_bf16 v[88:91], v[16:19], a[220:223], v[88:91]
    v_mfma_f32_16x16x32_bf16 v[120:123], v[20:23], a[220:223], v[120:123]
    s_waitcnt lgkmcnt(0)
    v_mfma_f32_16x16x32_bf16 v[68:71], v[24:27], a[72:75], v[68:71]
    s_add_u32 s45, s43, 33792
    ds_read_b64_tr_b16 v[16:17], v12 offset:4096
    v_mfma_f32_16x16x32_bf16 v[100:103], v[28:31], a[72:75], v[100:103]
    ds_read_b64_tr_b16 v[18:19], v12 offset:4608
    buffer_load_dwordx4 a[132:135], v9, s[12:15], s45 offen
    v_mfma_f32_16x16x32_bf16 v[76:79], v[24:27], a[76:79], v[76:79]
    ds_read_b64_tr_b16 v[20:21], v13 offset:4096
    v_mfma_f32_16x16x32_bf16 v[108:111], v[28:31], a[76:79], v[108:111]
    ds_read_b64_tr_b16 v[22:23], v13 offset:4608
    v_mfma_f32_16x16x32_bf16 v[84:87], v[24:27], a[216:219], v[84:87]
    s_add_u32 s45, s43, 70656
    ds_read_b64_tr_b16 v[48:49], v14 offset:16384
    v_mfma_f32_16x16x32_bf16 v[116:119], v[28:31], a[216:219], v[116:119]
    ds_read_b64_tr_b16 v[50:51], v14 offset:16896
    buffer_load_dwordx4 v[212:215], v9, s[12:15], s45 offen
    v_mfma_f32_16x16x32_bf16 v[92:95], v[24:27], a[220:223], v[92:95]
    ds_read_b64_tr_b16 v[52:53], v15 offset:16384
    v_mfma_f32_16x16x32_bf16 v[124:127], v[28:31], a[220:223], v[124:127]
    ds_read_b64_tr_b16 v[54:55], v15 offset:16896
    s_waitcnt lgkmcnt(4)
    s_waitcnt vmcnt(26)
    v_mfma_f32_16x16x32_bf16 v[64:67], v[16:19], a[80:83], v[64:67]
    s_add_u32 s45, s43, 34816
    ds_read_b64_tr_b16 v[24:25], v36 offset:4096
    v_mfma_f32_16x16x32_bf16 v[96:99], v[20:23], a[80:83], v[96:99]
    ds_read_b64_tr_b16 v[26:27], v36 offset:4608
    buffer_load_dwordx4 a[136:139], v9, s[12:15], s45 offen
    v_mfma_f32_16x16x32_bf16 v[72:75], v[16:19], a[84:87], v[72:75]
    v_mfma_f32_16x16x32_bf16 v[104:107], v[20:23], a[84:87], v[104:107]
    v_mfma_f32_16x16x32_bf16 v[80:83], v[16:19], a[224:227], v[80:83]
    s_add_u32 s45, s43, 71680
    v_mfma_f32_16x16x32_bf16 v[112:115], v[20:23], a[224:227], v[112:115]
    buffer_load_dwordx4 v[216:219], v9, s[12:15], s45 offen
    v_mfma_f32_16x16x32_bf16 v[88:91], v[16:19], a[228:231], v[88:91]
    v_mfma_f32_16x16x32_bf16 v[120:123], v[20:23], a[228:231], v[120:123]
    s_waitcnt lgkmcnt(2)
    v_mfma_f32_16x16x32_bf16 v[128:131], v[48:51], a[32:35], v[128:131]
    s_add_u32 s45, s43, 35840
    ds_read_b64_tr_b16 v[28:29], v37 offset:4096
    v_mfma_f32_16x16x32_bf16 v[160:163], v[52:55], a[32:35], v[160:163]
    ds_read_b64_tr_b16 v[30:31], v37 offset:4608
    buffer_load_dwordx4 a[140:143], v9, s[12:15], s45 offen
    v_mfma_f32_16x16x32_bf16 v[136:139], v[48:51], a[36:39], v[136:139]
    v_mfma_f32_16x16x32_bf16 v[168:171], v[52:55], a[36:39], v[168:171]
    v_mfma_f32_16x16x32_bf16 v[144:147], v[48:51], a[176:179], v[144:147]
    s_add_u32 s45, s43, 72704
    v_mfma_f32_16x16x32_bf16 v[176:179], v[52:55], a[176:179], v[176:179]
    buffer_load_dwordx4 v[220:223], v9, s[12:15], s45 offen
    v_mfma_f32_16x16x32_bf16 v[152:155], v[48:51], a[180:183], v[152:155]
    v_mfma_f32_16x16x32_bf16 v[184:187], v[52:55], a[180:183], v[184:187]
    s_waitcnt lgkmcnt(0)
    v_mfma_f32_16x16x32_bf16 v[68:71], v[24:27], a[80:83], v[68:71]
    ds_read_b64_tr_b16 v[16:17], v12 offset:8192
    v_mfma_f32_16x16x32_bf16 v[100:103], v[28:31], a[80:83], v[100:103]
    ds_read_b64_tr_b16 v[18:19], v12 offset:8704
    v_mfma_f32_16x16x32_bf16 v[76:79], v[24:27], a[84:87], v[76:79]
    ds_read_b64_tr_b16 v[20:21], v13 offset:8192
    v_mfma_f32_16x16x32_bf16 v[108:111], v[28:31], a[84:87], v[108:111]
    ds_read_b64_tr_b16 v[22:23], v13 offset:8704
    v_mfma_f32_16x16x32_bf16 v[84:87], v[24:27], a[224:227], v[84:87]
    ds_read_b64_tr_b16 v[56:57], v38 offset:16384
    v_mfma_f32_16x16x32_bf16 v[116:119], v[28:31], a[224:227], v[116:119]
    ds_read_b64_tr_b16 v[58:59], v38 offset:16896
    v_mfma_f32_16x16x32_bf16 v[92:95], v[24:27], a[228:231], v[92:95]
    ds_read_b64_tr_b16 v[60:61], v39 offset:16384
    v_mfma_f32_16x16x32_bf16 v[124:127], v[28:31], a[228:231], v[124:127]
    ds_read_b64_tr_b16 v[62:63], v39 offset:16896
    s_waitcnt lgkmcnt(4)
    s_waitcnt vmcnt(26)
    v_mfma_f32_16x16x32_bf16 v[64:67], v[16:19], a[88:91], v[64:67]
    ds_read_b64_tr_b16 v[24:25], v36 offset:8192
    v_mfma_f32_16x16x32_bf16 v[96:99], v[20:23], a[88:91], v[96:99]
    ds_read_b64_tr_b16 v[26:27], v36 offset:8704
    v_mfma_f32_16x16x32_bf16 v[72:75], v[16:19], a[92:95], v[72:75]
    v_mfma_f32_16x16x32_bf16 v[104:107], v[20:23], a[92:95], v[104:107]
    v_mfma_f32_16x16x32_bf16 v[80:83], v[16:19], a[232:235], v[80:83]
    v_mfma_f32_16x16x32_bf16 v[112:115], v[20:23], a[232:235], v[112:115]
    v_mfma_f32_16x16x32_bf16 v[88:91], v[16:19], a[236:239], v[88:91]
    v_mfma_f32_16x16x32_bf16 v[120:123], v[20:23], a[236:239], v[120:123]
    s_waitcnt lgkmcnt(2)
    v_mfma_f32_16x16x32_bf16 v[132:135], v[56:59], a[32:35], v[132:135]
    ds_read_b64_tr_b16 v[28:29], v37 offset:8192
    v_mfma_f32_16x16x32_bf16 v[164:167], v[60:63], a[32:35], v[164:167]
    ds_read_b64_tr_b16 v[30:31], v37 offset:8704
    v_mfma_f32_16x16x32_bf16 v[140:143], v[56:59], a[36:39], v[140:143]
    v_mfma_f32_16x16x32_bf16 v[172:175], v[60:63], a[36:39], v[172:175]
    v_mfma_f32_16x16x32_bf16 v[148:151], v[56:59], a[176:179], v[148:151]
    v_mfma_f32_16x16x32_bf16 v[180:183], v[60:63], a[176:179], v[180:183]
    v_mfma_f32_16x16x32_bf16 v[156:159], v[56:59], a[180:183], v[156:159]
    v_mfma_f32_16x16x32_bf16 v[188:191], v[60:63], a[180:183], v[188:191]
    s_waitcnt lgkmcnt(0)
    s_barrier
    s_mul_i32 s78, s3, 72
    s_and_b32 s79, s28, 1
    s_mul_i32 s79, s79, 36
    s_add_u32 s78, s78, s79
    v_min_u32 v255, 35, v0
    v_add_u32 v255, s78, v255
    v_mul_u32_u24 v255, 9216, v255
    s_cmp_lt_u32 s28, 2
    s_cselect_b32 s56, s84, s88
    s_cselect_b32 s57, s85, s89
    s_cselect_b32 s58, s86, s90
    s_mov_b32 s59, 0x00020000
    buffer_load_dword v240, v255, s[56:59], s52 offen offset:0
    buffer_load_dword v240, v255, s[56:59], s52 offen offset:64
    v_mfma_f32_16x16x32_bf16 v[68:71], v[24:27], a[88:91], v[68:71]
    ds_read_b64_tr_b16 v[16:17], v12 offset:12288
    v_mfma_f32_16x16x32_bf16 v[100:103], v[28:31], a[88:91], v[100:103]
    ds_read_b64_tr_b16 v[18:19], v12 offset:12800
    v_mfma_f32_16x16x32_bf16 v[76:79], v[24:27], a[92:95], v[76:79]
    ds_read_b64_tr_b16 v[20:21], v13 offset:12288
    v_mfma_f32_16x16x32_bf16 v[108:111], v[28:31], a[92:95], v[108:111]
    ds_read_b64_tr_b16 v[22:23], v13 offset:12800
    v_mfma_f32_16x16x32_bf16 v[84:87], v[24:27], a[232:235], v[84:87]
    ds_read_b64_tr_b16 v[48:49], v14 offset:20480
    v_mfma_f32_16x16x32_bf16 v[116:119], v[28:31], a[232:235], v[116:119]
    ds_read_b64_tr_b16 v[50:51], v14 offset:20992
    v_mfma_f32_16x16x32_bf16 v[92:95], v[24:27], a[236:239], v[92:95]
    ds_read_b64_tr_b16 v[52:53], v15 offset:20480
    v_mfma_f32_16x16x32_bf16 v[124:127], v[28:31], a[236:239], v[124:127]
    ds_read_b64_tr_b16 v[54:55], v15 offset:20992
    s_waitcnt lgkmcnt(4)
    s_waitcnt vmcnt(24)
    v_mfma_f32_16x16x32_bf16 v[64:67], v[16:19], a[96:99], v[64:67]
    ds_read_b64_tr_b16 v[24:25], v36 offset:12288
    v_mfma_f32_16x16x32_bf16 v[96:99], v[20:23], a[96:99], v[96:99]
    ds_read_b64_tr_b16 v[26:27], v36 offset:12800
    v_mfma_f32_16x16x32_bf16 v[72:75], v[16:19], a[100:103], v[72:75]
    v_mfma_f32_16x16x32_bf16 v[104:107], v[20:23], a[100:103], v[104:107]
    v_mfma_f32_16x16x32_bf16 v[80:83], v[16:19], a[240:243], v[80:83]
    v_mfma_f32_16x16x32_bf16 v[112:115], v[20:23], a[240:243], v[112:115]
    v_mfma_f32_16x16x32_bf16 v[88:91], v[16:19], a[244:247], v[88:91]
    v_mfma_f32_16x16x32_bf16 v[120:123], v[20:23], a[244:247], v[120:123]
    s_waitcnt lgkmcnt(2)
    v_mfma_f32_16x16x32_bf16 v[128:131], v[48:51], a[40:43], v[128:131]
    ds_read_b64_tr_b16 v[28:29], v37 offset:12288
    v_mfma_f32_16x16x32_bf16 v[160:163], v[52:55], a[40:43], v[160:163]
    ds_read_b64_tr_b16 v[30:31], v37 offset:12800
    v_mfma_f32_16x16x32_bf16 v[136:139], v[48:51], a[44:47], v[136:139]
    v_mfma_f32_16x16x32_bf16 v[168:171], v[52:55], a[44:47], v[168:171]
    v_mfma_f32_16x16x32_bf16 v[144:147], v[48:51], a[184:187], v[144:147]
    v_mfma_f32_16x16x32_bf16 v[176:179], v[52:55], a[184:187], v[176:179]
    v_mfma_f32_16x16x32_bf16 v[152:155], v[48:51], a[188:191], v[152:155]
    v_mfma_f32_16x16x32_bf16 v[184:187], v[52:55], a[188:191], v[184:187]
    s_waitcnt lgkmcnt(0)
    v_mfma_f32_16x16x32_bf16 v[68:71], v[24:27], a[96:99], v[68:71]
    ds_read_b64_tr_b16 v[16:17], v12 offset:16384
    v_mfma_f32_16x16x32_bf16 v[100:103], v[28:31], a[96:99], v[100:103]
    ds_read_b64_tr_b16 v[18:19], v12 offset:16896
    v_mfma_f32_16x16x32_bf16 v[76:79], v[24:27], a[100:103], v[76:79]
    ds_read_b64_tr_b16 v[20:21], v13 offset:16384
    v_mfma_f32_16x16x32_bf16 v[108:111], v[28:31], a[100:103], v[108:111]
    ds_read_b64_tr_b16 v[22:23], v13 offset:16896
    v_mfma_f32_16x16x32_bf16 v[84:87], v[24:27], a[240:243], v[84:87]
    ds_read_b64_tr_b16 v[56:57], v38 offset:20480
    v_mfma_f32_16x16x32_bf16 v[116:119], v[28:31], a[240:243], v[116:119]
    ds_read_b64_tr_b16 v[58:59], v38 offset:20992
    v_mfma_f32_16x16x32_bf16 v[92:95], v[24:27], a[244:247], v[92:95]
    ds_read_b64_tr_b16 v[60:61], v39 offset:20480
    v_mfma_f32_16x16x32_bf16 v[124:127], v[28:31], a[244:247], v[124:127]
    ds_read_b64_tr_b16 v[62:63], v39 offset:20992
    s_waitcnt lgkmcnt(4)
    s_waitcnt vmcnt(19)
    v_mfma_f32_16x16x32_bf16 v[64:67], v[16:19], a[104:107], v[64:67]
    ds_read_b64_tr_b16 v[24:25], v36 offset:16384
    v_mfma_f32_16x16x32_bf16 v[96:99], v[20:23], a[104:107], v[96:99]
    ds_read_b64_tr_b16 v[26:27], v36 offset:16896
    v_mfma_f32_16x16x32_bf16 v[72:75], v[16:19], a[108:111], v[72:75]
    v_mfma_f32_16x16x32_bf16 v[104:107], v[20:23], a[108:111], v[104:107]
    v_mfma_f32_16x16x32_bf16 v[80:83], v[16:19], a[248:251], v[80:83]
    v_mfma_f32_16x16x32_bf16 v[112:115], v[20:23], a[248:251], v[112:115]
    v_mfma_f32_16x16x32_bf16 v[88:91], v[16:19], a[252:255], v[88:91]
    v_mfma_f32_16x16x32_bf16 v[120:123], v[20:23], a[252:255], v[120:123]
    s_waitcnt lgkmcnt(2)
    v_mfma_f32_16x16x32_bf16 v[132:135], v[56:59], a[40:43], v[132:135]
    ds_read_b64_tr_b16 v[28:29], v37 offset:16384
    v_mfma_f32_16x16x32_bf16 v[164:167], v[60:63], a[40:43], v[164:167]
    ds_read_b64_tr_b16 v[30:31], v37 offset:16896
    v_mfma_f32_16x16x32_bf16 v[140:143], v[56:59], a[44:47], v[140:143]
    v_mfma_f32_16x16x32_bf16 v[172:175], v[60:63], a[44:47], v[172:175]
    v_mfma_f32_16x16x32_bf16 v[148:151], v[56:59], a[184:187], v[148:151]
    v_mfma_f32_16x16x32_bf16 v[180:183], v[60:63], a[184:187], v[180:183]
    v_mfma_f32_16x16x32_bf16 v[156:159], v[56:59], a[188:191], v[156:159]
    v_mfma_f32_16x16x32_bf16 v[188:191], v[60:63], a[188:191], v[188:191]
    s_waitcnt lgkmcnt(0)
    s_barrier
    v_mfma_f32_16x16x32_bf16 v[68:71], v[24:27], a[104:107], v[68:71]
    ds_read_b64_tr_b16 v[16:17], v12 offset:20480
    v_mfma_f32_16x16x32_bf16 v[100:103], v[28:31], a[104:107], v[100:103]
    ds_read_b64_tr_b16 v[18:19], v12 offset:20992
    v_mfma_f32_16x16x32_bf16 v[76:79], v[24:27], a[108:111], v[76:79]
    ds_read_b64_tr_b16 v[20:21], v13 offset:20480
    v_mfma_f32_16x16x32_bf16 v[108:111], v[28:31], a[108:111], v[108:111]
    ds_read_b64_tr_b16 v[22:23], v13 offset:20992
    v_mfma_f32_16x16x32_bf16 v[84:87], v[24:27], a[248:251], v[84:87]
    v_mfma_f32_16x16x32_bf16 v[116:119], v[28:31], a[248:251], v[116:119]
    v_mfma_f32_16x16x32_bf16 v[92:95], v[24:27], a[252:255], v[92:95]
    v_mfma_f32_16x16x32_bf16 v[124:127], v[28:31], a[252:255], v[124:127]
    s_waitcnt lgkmcnt(0)
    s_waitcnt vmcnt(15)
    v_mfma_f32_16x16x32_bf16 v[64:67], v[16:19], a[112:115], v[64:67]
    ds_read_b64_tr_b16 v[24:25], v36 offset:20480
    v_mfma_f32_16x16x32_bf16 v[96:99], v[20:23], a[112:115], v[96:99]
    ds_read_b64_tr_b16 v[26:27], v36 offset:20992
    v_mfma_f32_16x16x32_bf16 v[72:75], v[16:19], a[116:119], v[72:75]
    ds_read_b64_tr_b16 v[28:29], v37 offset:20480
    v_mfma_f32_16x16x32_bf16 v[104:107], v[20:23], a[116:119], v[104:107]
    ds_read_b64_tr_b16 v[30:31], v37 offset:20992
    v_mfma_f32_16x16x32_bf16 v[80:83], v[16:19], v[192:195], v[80:83]
    ds_read_b64_tr_b16 v[48:49], v14 offset:24576
    v_mfma_f32_16x16x32_bf16 v[112:115], v[20:23], v[192:195], v[112:115]
    ds_read_b64_tr_b16 v[50:51], v14 offset:25088
    v_mfma_f32_16x16x32_bf16 v[88:91], v[16:19], v[196:199], v[88:91]
    ds_read_b64_tr_b16 v[52:53], v15 offset:24576
    v_mfma_f32_16x16x32_bf16 v[120:123], v[20:23], v[196:199], v[120:123]
    ds_read_b64_tr_b16 v[54:55], v15 offset:25088
    s_waitcnt lgkmcnt(4)
    v_mfma_f32_16x16x32_bf16 v[68:71], v[24:27], a[112:115], v[68:71]
    ds_read_b64_tr_b16 v[16:17], v12 offset:24576
    v_mfma_f32_16x16x32_bf16 v[100:103], v[28:31], a[112:115], v[100:103]
    ds_read_b64_tr_b16 v[18:19], v12 offset:25088
    v_mfma_f32_16x16x32_bf16 v[76:79], v[24:27], a[116:119], v[76:79]
    v_mfma_f32_16x16x32_bf16 v[108:111], v[28:31], a[116:119], v[108:111]
    v_mfma_f32_16x16x32_bf16 v[84:87], v[24:27], v[192:195], v[84:87]
    v_mfma_f32_16x16x32_bf16 v[116:119], v[28:31], v[192:195], v[116:119]
    v_mfma_f32_16x16x32_bf16 v[92:95], v[24:27], v[196:199], v[92:95]
    v_mfma_f32_16x16x32_bf16 v[124:127], v[28:31], v[196:199], v[124:127]
    s_waitcnt lgkmcnt(2)
    v_mfma_f32_16x16x32_bf16 v[128:131], v[48:51], a[48:51], v[128:131]
    ds_read_b64_tr_b16 v[20:21], v13 offset:24576
    v_mfma_f32_16x16x32_bf16 v[160:163], v[52:55], a[48:51], v[160:163]
    ds_read_b64_tr_b16 v[22:23], v13 offset:25088
    v_mfma_f32_16x16x32_bf16 v[136:139], v[48:51], a[52:55], v[136:139]
    v_mfma_f32_16x16x32_bf16 v[168:171], v[52:55], a[52:55], v[168:171]
    v_mfma_f32_16x16x32_bf16 v[144:147], v[48:51], a[192:195], v[144:147]
    v_mfma_f32_16x16x32_bf16 v[176:179], v[52:55], a[192:195], v[176:179]
    v_mfma_f32_16x16x32_bf16 v[152:155], v[48:51], a[196:199], v[152:155]
    v_mfma_f32_16x16x32_bf16 v[184:187], v[52:55], a[196:199], v[184:187]
    s_waitcnt lgkmcnt(0)
    s_waitcnt vmcnt(11)
    v_mfma_f32_16x16x32_bf16 v[64:67], v[16:19], a[120:123], v[64:67]
    ds_read_b64_tr_b16 v[24:25], v36 offset:24576
    v_mfma_f32_16x16x32_bf16 v[96:99], v[20:23], a[120:123], v[96:99]
    ds_read_b64_tr_b16 v[26:27], v36 offset:25088
    v_mfma_f32_16x16x32_bf16 v[72:75], v[16:19], a[124:127], v[72:75]
    ds_read_b64_tr_b16 v[28:29], v37 offset:24576
    v_mfma_f32_16x16x32_bf16 v[104:107], v[20:23], a[124:127], v[104:107]
    ds_read_b64_tr_b16 v[30:31], v37 offset:25088
    v_mfma_f32_16x16x32_bf16 v[80:83], v[16:19], v[200:203], v[80:83]
    ds_read_b64_tr_b16 v[56:57], v38 offset:24576
    v_mfma_f32_16x16x32_bf16 v[112:115], v[20:23], v[200:203], v[112:115]
    ds_read_b64_tr_b16 v[58:59], v38 offset:25088
    v_mfma_f32_16x16x32_bf16 v[88:91], v[16:19], v[204:207], v[88:91]
    ds_read_b64_tr_b16 v[60:61], v39 offset:24576
    v_mfma_f32_16x16x32_bf16 v[120:123], v[20:23], v[204:207], v[120:123]
    ds_read_b64_tr_b16 v[62:63], v39 offset:25088
    s_waitcnt lgkmcnt(4)
    s_barrier
    v_mfma_f32_16x16x32_bf16 v[68:71], v[24:27], a[120:123], v[68:71]
    ds_read_b64_tr_b16 v[16:17], v12 offset:28672
    v_mfma_f32_16x16x32_bf16 v[100:103], v[28:31], a[120:123], v[100:103]
    ds_read_b64_tr_b16 v[18:19], v12 offset:29184
    v_mfma_f32_16x16x32_bf16 v[76:79], v[24:27], a[124:127], v[76:79]
    v_mfma_f32_16x16x32_bf16 v[108:111], v[28:31], a[124:127], v[108:111]
    v_mfma_f32_16x16x32_bf16 v[84:87], v[24:27], v[200:203], v[84:87]
    v_mfma_f32_16x16x32_bf16 v[116:119], v[28:31], v[200:203], v[116:119]
    v_mfma_f32_16x16x32_bf16 v[92:95], v[24:27], v[204:207], v[92:95]
    v_mfma_f32_16x16x32_bf16 v[124:127], v[28:31], v[204:207], v[124:127]
    s_waitcnt lgkmcnt(2)
    v_mfma_f32_16x16x32_bf16 v[132:135], v[56:59], a[48:51], v[132:135]
    ds_read_b64_tr_b16 v[20:21], v13 offset:28672
    v_mfma_f32_16x16x32_bf16 v[164:167], v[60:63], a[48:51], v[164:167]
    ds_read_b64_tr_b16 v[22:23], v13 offset:29184
    v_mfma_f32_16x16x32_bf16 v[140:143], v[56:59], a[52:55], v[140:143]
    v_mfma_f32_16x16x32_bf16 v[172:175], v[60:63], a[52:55], v[172:175]
    v_mfma_f32_16x16x32_bf16 v[148:151], v[56:59], a[192:195], v[148:151]
    v_mfma_f32_16x16x32_bf16 v[180:183], v[60:63], a[192:195], v[180:183]
    v_mfma_f32_16x16x32_bf16 v[156:159], v[56:59], a[196:199], v[156:159]
    v_mfma_f32_16x16x32_bf16 v[188:191], v[60:63], a[196:199], v[188:191]
    s_waitcnt lgkmcnt(0)
    s_waitcnt vmcnt(6)
    v_mfma_f32_16x16x32_bf16 v[64:67], v[16:19], a[128:131], v[64:67]
    ds_read_b64_tr_b16 v[24:25], v36 offset:28672
    v_mfma_f32_16x16x32_bf16 v[96:99], v[20:23], a[128:131], v[96:99]
    ds_read_b64_tr_b16 v[26:27], v36 offset:29184
    v_mfma_f32_16x16x32_bf16 v[72:75], v[16:19], a[132:135], v[72:75]
    ds_read_b64_tr_b16 v[28:29], v37 offset:28672
    v_mfma_f32_16x16x32_bf16 v[104:107], v[20:23], a[132:135], v[104:107]
    ds_read_b64_tr_b16 v[30:31], v37 offset:29184
    v_mfma_f32_16x16x32_bf16 v[80:83], v[16:19], v[208:211], v[80:83]
    ds_read_b64_tr_b16 v[48:49], v14 offset:28672
    v_mfma_f32_16x16x32_bf16 v[112:115], v[20:23], v[208:211], v[112:115]
    ds_read_b64_tr_b16 v[50:51], v14 offset:29184
    v_mfma_f32_16x16x32_bf16 v[88:91], v[16:19], v[212:215], v[88:91]
    ds_read_b64_tr_b16 v[52:53], v15 offset:28672
    v_mfma_f32_16x16x32_bf16 v[120:123], v[20:23], v[212:215], v[120:123]
    ds_read_b64_tr_b16 v[54:55], v15 offset:29184
    s_waitcnt lgkmcnt(4)
    v_mfma_f32_16x16x32_bf16 v[68:71], v[24:27], a[128:131], v[68:71]
    ds_read_b64_tr_b16 v[16:17], v12 offset:32768
    v_mfma_f32_16x16x32_bf16 v[100:103], v[28:31], a[128:131], v[100:103]
    ds_read_b64_tr_b16 v[18:19], v12 offset:33280
    v_mfma_f32_16x16x32_bf16 v[76:79], v[24:27], a[132:135], v[76:79]
    v_mfma_f32_16x16x32_bf16 v[108:111], v[28:31], a[132:135], v[108:111]
    v_mfma_f32_16x16x32_bf16 v[84:87], v[24:27], v[208:211], v[84:87]
    v_mfma_f32_16x16x32_bf16 v[116:119], v[28:31], v[208:211], v[116:119]
    v_mfma_f32_16x16x32_bf16 v[92:95], v[24:27], v[212:215], v[92:95]
    v_mfma_f32_16x16x32_bf16 v[124:127], v[28:31], v[212:215], v[124:127]
    s_waitcnt lgkmcnt(2)
    v_mfma_f32_16x16x32_bf16 v[128:131], v[48:51], a[56:59], v[128:131]
    ds_read_b64_tr_b16 v[20:21], v13 offset:32768
    v_mfma_f32_16x16x32_bf16 v[160:163], v[52:55], a[56:59], v[160:163]
    ds_read_b64_tr_b16 v[22:23], v13 offset:33280
    v_mfma_f32_16x16x32_bf16 v[136:139], v[48:51], a[60:63], v[136:139]
    v_mfma_f32_16x16x32_bf16 v[168:171], v[52:55], a[60:63], v[168:171]
    v_mfma_f32_16x16x32_bf16 v[144:147], v[48:51], a[200:203], v[144:147]
    v_mfma_f32_16x16x32_bf16 v[176:179], v[52:55], a[200:203], v[176:179]
    v_mfma_f32_16x16x32_bf16 v[152:155], v[48:51], a[204:207], v[152:155]
    v_mfma_f32_16x16x32_bf16 v[184:187], v[52:55], a[204:207], v[184:187]
    s_waitcnt lgkmcnt(0)
    s_waitcnt vmcnt(2)
    v_mfma_f32_16x16x32_bf16 v[64:67], v[16:19], a[136:139], v[64:67]
    ds_read_b64_tr_b16 v[24:25], v36 offset:32768
    v_mfma_f32_16x16x32_bf16 v[96:99], v[20:23], a[136:139], v[96:99]
    ds_read_b64_tr_b16 v[26:27], v36 offset:33280
    v_mfma_f32_16x16x32_bf16 v[72:75], v[16:19], a[140:143], v[72:75]
    ds_read_b64_tr_b16 v[28:29], v37 offset:32768
    v_mfma_f32_16x16x32_bf16 v[104:107], v[20:23], a[140:143], v[104:107]
    ds_read_b64_tr_b16 v[30:31], v37 offset:33280
    v_mfma_f32_16x16x32_bf16 v[80:83], v[16:19], v[216:219], v[80:83]
    ds_read_b64_tr_b16 v[56:57], v38 offset:28672
    v_mfma_f32_16x16x32_bf16 v[112:115], v[20:23], v[216:219], v[112:115]
    ds_read_b64_tr_b16 v[58:59], v38 offset:29184
    v_mfma_f32_16x16x32_bf16 v[88:91], v[16:19], v[220:223], v[88:91]
    ds_read_b64_tr_b16 v[60:61], v39 offset:28672
    v_mfma_f32_16x16x32_bf16 v[120:123], v[20:23], v[220:223], v[120:123]
    ds_read_b64_tr_b16 v[62:63], v39 offset:29184
    s_waitcnt lgkmcnt(4)
    s_barrier
    v_mfma_f32_16x16x32_bf16 v[68:71], v[24:27], a[136:139], v[68:71]
    ds_read_b64_tr_b16 v[48:49], v14 offset:32768
    v_mfma_f32_16x16x32_bf16 v[100:103], v[28:31], a[136:139], v[100:103]
    ds_read_b64_tr_b16 v[50:51], v14 offset:33280
    v_mfma_f32_16x16x32_bf16 v[76:79], v[24:27], a[140:143], v[76:79]
    v_mfma_f32_16x16x32_bf16 v[108:111], v[28:31], a[140:143], v[108:111]
    v_mfma_f32_16x16x32_bf16 v[84:87], v[24:27], v[216:219], v[84:87]
    v_mfma_f32_16x16x32_bf16 v[116:119], v[28:31], v[216:219], v[116:119]
    v_mfma_f32_16x16x32_bf16 v[92:95], v[24:27], v[220:223], v[92:95]
    v_mfma_f32_16x16x32_bf16 v[124:127], v[28:31], v[220:223], v[124:127]
    s_waitcnt lgkmcnt(2)
    v_mfma_f32_16x16x32_bf16 v[132:135], v[56:59], a[56:59], v[132:135]
    ds_read_b64_tr_b16 v[52:53], v15 offset:32768
    v_mfma_f32_16x16x32_bf16 v[164:167], v[60:63], a[56:59], v[164:167]
    ds_read_b64_tr_b16 v[54:55], v15 offset:33280
    v_mfma_f32_16x16x32_bf16 v[140:143], v[56:59], a[60:63], v[140:143]
    v_mfma_f32_16x16x32_bf16 v[172:175], v[60:63], a[60:63], v[172:175]
    v_mfma_f32_16x16x32_bf16 v[148:151], v[56:59], a[200:203], v[148:151]
    v_mfma_f32_16x16x32_bf16 v[180:183], v[60:63], a[200:203], v[180:183]
    v_mfma_f32_16x16x32_bf16 v[156:159], v[56:59], a[204:207], v[156:159]
    v_mfma_f32_16x16x32_bf16 v[188:191], v[60:63], a[204:207], v[188:191]
    s_waitcnt lgkmcnt(0)
    v_mfma_f32_16x16x32_bf16 v[128:131], v[48:51], a[64:67], v[128:131]
    s_add_u32 m0, s38, 0
    ds_read_b64_tr_b16 v[56:57], v38 offset:32768
    v_mfma_f32_16x16x32_bf16 v[160:163], v[52:55], a[64:67], v[160:163]
    s_add_u32 s35, s52, 0
    ds_read_b64_tr_b16 v[58:59], v38 offset:33280
    buffer_load_dwordx4 v6, s[84:87], s35 offen lds
    v_mfma_f32_16x16x32_bf16 v[136:139], v[48:51], a[68:71], v[136:139]
    ds_read_b64_tr_b16 v[60:61], v39 offset:32768
    v_mfma_f32_16x16x32_bf16 v[168:171], v[52:55], a[68:71], v[168:171]
    ds_read_b64_tr_b16 v[62:63], v39 offset:33280
    v_mfma_f32_16x16x32_bf16 v[144:147], v[48:51], a[208:211], v[144:147]
    s_add_u32 m0, s38, 36864
    v_cvt_pk_bf16_f32 v20, 0, v64
    v_cvt_pk_bf16_f32 v21, 0, v65
    v_mfma_f32_16x16x32_bf16 v[176:179], v[52:55], a[208:211], v[176:179]
    s_add_u32 s35, s52, 0
    buffer_load_dwordx4 v6, s[88:91], s35 offen lds
    v_mul_f32 v16, v20, v20
    v_mul_f32 v17, v21, v21
    v_mfma_f32_16x16x32_bf16 v[152:155], v[48:51], a[212:215], v[152:155]
    v_fma_f32 v16, v16, v11, v10
    v_fma_f32 v17, v17, v11, v10
    v_mul_f32 v16, v16, v20
    v_mfma_f32_16x16x32_bf16 v[184:187], v[52:55], a[212:215], v[184:187]
    s_waitcnt lgkmcnt(0)
    v_mul_f32 v17, v17, v21
    v_cvt_pk_bf16_f32 v18, 0, v96
    v_cvt_pk_bf16_f32 v19, 0, v97
    s_barrier
    v_add_u32 v14, 73728, v14
    v_add_u32 v38, 73728, v38
    v_add_u32 v15, 73728, v15
    v_add_u32 v39, 73728, v39
    v_mfma_f32_16x16x32_bf16 v[132:135], v[56:59], a[64:67], v[132:135]
    s_add_u32 m0, s38, 4096
    ds_read_b64_tr_b16 v[48:49], v14 offset:0
    v_exp_f32 v16, v16
    v_exp_f32 v17, v17
    v_mfma_f32_16x16x32_bf16 v[164:167], v[60:63], a[64:67], v[164:167]
    s_add_u32 s35, s52, 589824
    ds_read_b64_tr_b16 v[50:51], v14 offset:512
    buffer_load_dwordx4 v6, s[84:87], s35 offen lds
    v_add_f32 v16, 1.0, v16
    v_add_f32 v17, 1.0, v17
    v_mfma_f32_16x16x32_bf16 v[140:143], v[56:59], a[68:71], v[140:143]
    ds_read_b64_tr_b16 v[52:53], v15 offset:0
    v_cvt_pk_bf16_f32 v28, 0, v66
    v_cvt_pk_bf16_f32 v29, 0, v67
    v_mul_f32 v24, v28, v28
    v_mfma_f32_16x16x32_bf16 v[172:175], v[60:63], a[68:71], v[172:175]
    ds_read_b64_tr_b16 v[54:55], v15 offset:512
    v_mul_f32 v25, v29, v29
    v_fma_f32 v24, v24, v11, v10
    v_mfma_f32_16x16x32_bf16 v[148:151], v[56:59], a[208:211], v[148:151]
    s_add_u32 m0, s38, 40960
    v_rcp_f32 v16, v16
    v_fma_f32 v25, v25, v11, v10
    v_mfma_f32_16x16x32_bf16 v[180:183], v[60:63], a[208:211], v[180:183]
    s_add_u32 s35, s52, 589824
    buffer_load_dwordx4 v6, s[88:91], s35 offen lds
    v_mul_f32 v16, v16, v20
    v_cvt_pk_bf16_f32 v16, 0, v16
    v_mul_f32 v16, v16, v18
    v_mfma_f32_16x16x32_bf16 v[156:159], v[56:59], a[212:215], v[156:159]
    v_rcp_f32 v17, v17
    v_mul_f32 v24, v24, v28
    v_mfma_f32_16x16x32_bf16 v[188:191], v[60:63], a[212:215], v[188:191]
    s_waitcnt lgkmcnt(0)
    v_mul_f32 v17, v17, v21
    v_cvt_pk_bf16_f32 v17, 0, v17
    v_mul_f32 v17, v17, v19
    v_mfma_f32_16x16x32_bf16 v[128:131], v[48:51], a[72:75], v[128:131]
    s_add_u32 m0, s38, 8192
    ds_read_b64_tr_b16 v[56:57], v38 offset:0
    v_cvt_pk_bf16_f32 v40, v16, v17
    v_mul_f32 v25, v25, v29
    v_cvt_pk_bf16_f32 v26, 0, v98
    v_mfma_f32_16x16x32_bf16 v[160:163], v[52:55], a[72:75], v[160:163]
    s_add_u32 s35, s52, 1179648
    ds_read_b64_tr_b16 v[58:59], v38 offset:512
    buffer_load_dwordx4 v6, s[84:87], s35 offen lds
    v_cvt_pk_bf16_f32 v27, 0, v99
    v_exp_f32 v24, v24
    v_mfma_f32_16x16x32_bf16 v[136:139], v[48:51], a[76:79], v[136:139]
    ds_read_b64_tr_b16 v[60:61], v39 offset:0
    v_add_f32 v24, 1.0, v24
    v_cvt_pk_bf16_f32 v20, 0, v68
    v_cvt_pk_bf16_f32 v21, 0, v69
    v_mfma_f32_16x16x32_bf16 v[168:171], v[52:55], a[76:79], v[168:171]
    ds_read_b64_tr_b16 v[62:63], v39 offset:512
    v_mul_f32 v16, v20, v20
    v_mul_f32 v17, v21, v21
    v_mfma_f32_16x16x32_bf16 v[144:147], v[48:51], a[216:219], v[144:147]
    s_add_u32 m0, s38, 45056
    v_exp_f32 v25, v25
    v_fma_f32 v16, v16, v11, v10
    v_mfma_f32_16x16x32_bf16 v[176:179], v[52:55], a[216:219], v[176:179]
    s_add_u32 s35, s52, 1179648
    buffer_load_dwordx4 v6, s[88:91], s35 offen lds
    v_add_f32 v25, 1.0, v25
    v_fma_f32 v17, v17, v11, v10
    v_mul_f32 v16, v16, v20
    v_mfma_f32_16x16x32_bf16 v[152:155], v[48:51], a[220:223], v[152:155]
    v_rcp_f32 v24, v24
    v_mul_f32 v17, v17, v21
    v_mfma_f32_16x16x32_bf16 v[184:187], v[52:55], a[220:223], v[184:187]
    s_waitcnt lgkmcnt(0)
    v_rcp_f32 v25, v25
    v_mul_f32 v24, v24, v28
    s_barrier
    v_mfma_f32_16x16x32_bf16 v[132:135], v[56:59], a[72:75], v[132:135]
    s_add_u32 m0, s38, 12288
    ds_read_b64_tr_b16 v[48:49], v14 offset:4096
    v_mul_f32 v25, v25, v29
    v_cvt_pk_bf16_f32 v24, 0, v24
    v_cvt_pk_bf16_f32 v25, 0, v25
    v_mfma_f32_16x16x32_bf16 v[164:167], v[60:63], a[72:75], v[164:167]
    s_add_u32 s35, s52, 1769472
    ds_read_b64_tr_b16 v[50:51], v14 offset:4608
    buffer_load_dwordx4 v6, s[84:87], s35 offen lds
    v_mul_f32 v24, v24, v26
    v_mul_f32 v25, v25, v27
    v_cvt_pk_bf16_f32 v41, v24, v25
    v_mfma_f32_16x16x32_bf16 v[140:143], v[56:59], a[76:79], v[140:143]
    ds_read_b64_tr_b16 v[52:53], v15 offset:4096
    v_cvt_pk_bf16_f32 v18, 0, v100
    v_cvt_pk_bf16_f32 v19, 0, v101
    v_exp_f32 v16, v16
    v_mfma_f32_16x16x32_bf16 v[172:175], v[60:63], a[76:79], v[172:175]
    ds_read_b64_tr_b16 v[54:55], v15 offset:4608
    v_add_f32 v16, 1.0, v16
    v_mfma_f32_16x16x32_bf16 v[148:151], v[56:59], a[216:219], v[148:151]
    s_add_u32 m0, s38, 49152
    v_exp_f32 v17, v17
    v_cvt_pk_bf16_f32 v28, 0, v70
    v_mfma_f32_16x16x32_bf16 v[180:183], v[60:63], a[216:219], v[180:183]
    s_add_u32 s35, s52, 1769472
    buffer_load_dwordx4 v6, s[88:91], s35 offen lds
    v_add_f32 v17, 1.0, v17
    v_cvt_pk_bf16_f32 v29, 0, v71
    v_mul_f32 v24, v28, v28
    v_mfma_f32_16x16x32_bf16 v[156:159], v[56:59], a[220:223], v[156:159]
    v_rcp_f32 v16, v16
    v_mul_f32 v25, v29, v29
    v_mfma_f32_16x16x32_bf16 v[188:191], v[60:63], a[220:223], v[188:191]
    s_waitcnt lgkmcnt(0)
    v_rcp_f32 v17, v17
    v_mul_f32 v16, v16, v20
    v_mfma_f32_16x16x32_bf16 v[128:131], v[48:51], a[80:83], v[128:131]
    s_add_u32 m0, s38, 16384
    ds_read_b64_tr_b16 v[56:57], v38 offset:4096
    v_mul_f32 v17, v17, v21
    v_cvt_pk_bf16_f32 v16, 0, v16
    v_cvt_pk_bf16_f32 v17, 0, v17
    v_mfma_f32_16x16x32_bf16 v[160:163], v[52:55], a[80:83], v[160:163]
    s_add_u32 s35, s52, 2359296
    ds_read_b64_tr_b16 v[58:59], v38 offset:4608
    buffer_load_dwordx4 v6, s[84:87], s35 offen lds
    v_mul_f32 v16, v16, v18
    v_mul_f32 v17, v17, v19
    v_cvt_pk_bf16_f32 v42, v16, v17
    v_mfma_f32_16x16x32_bf16 v[136:139], v[48:51], a[84:87], v[136:139]
    ds_read_b64_tr_b16 v[60:61], v39 offset:4096
    v_fma_f32 v24, v24, v11, v10
    v_fma_f32 v25, v25, v11, v10
    v_mul_f32 v24, v24, v28
    v_mfma_f32_16x16x32_bf16 v[168:171], v[52:55], a[84:87], v[168:171]
    ds_read_b64_tr_b16 v[62:63], v39 offset:4608
    v_mul_f32 v25, v25, v29
    v_cvt_pk_bf16_f32 v26, 0, v102
    v_mfma_f32_16x16x32_bf16 v[144:147], v[48:51], a[224:227], v[144:147]
    s_add_u32 m0, s38, 53248
    v_exp_f32 v24, v24
    v_cvt_pk_bf16_f32 v27, 0, v103
    v_mfma_f32_16x16x32_bf16 v[176:179], v[52:55], a[224:227], v[176:179]
    s_add_u32 s35, s52, 2359296
    buffer_load_dwordx4 v6, s[88:91], s35 offen lds
    v_add_f32 v24, 1.0, v24
    v_exp_f32 v25, v25
    v_mfma_f32_16x16x32_bf16 v[152:155], v[48:51], a[228:231], v[152:155]
    v_add_f32 v25, 1.0, v25
    v_cvt_pk_bf16_f32 v20, 0, v72
    v_cvt_pk_bf16_f32 v21, 0, v73
    v_mfma_f32_16x16x32_bf16 v[184:187], v[52:55], a[228:231], v[184:187]
    s_waitcnt lgkmcnt(0)
    v_rcp_f32 v24, v24
    v_mul_f32 v16, v20, v20
    s_barrier
    v_mfma_f32_16x16x32_bf16 v[132:135], v[56:59], a[80:83], v[132:135]
    s_add_u32 m0, s38, 20480
    ds_read_b64_tr_b16 v[48:49], v14 offset:8192
    v_mul_f32 v24, v24, v28
    v_cvt_pk_bf16_f32 v24, 0, v24
    v_mul_f32 v24, v24, v26
    v_mfma_f32_16x16x32_bf16 v[164:167], v[60:63], a[80:83], v[164:167]
    s_add_u32 s35, s52, 2949120
    ds_read_b64_tr_b16 v[50:51], v14 offset:8704
    buffer_load_dwordx4 v6, s[84:87], s35 offen lds
    v_mul_f32 v17, v21, v21
    v_fma_f32 v16, v16, v11, v10
    v_fma_f32 v17, v17, v11, v10
    v_mfma_f32_16x16x32_bf16 v[140:143], v[56:59], a[84:87], v[140:143]
    ds_read_b64_tr_b16 v[52:53], v15 offset:8192
    v_mul_f32 v16, v16, v20
    v_mul_f32 v17, v17, v21
    v_cvt_pk_bf16_f32 v18, 0, v104
    v_mfma_f32_16x16x32_bf16 v[172:175], v[60:63], a[84:87], v[172:175]
    ds_read_b64_tr_b16 v[54:55], v15 offset:8704
    v_rcp_f32 v25, v25
    v_mfma_f32_16x16x32_bf16 v[148:151], v[56:59], a[224:227], v[148:151]
    s_add_u32 m0, s38, 57344
    v_mul_f32 v25, v25, v29
    v_cvt_pk_bf16_f32 v25, 0, v25
    v_mul_f32 v25, v25, v27
    v_mfma_f32_16x16x32_bf16 v[180:183], v[60:63], a[224:227], v[180:183]
    s_add_u32 s35, s52, 2949120
    buffer_load_dwordx4 v6, s[88:91], s35 offen lds
    v_cvt_pk_bf16_f32 v43, v24, v25
    v_cvt_pk_bf16_f32 v19, 0, v105
    v_exp_f32 v16, v16
    v_mfma_f32_16x16x32_bf16 v[156:159], v[56:59], a[228:231], v[156:159]
    buffer_store_dwordx4 v[40:43], v7, s[20:23], s39 offen offset:0 sc0 sc1
    v_add_f32 v16, 1.0, v16
    v_mfma_f32_16x16x32_bf16 v[188:191], v[60:63], a[228:231], v[188:191]
    s_waitcnt lgkmcnt(0)
    v_exp_f32 v17, v17
    v_cvt_pk_bf16_f32 v28, 0, v74
    v_mfma_f32_16x16x32_bf16 v[128:131], v[48:51], a[88:91], v[128:131]
    s_add_u32 m0, s38, 24576
    ds_read_b64_tr_b16 v[56:57], v38 offset:8192
    v_add_f32 v17, 1.0, v17
    v_cvt_pk_bf16_f32 v29, 0, v75
    v_mul_f32 v24, v28, v28
    v_mfma_f32_16x16x32_bf16 v[160:163], v[52:55], a[88:91], v[160:163]
    s_add_u32 s35, s52, 3538944
    ds_read_b64_tr_b16 v[58:59], v38 offset:8704
    buffer_load_dwordx4 v6, s[84:87], s35 offen lds
    v_mul_f32 v25, v29, v29
    v_fma_f32 v24, v24, v11, v10
    v_fma_f32 v25, v25, v11, v10
    v_mfma_f32_16x16x32_bf16 v[136:139], v[48:51], a[92:95], v[136:139]
    ds_read_b64_tr_b16 v[60:61], v39 offset:8192
    v_mul_f32 v24, v24, v28
    v_mul_f32 v25, v25, v29
    v_cvt_pk_bf16_f32 v26, 0, v106
    v_mfma_f32_16x16x32_bf16 v[168:171], v[52:55], a[92:95], v[168:171]
    ds_read_b64_tr_b16 v[62:63], v39 offset:8704
    v_rcp_f32 v16, v16
    v_mfma_f32_16x16x32_bf16 v[144:147], v[48:51], a[232:235], v[144:147]
    s_add_u32 m0, s38, 61440
    v_rcp_f32 v17, v17
    v_mul_f32 v16, v16, v20
    v_mfma_f32_16x16x32_bf16 v[176:179], v[52:55], a[232:235], v[176:179]
    s_add_u32 s35, s52, 3538944
    buffer_load_dwordx4 v6, s[88:91], s35 offen lds
    v_mul_f32 v17, v17, v21
    v_cvt_pk_bf16_f32 v16, 0, v16
    v_cvt_pk_bf16_f32 v17, 0, v17
    v_mfma_f32_16x16x32_bf16 v[152:155], v[48:51], a[236:239], v[152:155]
    v_mul_f32 v16, v16, v18
    v_mul_f32 v17, v17, v19
    v_cvt_pk_bf16_f32 v44, v16, v17
    v_mfma_f32_16x16x32_bf16 v[184:187], v[52:55], a[236:239], v[184:187]
    s_waitcnt lgkmcnt(0)
    v_exp_f32 v24, v24
    v_cvt_pk_bf16_f32 v27, 0, v107
    s_barrier
    v_mfma_f32_16x16x32_bf16 v[132:135], v[56:59], a[88:91], v[132:135]
    s_add_u32 m0, s38, 28672
    ds_read_b64_tr_b16 v[48:49], v14 offset:12288
    v_add_f32 v24, 1.0, v24
    v_cvt_pk_bf16_f32 v20, 0, v76
    v_cvt_pk_bf16_f32 v21, 0, v77
    v_mfma_f32_16x16x32_bf16 v[164:167], v[60:63], a[88:91], v[164:167]
    s_add_u32 s35, s52, 4128768
    ds_read_b64_tr_b16 v[50:51], v14 offset:12800
    buffer_load_dwordx4 v6, s[84:87], s35 offen lds
    v_mul_f32 v16, v20, v20
    v_mul_f32 v17, v21, v21
    v_fma_f32 v16, v16, v11, v10
    v_mfma_f32_16x16x32_bf16 v[140:143], v[56:59], a[92:95], v[140:143]
    ds_read_b64_tr_b16 v[52:53], v15 offset:12288
    v_fma_f32 v17, v17, v11, v10
    v_mul_f32 v16, v16, v20
    v_mul_f32 v17, v17, v21
    v_mfma_f32_16x16x32_bf16 v[172:175], v[60:63], a[92:95], v[172:175]
    ds_read_b64_tr_b16 v[54:55], v15 offset:12800
    v_exp_f32 v25, v25
    v_mfma_f32_16x16x32_bf16 v[148:151], v[56:59], a[232:235], v[148:151]
    s_add_u32 m0, s38, 65536
    v_add_f32 v25, 1.0, v25
    v_cvt_pk_bf16_f32 v18, 0, v108
    v_rcp_f32 v24, v24
    v_mfma_f32_16x16x32_bf16 v[180:183], v[60:63], a[232:235], v[180:183]
    s_add_u32 s35, s52, 4128768
    buffer_load_dwordx4 v6, s[88:91], s35 offen lds
    v_mul_f32 v24, v24, v28
    v_cvt_pk_bf16_f32 v24, 0, v24
    v_mfma_f32_16x16x32_bf16 v[156:159], v[56:59], a[236:239], v[156:159]
    v_rcp_f32 v25, v25
    v_mul_f32 v24, v24, v26
    v_mfma_f32_16x16x32_bf16 v[188:191], v[60:63], a[236:239], v[188:191]
    s_waitcnt lgkmcnt(0)
    v_mul_f32 v25, v25, v29
    v_cvt_pk_bf16_f32 v25, 0, v25
    v_mul_f32 v25, v25, v27
    v_mfma_f32_16x16x32_bf16 v[128:131], v[48:51], a[96:99], v[128:131]
    s_add_u32 m0, s38, 32768
    ds_read_b64_tr_b16 v[56:57], v38 offset:12288
    v_cvt_pk_bf16_f32 v45, v24, v25
    v_cvt_pk_bf16_f32 v19, 0, v109
    v_exp_f32 v16, v16
    v_mfma_f32_16x16x32_bf16 v[160:163], v[52:55], a[96:99], v[160:163]
    s_add_u32 s35, s52, 4718592
    ds_read_b64_tr_b16 v[58:59], v38 offset:12800
    buffer_load_dwordx4 v6, s[84:87], s35 offen lds
    v_add_f32 v16, 1.0, v16
    v_cvt_pk_bf16_f32 v28, 0, v78
    v_mfma_f32_16x16x32_bf16 v[136:139], v[48:51], a[100:103], v[136:139]
    ds_read_b64_tr_b16 v[60:61], v39 offset:12288
    v_cvt_pk_bf16_f32 v29, 0, v79
    v_mul_f32 v24, v28, v28
    v_mul_f32 v25, v29, v29
    v_mfma_f32_16x16x32_bf16 v[168:171], v[52:55], a[100:103], v[168:171]
    ds_read_b64_tr_b16 v[62:63], v39 offset:12800
    v_fma_f32 v24, v24, v11, v10
    v_fma_f32 v25, v25, v11, v10
    v_mfma_f32_16x16x32_bf16 v[144:147], v[48:51], a[240:243], v[144:147]
    s_add_u32 m0, s38, 69632
    v_exp_f32 v17, v17
    v_mul_f32 v24, v24, v28
    v_mfma_f32_16x16x32_bf16 v[176:179], v[52:55], a[240:243], v[176:179]
    s_add_u32 s35, s52, 4718592
    buffer_load_dwordx4 v6, s[88:91], s35 offen lds
    v_add_f32 v17, 1.0, v17
    v_mul_f32 v25, v25, v29
    v_cvt_pk_bf16_f32 v26, 0, v110
    v_mfma_f32_16x16x32_bf16 v[152:155], v[48:51], a[244:247], v[152:155]
    v_rcp_f32 v16, v16
    v_rcp_f32 v17, v17
    v_mfma_f32_16x16x32_bf16 v[184:187], v[52:55], a[244:247], v[184:187]
    s_waitcnt lgkmcnt(0)
    v_mul_f32 v16, v16, v20
    v_mul_f32 v17, v17, v21
    v_mfma_f32_16x16x32_bf16 v[132:135], v[56:59], a[96:99], v[132:135]
    ds_read_b64_tr_b16 v[48:49], v14 offset:16384
    v_cvt_pk_bf16_f32 v16, 0, v16
    v_cvt_pk_bf16_f32 v17, 0, v17
    v_mul_f32 v16, v16, v18
    v_mfma_f32_16x16x32_bf16 v[164:167], v[60:63], a[96:99], v[164:167]
    ds_read_b64_tr_b16 v[50:51], v14 offset:16896
    v_mul_f32 v17, v17, v19
    v_cvt_pk_bf16_f32 v46, v16, v17
    v_cvt_pk_bf16_f32 v27, 0, v111
    v_mfma_f32_16x16x32_bf16 v[140:143], v[56:59], a[100:103], v[140:143]
    ds_read_b64_tr_b16 v[52:53], v15 offset:16384
    v_exp_f32 v24, v24
    v_exp_f32 v25, v25
    v_mfma_f32_16x16x32_bf16 v[172:175], v[60:63], a[100:103], v[172:175]
    ds_read_b64_tr_b16 v[54:55], v15 offset:16896
    v_add_f32 v24, 1.0, v24
    v_mfma_f32_16x16x32_bf16 v[148:151], v[56:59], a[240:243], v[148:151]
    v_add_f32 v25, 1.0, v25
    v_cvt_pk_bf16_f32 v20, 0, v80
    v_cvt_pk_bf16_f32 v21, 0, v81
    v_mfma_f32_16x16x32_bf16 v[180:183], v[60:63], a[240:243], v[180:183]
    v_rcp_f32 v24, v24
    v_mul_f32 v16, v20, v20
    v_mfma_f32_16x16x32_bf16 v[156:159], v[56:59], a[244:247], v[156:159]
    v_rcp_f32 v25, v25
    v_mul_f32 v24, v24, v28
    v_mfma_f32_16x16x32_bf16 v[188:191], v[60:63], a[244:247], v[188:191]
    s_waitcnt lgkmcnt(0)
    v_mul_f32 v25, v25, v29
    v_cvt_pk_bf16_f32 v24, 0, v24
    v_cvt_pk_bf16_f32 v25, 0, v25
    s_mov_b32 m0, s9
    s_add_u32 s10, s76, 9216
    buffer_load_dwordx4 v254, s[68:71], s76 offen lds
    s_add_u32 m0, s9, 1024
    s_add_u32 s76, s76, 128
    buffer_load_dwordx4 v254, s[68:71], s10 offen lds
    s_add_u32 s12, s6, 0x03400000
    s_addc_u32 s13, s7, 0
    s_and_b32 s13, s13, 0xffff
    s_mov_b32 s14, 0x005b2000
    s_mov_b32 s15, 0x00020000
    v_mfma_f32_16x16x32_bf16 v[128:131], v[48:51], a[104:107], v[128:131]
    ds_read_b64_tr_b16 v[56:57], v38 offset:16384
    v_mul_f32 v24, v24, v26
    v_mul_f32 v25, v25, v27
    v_cvt_pk_bf16_f32 v47, v24, v25
    v_mfma_f32_16x16x32_bf16 v[160:163], v[52:55], a[104:107], v[160:163]
    ds_read_b64_tr_b16 v[58:59], v38 offset:16896
    v_mul_f32 v17, v21, v21
    v_fma_f32 v16, v16, v11, v10
    v_fma_f32 v17, v17, v11, v10
    v_mfma_f32_16x16x32_bf16 v[136:139], v[48:51], a[108:111], v[136:139]
    ds_read_b64_tr_b16 v[60:61], v39 offset:16384
    v_mul_f32 v16, v16, v20
    v_mul_f32 v17, v17, v21
    v_cvt_pk_bf16_f32 v18, 0, v112
    v_mfma_f32_16x16x32_bf16 v[168:171], v[52:55], a[108:111], v[168:171]
    ds_read_b64_tr_b16 v[62:63], v39 offset:16896
    v_cvt_pk_bf16_f32 v19, 0, v113
    v_exp_f32 v16, v16
    v_mfma_f32_16x16x32_bf16 v[144:147], v[48:51], a[248:251], v[144:147]
    buffer_store_dwordx4 v[44:47], v7, s[20:23], s39 offen offset:1024 sc0 sc1
    v_add_f32 v16, 1.0, v16
    v_mfma_f32_16x16x32_bf16 v[176:179], v[52:55], a[248:251], v[176:179]
    v_exp_f32 v17, v17
    v_cvt_pk_bf16_f32 v28, 0, v82
    v_mfma_f32_16x16x32_bf16 v[152:155], v[48:51], a[252:255], v[152:155]
    v_add_f32 v17, 1.0, v17
    v_cvt_pk_bf16_f32 v29, 0, v83
    v_mul_f32 v24, v28, v28
    v_mfma_f32_16x16x32_bf16 v[184:187], v[52:55], a[252:255], v[184:187]
    s_waitcnt lgkmcnt(0)
    v_rcp_f32 v16, v16
    v_mul_f32 v25, v29, v29
    v_mfma_f32_16x16x32_bf16 v[132:135], v[56:59], a[104:107], v[132:135]
    ds_read_b64_tr_b16 v[48:49], v14 offset:20480
    v_mul_f32 v16, v16, v20
    v_cvt_pk_bf16_f32 v16, 0, v16
    v_mul_f32 v16, v16, v18
    v_mfma_f32_16x16x32_bf16 v[164:167], v[60:63], a[104:107], v[164:167]
    ds_read_b64_tr_b16 v[50:51], v14 offset:20992
    v_fma_f32 v24, v24, v11, v10
    v_fma_f32 v25, v25, v11, v10
    v_mul_f32 v24, v24, v28
    v_mfma_f32_16x16x32_bf16 v[140:143], v[56:59], a[108:111], v[140:143]
    ds_read_b64_tr_b16 v[52:53], v15 offset:20480
    v_mul_f32 v25, v25, v29
    v_cvt_pk_bf16_f32 v26, 0, v114
    v_cvt_pk_bf16_f32 v27, 0, v115
    v_mfma_f32_16x16x32_bf16 v[172:175], v[60:63], a[108:111], v[172:175]
    ds_read_b64_tr_b16 v[54:55], v15 offset:20992
    v_rcp_f32 v17, v17
    v_mfma_f32_16x16x32_bf16 v[148:151], v[56:59], a[248:251], v[148:151]
    v_mul_f32 v17, v17, v21
    v_cvt_pk_bf16_f32 v17, 0, v17
    v_mul_f32 v17, v17, v19
    v_mfma_f32_16x16x32_bf16 v[180:183], v[60:63], a[248:251], v[180:183]
    v_cvt_pk_bf16_f32 v40, v16, v17
    v_exp_f32 v24, v24
    v_mfma_f32_16x16x32_bf16 v[156:159], v[56:59], a[252:255], v[156:159]
    v_exp_f32 v25, v25
    v_add_f32 v24, 1.0, v24
    v_mfma_f32_16x16x32_bf16 v[188:191], v[60:63], a[252:255], v[188:191]
    s_waitcnt lgkmcnt(0)
    v_add_f32 v25, 1.0, v25
    v_cvt_pk_bf16_f32 v20, 0, v84
    v_cvt_pk_bf16_f32 v21, 0, v85
    v_mfma_f32_16x16x32_bf16 v[128:131], v[48:51], a[112:115], v[128:131]
    ds_read_b64_tr_b16 v[56:57], v38 offset:20480
    v_mul_f32 v16, v20, v20
    v_mul_f32 v17, v21, v21
    v_fma_f32 v16, v16, v11, v10
    v_mfma_f32_16x16x32_bf16 v[160:163], v[52:55], a[112:115], v[160:163]
    ds_read_b64_tr_b16 v[58:59], v38 offset:20992
    v_fma_f32 v17, v17, v11, v10
    v_mul_f32 v16, v16, v20
    v_mul_f32 v17, v17, v21
    v_mfma_f32_16x16x32_bf16 v[136:139], v[48:51], a[116:119], v[136:139]
    ds_read_b64_tr_b16 v[60:61], v39 offset:20480
    v_cvt_pk_bf16_f32 v18, 0, v116
    v_rcp_f32 v24, v24
    v_mfma_f32_16x16x32_bf16 v[168:171], v[52:55], a[116:119], v[168:171]
    ds_read_b64_tr_b16 v[62:63], v39 offset:20992
    v_mul_f32 v24, v24, v28
    v_cvt_pk_bf16_f32 v24, 0, v24
    v_mfma_f32_16x16x32_bf16 v[144:147], v[48:51], v[192:195], v[144:147]
    v_rcp_f32 v25, v25
    v_mul_f32 v24, v24, v26
    v_mfma_f32_16x16x32_bf16 v[176:179], v[52:55], v[192:195], v[176:179]
    v_mul_f32 v25, v25, v29
    v_cvt_pk_bf16_f32 v25, 0, v25
    v_mul_f32 v25, v25, v27
    v_mfma_f32_16x16x32_bf16 v[152:155], v[48:51], v[196:199], v[152:155]
    v_cvt_pk_bf16_f32 v41, v24, v25
    v_cvt_pk_bf16_f32 v19, 0, v117
    v_exp_f32 v16, v16
    v_mfma_f32_16x16x32_bf16 v[184:187], v[52:55], v[196:199], v[184:187]
    s_waitcnt lgkmcnt(0)
    v_exp_f32 v17, v17
    v_mfma_f32_16x16x32_bf16 v[132:135], v[56:59], a[112:115], v[132:135]
    ds_read_b64_tr_b16 v[48:49], v14 offset:24576
    v_add_f32 v16, 1.0, v16
    v_add_f32 v17, 1.0, v17
    v_cvt_pk_bf16_f32 v28, 0, v86
    v_mfma_f32_16x16x32_bf16 v[164:167], v[60:63], a[112:115], v[164:167]
    ds_read_b64_tr_b16 v[50:51], v14 offset:25088
    v_cvt_pk_bf16_f32 v29, 0, v87
    v_mul_f32 v24, v28, v28
    v_mul_f32 v25, v29, v29
    v_mfma_f32_16x16x32_bf16 v[140:143], v[56:59], a[116:119], v[140:143]
    ds_read_b64_tr_b16 v[52:53], v15 offset:24576
    v_fma_f32 v24, v24, v11, v10
    v_fma_f32 v25, v25, v11, v10
    v_mul_f32 v24, v24, v28
    v_mfma_f32_16x16x32_bf16 v[172:175], v[60:63], a[116:119], v[172:175]
    ds_read_b64_tr_b16 v[54:55], v15 offset:25088
    v_mul_f32 v25, v25, v29
    v_cvt_pk_bf16_f32 v26, 0, v118
    v_mfma_f32_16x16x32_bf16 v[148:151], v[56:59], v[192:195], v[148:151]
    v_rcp_f32 v16, v16
    v_rcp_f32 v17, v17
    v_mfma_f32_16x16x32_bf16 v[180:183], v[60:63], v[192:195], v[180:183]
    v_mul_f32 v16, v16, v20
    v_mul_f32 v17, v17, v21
    v_mfma_f32_16x16x32_bf16 v[156:159], v[56:59], v[196:199], v[156:159]
    v_cvt_pk_bf16_f32 v16, 0, v16
    v_cvt_pk_bf16_f32 v17, 0, v17
    v_mul_f32 v16, v16, v18
    v_mfma_f32_16x16x32_bf16 v[188:191], v[60:63], v[196:199], v[188:191]
    s_waitcnt lgkmcnt(0)
    v_mul_f32 v17, v17, v19
    v_cvt_pk_bf16_f32 v42, v16, v17
    v_cvt_pk_bf16_f32 v27, 0, v119
    v_mfma_f32_16x16x32_bf16 v[128:131], v[48:51], a[120:123], v[128:131]
    ds_read_b64_tr_b16 v[56:57], v38 offset:24576
    v_exp_f32 v24, v24
    v_exp_f32 v25, v25
    v_mfma_f32_16x16x32_bf16 v[160:163], v[52:55], a[120:123], v[160:163]
    ds_read_b64_tr_b16 v[58:59], v38 offset:25088
    v_add_f32 v24, 1.0, v24
    v_add_f32 v25, 1.0, v25
    v_mfma_f32_16x16x32_bf16 v[136:139], v[48:51], a[124:127], v[136:139]
    ds_read_b64_tr_b16 v[60:61], v39 offset:24576
    v_cvt_pk_bf16_f32 v20, 0, v88
    v_cvt_pk_bf16_f32 v21, 0, v89
    v_mul_f32 v16, v20, v20
    v_mfma_f32_16x16x32_bf16 v[168:171], v[52:55], a[124:127], v[168:171]
    ds_read_b64_tr_b16 v[62:63], v39 offset:25088
    v_mul_f32 v17, v21, v21
    v_fma_f32 v16, v16, v11, v10
    v_mfma_f32_16x16x32_bf16 v[144:147], v[48:51], v[200:203], v[144:147]
    v_rcp_f32 v24, v24
    v_fma_f32 v17, v17, v11, v10
    v_mfma_f32_16x16x32_bf16 v[176:179], v[52:55], v[200:203], v[176:179]
    v_rcp_f32 v25, v25
    v_mul_f32 v24, v24, v28
    v_mfma_f32_16x16x32_bf16 v[152:155], v[48:51], v[204:207], v[152:155]
    v_mul_f32 v25, v25, v29
    v_cvt_pk_bf16_f32 v24, 0, v24
    v_cvt_pk_bf16_f32 v25, 0, v25
    v_mfma_f32_16x16x32_bf16 v[184:187], v[52:55], v[204:207], v[184:187]
    s_waitcnt lgkmcnt(0)
    v_mul_f32 v24, v24, v26
    v_mul_f32 v25, v25, v27
    v_cvt_pk_bf16_f32 v43, v24, v25
    v_mfma_f32_16x16x32_bf16 v[132:135], v[56:59], a[120:123], v[132:135]
    ds_read_b64_tr_b16 v[48:49], v14 offset:28672
    v_mul_f32 v16, v16, v20
    v_mul_f32 v17, v17, v21
    v_cvt_pk_bf16_f32 v18, 0, v120
    v_mfma_f32_16x16x32_bf16 v[164:167], v[60:63], a[120:123], v[164:167]
    ds_read_b64_tr_b16 v[50:51], v14 offset:29184
    v_cvt_pk_bf16_f32 v19, 0, v121
    v_exp_f32 v16, v16
    v_mfma_f32_16x16x32_bf16 v[140:143], v[56:59], a[124:127], v[140:143]
    ds_read_b64_tr_b16 v[52:53], v15 offset:28672
    v_add_f32 v16, 1.0, v16
    v_exp_f32 v17, v17
    v_mfma_f32_16x16x32_bf16 v[172:175], v[60:63], a[124:127], v[172:175]
    ds_read_b64_tr_b16 v[54:55], v15 offset:29184
    v_add_f32 v17, 1.0, v17
    v_cvt_pk_bf16_f32 v28, 0, v90
    v_mfma_f32_16x16x32_bf16 v[148:151], v[56:59], v[200:203], v[148:151]
    buffer_store_dwordx4 v[40:43], v7, s[20:23], s39 offen offset:2048 sc0 sc1
    v_cvt_pk_bf16_f32 v29, 0, v91
    v_mul_f32 v24, v28, v28
    v_mfma_f32_16x16x32_bf16 v[180:183], v[60:63], v[200:203], v[180:183]
    v_rcp_f32 v16, v16
    v_mul_f32 v25, v29, v29
    v_mfma_f32_16x16x32_bf16 v[156:159], v[56:59], v[204:207], v[156:159]
    v_rcp_f32 v17, v17
    v_mul_f32 v16, v16, v20
    v_mfma_f32_16x16x32_bf16 v[188:191], v[60:63], v[204:207], v[188:191]
    s_waitcnt lgkmcnt(0)
    v_mul_f32 v17, v17, v21
    v_cvt_pk_bf16_f32 v16, 0, v16
    v_cvt_pk_bf16_f32 v17, 0, v17
    s_cmp_eq_u32 s30, 5
    s_cselect_b32 s58, s58, 0
    buffer_load_dword v240, v255, s[56:59], s48 offen offset:0
    v_mfma_f32_16x16x32_bf16 v[128:131], v[48:51], a[128:131], v[128:131]
    ds_read_b64_tr_b16 v[56:57], v38 offset:28672
    v_mul_f32 v16, v16, v18
    v_mul_f32 v17, v17, v19
    v_cvt_pk_bf16_f32 v44, v16, v17
    v_mfma_f32_16x16x32_bf16 v[160:163], v[52:55], a[128:131], v[160:163]
    ds_read_b64_tr_b16 v[58:59], v38 offset:29184
    v_fma_f32 v24, v24, v11, v10
    v_fma_f32 v25, v25, v11, v10
    v_mul_f32 v24, v24, v28
    v_mfma_f32_16x16x32_bf16 v[136:139], v[48:51], a[132:135], v[136:139]
    ds_read_b64_tr_b16 v[60:61], v39 offset:28672
    v_mul_f32 v25, v25, v29
    v_cvt_pk_bf16_f32 v26, 0, v122
    v_cvt_pk_bf16_f32 v27, 0, v123
    v_mfma_f32_16x16x32_bf16 v[168:171], v[52:55], a[132:135], v[168:171]
    ds_read_b64_tr_b16 v[62:63], v39 offset:29184
    v_exp_f32 v24, v24
    v_mfma_f32_16x16x32_bf16 v[144:147], v[48:51], v[208:211], v[144:147]
    v_exp_f32 v25, v25
    v_add_f32 v24, 1.0, v24
    v_mfma_f32_16x16x32_bf16 v[176:179], v[52:55], v[208:211], v[176:179]
    v_add_f32 v25, 1.0, v25
    v_cvt_pk_bf16_f32 v20, 0, v92
    v_cvt_pk_bf16_f32 v21, 0, v93
    v_mfma_f32_16x16x32_bf16 v[152:155], v[48:51], v[212:215], v[152:155]
    v_rcp_f32 v24, v24
    v_mul_f32 v16, v20, v20
    v_mfma_f32_16x16x32_bf16 v[184:187], v[52:55], v[212:215], v[184:187]
    s_waitcnt lgkmcnt(0)
    v_rcp_f32 v25, v25
    v_mul_f32 v24, v24, v28
    s_waitcnt vmcnt(6)
    s_barrier
    v_mfma_f32_16x16x32_bf16 v[132:135], v[56:59], a[128:131], v[132:135]
    ds_read_b64_tr_b16 v[48:49], v14 offset:32768
    v_mul_f32 v25, v25, v29
    v_cvt_pk_bf16_f32 v24, 0, v24
    v_cvt_pk_bf16_f32 v25, 0, v25
    v_mfma_f32_16x16x32_bf16 v[164:167], v[60:63], a[128:131], v[164:167]
    ds_read_b64_tr_b16 v[50:51], v14 offset:33280
    v_mul_f32 v24, v24, v26
    v_mul_f32 v25, v25, v27
    v_cvt_pk_bf16_f32 v45, v24, v25
    v_mfma_f32_16x16x32_bf16 v[140:143], v[56:59], a[132:135], v[140:143]
    ds_read_b64_tr_b16 v[52:53], v15 offset:32768
    v_mul_f32 v17, v21, v21
    v_fma_f32 v16, v16, v11, v10
    v_fma_f32 v17, v17, v11, v10
    v_mfma_f32_16x16x32_bf16 v[172:175], v[60:63], a[132:135], v[172:175]
    ds_read_b64_tr_b16 v[54:55], v15 offset:33280
    v_mul_f32 v16, v16, v20
    v_mul_f32 v17, v17, v21
    v_mfma_f32_16x16x32_bf16 v[148:151], v[56:59], v[208:211], v[148:151]
    ds_read_b64_tr_b16 v[224:225], v1 offset:0
    v_cvt_pk_bf16_f32 v18, 0, v124
    v_cvt_pk_bf16_f32 v19, 0, v125
    v_exp_f32 v16, v16
    v_mfma_f32_16x16x32_bf16 v[180:183], v[60:63], v[208:211], v[180:183]
    ds_read_b64_tr_b16 v[226:227], v1 offset:256
    v_add_f32 v16, 1.0, v16
    v_cvt_pk_bf16_f32 v28, 0, v94
    v_mfma_f32_16x16x32_bf16 v[156:159], v[56:59], v[212:215], v[156:159]
    v_exp_f32 v17, v17
    v_cvt_pk_bf16_f32 v29, 0, v95
    v_mfma_f32_16x16x32_bf16 v[188:191], v[60:63], v[212:215], v[188:191]
    s_waitcnt lgkmcnt(2)
    v_add_f32 v17, 1.0, v17
    v_mul_f32 v24, v28, v28
    v_mul_f32 v25, v29, v29
    v_mfma_f32_16x16x32_bf16 v[128:131], v[48:51], a[136:139], v[128:131]
    ds_read_b64_tr_b16 v[56:57], v38 offset:32768
    v_fma_f32 v24, v24, v11, v10
    v_fma_f32 v25, v25, v11, v10
    v_mul_f32 v24, v24, v28
    v_mfma_f32_16x16x32_bf16 v[160:163], v[52:55], a[136:139], v[160:163]
    ds_read_b64_tr_b16 v[58:59], v38 offset:33280
    v_mul_f32 v25, v25, v29
    v_cvt_pk_bf16_f32 v26, 0, v126
    v_rcp_f32 v16, v16
    v_mfma_f32_16x16x32_bf16 v[136:139], v[48:51], a[140:143], v[136:139]
    ds_read_b64_tr_b16 v[60:61], v39 offset:32768
    v_mul_f32 v16, v16, v20
    v_cvt_pk_bf16_f32 v16, 0, v16
    v_mfma_f32_16x16x32_bf16 v[168:171], v[52:55], a[140:143], v[168:171]
    ds_read_b64_tr_b16 v[62:63], v39 offset:33280
    v_mul_f32 v16, v16, v18
    v_cvt_pk_bf16_f32 v27, 0, v127
    v_mfma_f32_16x16x32_bf16 v[144:147], v[48:51], v[216:219], v[144:147]
    ds_read_b64_tr_b16 v[228:229], v32 offset:0
    v_rcp_f32 v17, v17
    v_exp_f32 v24, v24
    v_mfma_f32_16x16x32_bf16 v[176:179], v[52:55], v[216:219], v[176:179]
    ds_read_b64_tr_b16 v[230:231], v32 offset:256
    v_mul_f32 v17, v17, v21
    v_cvt_pk_bf16_f32 v17, 0, v17
    v_mfma_f32_16x16x32_bf16 v[152:155], v[48:51], v[220:223], v[152:155]
    v_mul_f32 v17, v17, v19
    v_cvt_pk_bf16_f32 v46, v16, v17
    v_add_f32 v24, 1.0, v24
    v_mfma_f32_16x16x32_bf16 v[184:187], v[52:55], v[220:223], v[184:187]
    s_waitcnt lgkmcnt(2)
    v_exp_f32 v25, v25
    v_rcp_f32 v24, v24
    v_mfma_f32_16x16x32_bf16 v[132:135], v[56:59], a[136:139], v[132:135]
    ds_read_b64_tr_b16 v[232:233], v1 offset:2048
    v_add_f32 v25, 1.0, v25
    v_mul_f32 v24, v24, v28
    v_mfma_f32_16x16x32_bf16 v[164:167], v[60:63], a[136:139], v[164:167]
    ds_read_b64_tr_b16 v[234:235], v1 offset:2304
    v_cvt_pk_bf16_f32 v24, 0, v24
    v_mul_f32 v24, v24, v26
    v_rcp_f32 v25, v25
    v_mfma_f32_16x16x32_bf16 v[140:143], v[56:59], a[140:143], v[140:143]
    ds_read_b64_tr_b16 v[236:237], v32 offset:2048
    v_mul_f32 v25, v25, v29
    v_cvt_pk_bf16_f32 v25, 0, v25
    v_mfma_f32_16x16x32_bf16 v[172:175], v[60:63], a[140:143], v[172:175]
    ds_read_b64_tr_b16 v[238:239], v32 offset:2304
    v_mul_f32 v25, v25, v27
    v_cvt_pk_bf16_f32 v47, v24, v25
    v_mfma_f32_16x16x32_bf16 v[148:151], v[56:59], v[216:219], v[148:151]
    buffer_store_dwordx4 v[44:47], v7, s[20:23], s39 offen offset:3072 sc0 sc1
    v_mfma_f32_16x16x32_bf16 v[180:183], v[60:63], v[216:219], v[180:183]
    s_add_u32 s39, s39, 32768
    v_mfma_f32_16x16x32_bf16 v[156:159], v[56:59], v[220:223], v[156:159]
    v_mfma_f32_16x16x32_bf16 v[188:191], v[60:63], v[220:223], v[188:191]
    s_barrier
L_k1_abody:
    s_waitcnt lgkmcnt(4)
    v_mfma_f32_16x16x32_bf16 v[64:67], v[224:227], a[0:3], 0
    ds_read_b64_tr_b16 v[12:13], v1 offset:4096
    v_mfma_f32_16x16x32_bf16 v[68:71], v[228:231], a[0:3], 0
    s_add_u32 m0, s38, 73728
    v_mfma_f32_16x16x32_bf16 v[72:75], v[224:227], a[4:7], 0
    ds_read_b64_tr_b16 v[14:15], v1 offset:4352
    v_mfma_f32_16x16x32_bf16 v[76:79], v[228:231], a[4:7], 0
    v_mfma_f32_16x16x32_bf16 v[80:83], v[224:227], a[144:147], 0
    ds_read_b64_tr_b16 v[36:37], v32 offset:4096
    v_cvt_pk_bf16_f32 v20, 0, v128
    v_cvt_pk_bf16_f32 v21, 0, v129
    v_mfma_f32_16x16x32_bf16 v[84:87], v[228:231], a[144:147], 0
    v_mul_f32 v16, v20, v20
    v_mul_f32 v17, v21, v21
    v_fma_f32 v16, v16, v11, v10
    v_mfma_f32_16x16x32_bf16 v[88:91], v[224:227], a[148:151], 0
    ds_read_b64_tr_b16 v[38:39], v32 offset:4352
    v_fma_f32 v17, v17, v11, v10
    v_mul_f32 v16, v16, v20
    v_mfma_f32_16x16x32_bf16 v[92:95], v[228:231], a[148:151], 0
    s_waitcnt lgkmcnt(4)
    v_mul_f32 v17, v17, v21
    v_cvt_pk_bf16_f32 v18, 0, v160
    v_cvt_pk_bf16_f32 v19, 0, v161
    v_mfma_f32_16x16x32_bf16 v[64:67], v[232:235], a[8:11], v[64:67]
    ds_read_b64_tr_b16 v[224:225], v1 offset:6144
    v_exp_f32 v16, v16
    v_mfma_f32_16x16x32_bf16 v[68:71], v[236:239], a[8:11], v[68:71]
    buffer_load_dwordx4 v252, s[24:27], s46 offen lds
    v_add_f32 v16, 1.0, v16
    v_cvt_pk_bf16_f32 v28, 0, v130
    v_mfma_f32_16x16x32_bf16 v[72:75], v[232:235], a[12:15], v[72:75]
    s_add_u32 m0, m0, 4096
    ds_read_b64_tr_b16 v[226:227], v1 offset:6400
    v_cvt_pk_bf16_f32 v29, 0, v131
    v_mfma_f32_16x16x32_bf16 v[76:79], v[236:239], a[12:15], v[76:79]
    s_add_u32 s46, s46, s50
    v_exp_f32 v17, v17
    v_mul_f32 v24, v28, v28
    v_mfma_f32_16x16x32_bf16 v[80:83], v[232:235], a[152:155], v[80:83]
    ds_read_b64_tr_b16 v[228:229], v32 offset:6144
    v_add_f32 v17, 1.0, v17
    v_mfma_f32_16x16x32_bf16 v[84:87], v[236:239], a[152:155], v[84:87]
    v_rcp_f32 v16, v16
    v_mfma_f32_16x16x32_bf16 v[88:91], v[232:235], a[156:159], v[88:91]
    ds_read_b64_tr_b16 v[230:231], v32 offset:6400
    v_mul_f32 v16, v16, v20
    v_mfma_f32_16x16x32_bf16 v[92:95], v[236:239], a[156:159], v[92:95]
    s_waitcnt lgkmcnt(4)
    v_rcp_f32 v17, v17
    v_mfma_f32_16x16x32_bf16 v[64:67], v[12:15], a[16:19], v[64:67]
    ds_read_b64_tr_b16 v[232:233], v1 offset:8192
    v_mul_f32 v17, v17, v21
    v_cvt_pk_bf16_f32 v16, 0, v16
    v_mfma_f32_16x16x32_bf16 v[68:71], v[36:39], a[16:19], v[68:71]
    v_cvt_pk_bf16_f32 v17, 0, v17
    v_mul_f32 v16, v16, v18
    v_mfma_f32_16x16x32_bf16 v[72:75], v[12:15], a[20:23], v[72:75]
    ds_read_b64_tr_b16 v[234:235], v1 offset:8448
    v_mul_f32 v17, v17, v19
    v_mfma_f32_16x16x32_bf16 v[76:79], v[36:39], a[20:23], v[76:79]
    buffer_load_dwordx4 v252, s[24:27], s46 offen lds
    v_cvt_pk_bf16_f32 v40, v16, v17
    v_mfma_f32_16x16x32_bf16 v[80:83], v[12:15], a[160:163], v[80:83]
    s_add_u32 m0, m0, 4096
    ds_read_b64_tr_b16 v[236:237], v32 offset:8192
    v_mul_f32 v25, v29, v29
    v_mfma_f32_16x16x32_bf16 v[84:87], v[36:39], a[160:163], v[84:87]
    s_add_u32 s46, s46, s50
    v_fma_f32 v24, v24, v11, v10
    v_fma_f32 v25, v25, v11, v10
    v_mfma_f32_16x16x32_bf16 v[88:91], v[12:15], a[164:167], v[88:91]
    ds_read_b64_tr_b16 v[238:239], v32 offset:8448
    v_mul_f32 v24, v24, v28
    v_mul_f32 v25, v25, v29
    v_mfma_f32_16x16x32_bf16 v[92:95], v[36:39], a[164:167], v[92:95]
    s_waitcnt lgkmcnt(4)
    v_exp_f32 v24, v24
    v_mfma_f32_16x16x32_bf16 v[64:67], v[224:227], a[24:27], v[64:67]
    ds_read_b64_tr_b16 v[12:13], v1 offset:10240
    v_cvt_pk_bf16_f32 v26, 0, v162
    v_mfma_f32_16x16x32_bf16 v[68:71], v[228:231], a[24:27], v[68:71]
    v_exp_f32 v25, v25
    v_mfma_f32_16x16x32_bf16 v[72:75], v[224:227], a[28:31], v[72:75]
    ds_read_b64_tr_b16 v[14:15], v1 offset:10496
    v_add_f32 v24, 1.0, v24
    v_mfma_f32_16x16x32_bf16 v[76:79], v[228:231], a[28:31], v[76:79]
    v_add_f32 v25, 1.0, v25
    v_cvt_pk_bf16_f32 v27, 0, v163
    v_mfma_f32_16x16x32_bf16 v[80:83], v[224:227], a[168:171], v[80:83]
    ds_read_b64_tr_b16 v[36:37], v32 offset:10240
    v_cvt_pk_bf16_f32 v20, 0, v132
    v_cvt_pk_bf16_f32 v21, 0, v133
    v_mfma_f32_16x16x32_bf16 v[84:87], v[228:231], a[168:171], v[84:87]
    buffer_load_dwordx4 v252, s[24:27], s46 offen lds
    v_mul_f32 v16, v20, v20
    v_mfma_f32_16x16x32_bf16 v[88:91], v[224:227], a[172:175], v[88:91]
    s_add_u32 m0, m0, 4096
    ds_read_b64_tr_b16 v[38:39], v32 offset:10496
    v_mul_f32 v17, v21, v21
    v_mfma_f32_16x16x32_bf16 v[92:95], v[228:231], a[172:175], v[92:95]
    s_waitcnt lgkmcnt(4)
    v_rcp_f32 v24, v24
    v_mfma_f32_16x16x32_bf16 v[64:67], v[232:235], a[32:35], v[64:67]
    s_add_u32 s46, s46, s50
    ds_read_b64_tr_b16 v[224:225], v1 offset:12288
    v_mul_f32 v24, v24, v28
    v_mfma_f32_16x16x32_bf16 v[68:71], v[236:239], a[32:35], v[68:71]
    v_rcp_f32 v25, v25
    v_cvt_pk_bf16_f32 v24, 0, v24
    v_mfma_f32_16x16x32_bf16 v[72:75], v[232:235], a[36:39], v[72:75]
    ds_read_b64_tr_b16 v[226:227], v1 offset:12544
    v_mul_f32 v25, v25, v29
    v_mfma_f32_16x16x32_bf16 v[76:79], v[236:239], a[36:39], v[76:79]
    v_cvt_pk_bf16_f32 v25, 0, v25
    v_mul_f32 v24, v24, v26
    v_mfma_f32_16x16x32_bf16 v[80:83], v[232:235], a[176:179], v[80:83]
    ds_read_b64_tr_b16 v[228:229], v32 offset:12288
    v_mul_f32 v25, v25, v27
    v_mfma_f32_16x16x32_bf16 v[84:87], v[236:239], a[176:179], v[84:87]
    v_cvt_pk_bf16_f32 v41, v24, v25
    v_fma_f32 v16, v16, v11, v10
    v_mfma_f32_16x16x32_bf16 v[88:91], v[232:235], a[180:183], v[88:91]
    ds_read_b64_tr_b16 v[230:231], v32 offset:12544
    v_fma_f32 v17, v17, v11, v10
    v_mfma_f32_16x16x32_bf16 v[92:95], v[236:239], a[180:183], v[92:95]
    s_waitcnt lgkmcnt(4)
    buffer_load_dwordx4 v252, s[24:27], s46 offen lds
    v_mul_f32 v16, v16, v20
    v_mul_f32 v17, v17, v21
    v_mfma_f32_16x16x32_bf16 v[64:67], v[12:15], a[40:43], v[64:67]
    s_add_u32 m0, m0, 4096
    ds_read_b64_tr_b16 v[232:233], v1 offset:14336
    v_cvt_pk_bf16_f32 v18, 0, v164
    v_mfma_f32_16x16x32_bf16 v[68:71], v[36:39], a[40:43], v[68:71]
    s_add_u32 s46, s46, s50
    v_exp_f32 v16, v16
    v_mfma_f32_16x16x32_bf16 v[72:75], v[12:15], a[44:47], v[72:75]
    ds_read_b64_tr_b16 v[234:235], v1 offset:14592
    v_add_f32 v16, 1.0, v16
    v_mfma_f32_16x16x32_bf16 v[76:79], v[36:39], a[44:47], v[76:79]
    v_exp_f32 v17, v17
    v_mfma_f32_16x16x32_bf16 v[80:83], v[12:15], a[184:187], v[80:83]
    ds_read_b64_tr_b16 v[236:237], v32 offset:14336
    v_add_f32 v17, 1.0, v17
    v_cvt_pk_bf16_f32 v19, 0, v165
    v_mfma_f32_16x16x32_bf16 v[84:87], v[36:39], a[184:187], v[84:87]
    v_rcp_f32 v16, v16
    v_mfma_f32_16x16x32_bf16 v[88:91], v[12:15], a[188:191], v[88:91]
    ds_read_b64_tr_b16 v[238:239], v32 offset:14592
    v_mul_f32 v16, v16, v20
    v_mfma_f32_16x16x32_bf16 v[92:95], v[36:39], a[188:191], v[92:95]
    s_waitcnt lgkmcnt(4)
    v_rcp_f32 v17, v17
    v_mfma_f32_16x16x32_bf16 v[64:67], v[224:227], a[48:51], v[64:67]
    ds_read_b64_tr_b16 v[12:13], v1 offset:16384
    v_mul_f32 v17, v17, v21
    v_mfma_f32_16x16x32_bf16 v[68:71], v[228:231], a[48:51], v[68:71]
    buffer_load_dwordx4 v252, s[24:27], s46 offen lds
    v_cvt_pk_bf16_f32 v16, 0, v16
    v_mfma_f32_16x16x32_bf16 v[72:75], v[224:227], a[52:55], v[72:75]
    s_add_u32 m0, m0, 4096
    ds_read_b64_tr_b16 v[14:15], v1 offset:16640
    v_cvt_pk_bf16_f32 v17, 0, v17
    v_mul_f32 v16, v16, v18
    v_mfma_f32_16x16x32_bf16 v[76:79], v[228:231], a[52:55], v[76:79]
    s_add_u32 s46, s46, s50
    v_mul_f32 v17, v17, v19
    v_cvt_pk_bf16_f32 v42, v16, v17
    v_mfma_f32_16x16x32_bf16 v[80:83], v[224:227], a[192:195], v[80:83]
    ds_read_b64_tr_b16 v[36:37], v32 offset:16384
    v_cvt_pk_bf16_f32 v28, 0, v134
    v_mfma_f32_16x16x32_bf16 v[84:87], v[228:231], a[192:195], v[84:87]
    v_cvt_pk_bf16_f32 v29, 0, v135
    v_mul_f32 v24, v28, v28
    v_mfma_f32_16x16x32_bf16 v[88:91], v[224:227], a[196:199], v[88:91]
    ds_read_b64_tr_b16 v[38:39], v32 offset:16640
    v_mul_f32 v25, v29, v29
    v_mfma_f32_16x16x32_bf16 v[92:95], v[228:231], a[196:199], v[92:95]
    s_waitcnt lgkmcnt(4)
    v_fma_f32 v24, v24, v11, v10
    v_fma_f32 v25, v25, v11, v10
    v_mfma_f32_16x16x32_bf16 v[64:67], v[232:235], a[56:59], v[64:67]
    ds_read_b64_tr_b16 v[224:225], v1 offset:18432
    v_mul_f32 v24, v24, v28
    v_mul_f32 v25, v25, v29
    v_mfma_f32_16x16x32_bf16 v[68:71], v[236:239], a[56:59], v[68:71]
    v_exp_f32 v24, v24
    v_mfma_f32_16x16x32_bf16 v[72:75], v[232:235], a[60:63], v[72:75]
    ds_read_b64_tr_b16 v[226:227], v1 offset:18688
    v_cvt_pk_bf16_f32 v26, 0, v166
    v_mfma_f32_16x16x32_bf16 v[76:79], v[236:239], a[60:63], v[76:79]
    buffer_load_dwordx4 v252, s[24:27], s46 offen lds
    v_add_f32 v24, 1.0, v24
    v_mfma_f32_16x16x32_bf16 v[80:83], v[232:235], a[200:203], v[80:83]
    s_add_u32 m0, m0, 4096
    ds_read_b64_tr_b16 v[228:229], v32 offset:18432
    v_cvt_pk_bf16_f32 v27, 0, v167
    v_mfma_f32_16x16x32_bf16 v[84:87], v[236:239], a[200:203], v[84:87]
    s_add_u32 s46, s46, s50
    v_exp_f32 v25, v25
    v_cvt_pk_bf16_f32 v20, 0, v136
    v_mfma_f32_16x16x32_bf16 v[88:91], v[232:235], a[204:207], v[88:91]
    ds_read_b64_tr_b16 v[230:231], v32 offset:18688
    v_add_f32 v25, 1.0, v25
    v_mfma_f32_16x16x32_bf16 v[92:95], v[236:239], a[204:207], v[92:95]
    s_waitcnt lgkmcnt(4)
    v_rcp_f32 v24, v24
    v_mfma_f32_16x16x32_bf16 v[64:67], v[12:15], a[64:67], v[64:67]
    ds_read_b64_tr_b16 v[232:233], v1 offset:20480
    v_mul_f32 v24, v24, v28
    v_mfma_f32_16x16x32_bf16 v[68:71], v[36:39], a[64:67], v[68:71]
    v_rcp_f32 v25, v25
    v_mfma_f32_16x16x32_bf16 v[72:75], v[12:15], a[68:71], v[72:75]
    ds_read_b64_tr_b16 v[234:235], v1 offset:20736
    v_mul_f32 v25, v25, v29
    v_mfma_f32_16x16x32_bf16 v[76:79], v[36:39], a[68:71], v[76:79]
    v_cvt_pk_bf16_f32 v24, 0, v24
    v_cvt_pk_bf16_f32 v25, 0, v25
    v_mul_f32 v24, v24, v26
    v_mfma_f32_16x16x32_bf16 v[80:83], v[12:15], a[208:211], v[80:83]
    ds_read_b64_tr_b16 v[236:237], v32 offset:20480
    v_mul_f32 v25, v25, v27
    v_mfma_f32_16x16x32_bf16 v[84:87], v[36:39], a[208:211], v[84:87]
    buffer_load_dwordx4 v252, s[24:27], s46 offen lds
    v_cvt_pk_bf16_f32 v43, v24, v25
    v_mfma_f32_16x16x32_bf16 v[88:91], v[12:15], a[212:215], v[88:91]
    s_add_u32 m0, m0, 4096
    ds_read_b64_tr_b16 v[238:239], v32 offset:20736
    v_cvt_pk_bf16_f32 v21, 0, v137
    v_mfma_f32_16x16x32_bf16 v[92:95], v[36:39], a[212:215], v[92:95]
    s_waitcnt lgkmcnt(4)
    buffer_store_dwordx4 v[40:43], v7, s[20:23], s39 offen offset:0 sc0 sc1
    v_mul_f32 v16, v20, v20
    v_mfma_f32_16x16x32_bf16 v[64:67], v[224:227], a[72:75], v[64:67]
    s_add_u32 s46, s46, s50
    ds_read_b64_tr_b16 v[12:13], v1 offset:22528
    v_mul_f32 v17, v21, v21
    v_fma_f32 v16, v16, v11, v10
    v_mfma_f32_16x16x32_bf16 v[68:71], v[228:231], a[72:75], v[68:71]
    v_fma_f32 v17, v17, v11, v10
    v_mul_f32 v16, v16, v20
    v_mfma_f32_16x16x32_bf16 v[72:75], v[224:227], a[76:79], v[72:75]
    ds_read_b64_tr_b16 v[14:15], v1 offset:22784
    v_mul_f32 v17, v17, v21
    v_mfma_f32_16x16x32_bf16 v[76:79], v[228:231], a[76:79], v[76:79]
    v_exp_f32 v16, v16
    v_mfma_f32_16x16x32_bf16 v[80:83], v[224:227], a[216:219], v[80:83]
    ds_read_b64_tr_b16 v[36:37], v32 offset:22528
    v_cvt_pk_bf16_f32 v18, 0, v168
    v_mfma_f32_16x16x32_bf16 v[84:87], v[228:231], a[216:219], v[84:87]
    v_exp_f32 v17, v17
    v_mfma_f32_16x16x32_bf16 v[88:91], v[224:227], a[220:223], v[88:91]
    ds_read_b64_tr_b16 v[38:39], v32 offset:22784
    v_add_f32 v16, 1.0, v16
    v_add_f32 v17, 1.0, v17
    v_mfma_f32_16x16x32_bf16 v[92:95], v[228:231], a[220:223], v[92:95]
    s_waitcnt lgkmcnt(4)
    buffer_load_dwordx4 v252, s[24:27], s46 offen lds
    v_cvt_pk_bf16_f32 v19, 0, v169
    v_mfma_f32_16x16x32_bf16 v[64:67], v[232:235], a[80:83], v[64:67]
    s_add_u32 m0, m0, 4096
    ds_read_b64_tr_b16 v[224:225], v1 offset:24576
    v_cvt_pk_bf16_f32 v28, 0, v138
    v_mfma_f32_16x16x32_bf16 v[68:71], v[236:239], a[80:83], v[68:71]
    s_add_u32 s46, s46, s50
    v_rcp_f32 v16, v16
    v_mfma_f32_16x16x32_bf16 v[72:75], v[232:235], a[84:87], v[72:75]
    ds_read_b64_tr_b16 v[226:227], v1 offset:24832
    v_mul_f32 v16, v16, v20
    v_mfma_f32_16x16x32_bf16 v[76:79], v[236:239], a[84:87], v[76:79]
    v_rcp_f32 v17, v17
    v_mfma_f32_16x16x32_bf16 v[80:83], v[232:235], a[224:227], v[80:83]
    ds_read_b64_tr_b16 v[228:229], v32 offset:24576
    v_mul_f32 v17, v17, v21
    v_cvt_pk_bf16_f32 v16, 0, v16
    v_mfma_f32_16x16x32_bf16 v[84:87], v[236:239], a[224:227], v[84:87]
    v_cvt_pk_bf16_f32 v17, 0, v17
    v_mul_f32 v16, v16, v18
    v_mfma_f32_16x16x32_bf16 v[88:91], v[232:235], a[228:231], v[88:91]
    ds_read_b64_tr_b16 v[230:231], v32 offset:24832
    v_mul_f32 v17, v17, v19
    v_mfma_f32_16x16x32_bf16 v[92:95], v[236:239], a[228:231], v[92:95]
    s_waitcnt lgkmcnt(4)
    v_cvt_pk_bf16_f32 v44, v16, v17
    v_cvt_pk_bf16_f32 v29, 0, v139
    v_mfma_f32_16x16x32_bf16 v[64:67], v[12:15], a[88:91], v[64:67]
    ds_read_b64_tr_b16 v[232:233], v1 offset:26624
    v_mul_f32 v24, v28, v28
    v_mfma_f32_16x16x32_bf16 v[68:71], v[36:39], a[88:91], v[68:71]
    buffer_load_dwordx4 v252, s[24:27], s46 offen lds
    v_mul_f32 v25, v29, v29
    v_fma_f32 v24, v24, v11, v10
    v_mfma_f32_16x16x32_bf16 v[72:75], v[12:15], a[92:95], v[72:75]
    s_add_u32 m0, m0, 4096
    ds_read_b64_tr_b16 v[234:235], v1 offset:26880
    v_fma_f32 v25, v25, v11, v10
    v_mfma_f32_16x16x32_bf16 v[76:79], v[36:39], a[92:95], v[76:79]
    s_add_u32 s46, s46, s50
    v_mul_f32 v24, v24, v28
    v_mul_f32 v25, v25, v29
    v_mfma_f32_16x16x32_bf16 v[80:83], v[12:15], a[232:235], v[80:83]
    ds_read_b64_tr_b16 v[236:237], v32 offset:26624
    v_cvt_pk_bf16_f32 v26, 0, v170
    v_mfma_f32_16x16x32_bf16 v[84:87], v[36:39], a[232:235], v[84:87]
    v_exp_f32 v24, v24
    v_mfma_f32_16x16x32_bf16 v[88:91], v[12:15], a[236:239], v[88:91]
    ds_read_b64_tr_b16 v[238:239], v32 offset:26880
    v_add_f32 v24, 1.0, v24
    v_mfma_f32_16x16x32_bf16 v[92:95], v[36:39], a[236:239], v[92:95]
    s_waitcnt lgkmcnt(4)
    v_exp_f32 v25, v25
    v_cvt_pk_bf16_f32 v27, 0, v171
    v_mfma_f32_16x16x32_bf16 v[64:67], v[224:227], a[96:99], v[64:67]
    ds_read_b64_tr_b16 v[12:13], v1 offset:28672
    v_add_f32 v25, 1.0, v25
    v_mfma_f32_16x16x32_bf16 v[68:71], v[228:231], a[96:99], v[68:71]
    s_add_u32 m0, s9, 2048
    v_rcp_f32 v24, v24
    v_mfma_f32_16x16x32_bf16 v[72:75], v[224:227], a[100:103], v[72:75]
    s_add_u32 s10, s76, 9216
    ds_read_b64_tr_b16 v[14:15], v1 offset:28928
    v_mul_f32 v24, v24, v28
    v_mfma_f32_16x16x32_bf16 v[76:79], v[228:231], a[100:103], v[76:79]
    buffer_load_dwordx4 v254, s[68:71], s76 offen lds
    v_cvt_pk_bf16_f32 v24, 0, v24
    v_mfma_f32_16x16x32_bf16 v[80:83], v[224:227], a[240:243], v[80:83]
    s_add_u32 m0, s9, 3072
    ds_read_b64_tr_b16 v[36:37], v32 offset:28672
    v_mul_f32 v24, v24, v26
    v_cvt_pk_bf16_f32 v20, 0, v140
    v_mfma_f32_16x16x32_bf16 v[84:87], v[228:231], a[240:243], v[84:87]
    s_add_u32 s76, s76, 128
    buffer_load_dwordx4 v254, s[68:71], s10 offen lds
    v_cvt_pk_bf16_f32 v21, 0, v141
    v_mfma_f32_16x16x32_bf16 v[88:91], v[224:227], a[244:247], v[88:91]
    ds_read_b64_tr_b16 v[38:39], v32 offset:28928
    v_mul_f32 v16, v20, v20
    v_mfma_f32_16x16x32_bf16 v[92:95], v[228:231], a[244:247], v[92:95]
    s_waitcnt lgkmcnt(4)
    s_getpc_b64 s[56:57]
L_pc2:
    v_mul_f32 v17, v21, v21
    v_mfma_f32_16x16x32_bf16 v[64:67], v[232:235], a[104:107], v[64:67]
    ds_read_b64_tr_b16 v[224:225], v1 offset:30720
    v_fma_f32 v16, v16, v11, v10
    v_mfma_f32_16x16x32_bf16 v[68:71], v[236:239], a[104:107], v[68:71]
    s_sub_u32 s56, s56, L_pc2-L_k1_abody
    s_subb_u32 s57, s57, 0
    v_mfma_f32_16x16x32_bf16 v[72:75], v[232:235], a[108:111], v[72:75]
    ds_read_b64_tr_b16 v[226:227], v1 offset:30976
    v_fma_f32 v17, v17, v11, v10
    v_mul_f32 v16, v16, v20
    v_mfma_f32_16x16x32_bf16 v[76:79], v[236:239], a[108:111], v[76:79]
    s_and_b32 s57, s57, 0xffff
    v_rcp_f32 v25, v25
    v_mfma_f32_16x16x32_bf16 v[80:83], v[232:235], a[248:251], v[80:83]
    s_mov_b32 s58, L_k1_done-L_k1_abody
    ds_read_b64_tr_b16 v[228:229], v32 offset:30720
    v_mul_f32 v25, v25, v29
    v_mfma_f32_16x16x32_bf16 v[84:87], v[236:239], a[248:251], v[84:87]
    s_mov_b32 s59, 0x00020000
    v_cvt_pk_bf16_f32 v25, 0, v25
    v_mul_f32 v25, v25, v27
    v_mfma_f32_16x16x32_bf16 v[88:91], v[232:235], a[252:255], v[88:91]
    s_lshr_b32 s77, s2, 3
    ds_read_b64_tr_b16 v[230:231], v32 offset:30976
    v_cvt_pk_bf16_f32 v45, v24, v25
    v_mfma_f32_16x16x32_bf16 v[92:95], v[236:239], a[252:255], v[92:95]
    s_waitcnt lgkmcnt(4)
    v_mul_f32 v17, v17, v21
    v_cvt_pk_bf16_f32 v18, 0, v172
    v_mfma_f32_16x16x32_bf16 v[64:67], v[12:15], a[112:115], v[64:67]
    s_lshl_b32 s77, s77, 2
    ds_read_b64_tr_b16 v[232:233], v1 offset:32768
    v_cvt_pk_bf16_f32 v19, 0, v173
    v_exp_f32 v16, v16
    v_mfma_f32_16x16x32_bf16 v[68:71], v[36:39], a[112:115], v[68:71]
    s_add_u32 s77, s77, s28
    v_exp_f32 v17, v17
    v_mfma_f32_16x16x32_bf16 v[72:75], v[12:15], a[116:119], v[72:75]
    s_lshl_b32 s77, s77, 10
    ds_read_b64_tr_b16 v[234:235], v1 offset:33024
    v_add_f32 v16, 1.0, v16
    v_mfma_f32_16x16x32_bf16 v[76:79], v[36:39], a[116:119], v[76:79]
    buffer_load_dwordx4 v[240:243], v9, s[56:59], s77 offen
    v_add_f32 v17, 1.0, v17
    v_mfma_f32_16x16x32_bf16 v[80:83], v[12:15], v[192:195], v[80:83]
    ds_read_b64_tr_b16 v[236:237], v32 offset:32768
    v_cvt_pk_bf16_f32 v28, 0, v142
    v_mfma_f32_16x16x32_bf16 v[84:87], v[36:39], v[192:195], v[84:87]
    v_rcp_f32 v16, v16
    v_mfma_f32_16x16x32_bf16 v[88:91], v[12:15], v[196:199], v[88:91]
    ds_read_b64_tr_b16 v[238:239], v32 offset:33024
    v_mul_f32 v16, v16, v20
    v_mfma_f32_16x16x32_bf16 v[92:95], v[36:39], v[196:199], v[92:95]
    s_waitcnt lgkmcnt(4)
    v_rcp_f32 v17, v17
    v_mfma_f32_16x16x32_bf16 v[64:67], v[224:227], a[120:123], v[64:67]
    ds_read_b64_tr_b16 v[12:13], v1 offset:34816
    v_mul_f32 v17, v17, v21
    v_mfma_f32_16x16x32_bf16 v[68:71], v[228:231], a[120:123], v[68:71]
    v_cvt_pk_bf16_f32 v16, 0, v16
    v_cvt_pk_bf16_f32 v17, 0, v17
    v_mfma_f32_16x16x32_bf16 v[72:75], v[224:227], a[124:127], v[72:75]
    ds_read_b64_tr_b16 v[14:15], v1 offset:35072
    v_mul_f32 v16, v16, v18
    v_mfma_f32_16x16x32_bf16 v[76:79], v[228:231], a[124:127], v[76:79]
    v_mul_f32 v17, v17, v19
    v_cvt_pk_bf16_f32 v46, v16, v17
    v_cvt_pk_bf16_f32 v29, 0, v143
    v_mfma_f32_16x16x32_bf16 v[80:83], v[224:227], v[200:203], v[80:83]
    ds_read_b64_tr_b16 v[36:37], v32 offset:34816
    v_mul_f32 v24, v28, v28
    v_mfma_f32_16x16x32_bf16 v[84:87], v[228:231], v[200:203], v[84:87]
    v_mul_f32 v25, v29, v29
    v_fma_f32 v24, v24, v11, v10
    v_mfma_f32_16x16x32_bf16 v[88:91], v[224:227], v[204:207], v[88:91]
    ds_read_b64_tr_b16 v[38:39], v32 offset:35072
    v_fma_f32 v25, v25, v11, v10
    v_mfma_f32_16x16x32_bf16 v[92:95], v[228:231], v[204:207], v[92:95]
    s_waitcnt lgkmcnt(4)
    v_mul_f32 v24, v24, v28
    v_mul_f32 v25, v25, v29
    s_waitcnt vmcnt(13)
    s_barrier
    s_cmp_eq_u32 s28, 0
    s_cselect_b32 s77, s53, 0
    v_mov_b32 v244, s4
    v_mov_b32 v245, s5
    v_lshrrev_b32 v246, 1, v9
    s_and_b32 s78, s2, 7
    s_lshl_b32 s78, s78, 5
    s_lshr_b32 s79, s2, 3
    s_add_u32 s78, s78, s79
    s_lshl_b32 s78, s78, 7
    s_add_u32 s78, s78, 65536
    s_mul_i32 exec_lo, s77, 65535
    s_mov_b32 exec_hi, 0
    buffer_store_dwordx2 v[244:245], v246, s[64:67], s78 offen sc0 sc1
    s_mov_b64 exec, -1
    v_mfma_f32_16x16x32_bf16 v[64:67], v[232:235], a[128:131], v[64:67]
    ds_read_b64_tr_b16 v[224:225], v2 offset:0
    v_cvt_pk_bf16_f32 v26, 0, v174
    v_cvt_pk_bf16_f32 v27, 0, v175
    v_mfma_f32_16x16x32_bf16 v[68:71], v[236:239], a[128:131], v[68:71]
    v_exp_f32 v24, v24
    v_mfma_f32_16x16x32_bf16 v[72:75], v[232:235], a[132:135], v[72:75]
    ds_read_b64_tr_b16 v[226:227], v2 offset:256
    v_add_f32 v24, 1.0, v24
    v_mfma_f32_16x16x32_bf16 v[76:79], v[236:239], a[132:135], v[76:79]
    v_exp_f32 v25, v25
    v_mfma_f32_16x16x32_bf16 v[80:83], v[232:235], v[208:211], v[80:83]
    ds_read_b64_tr_b16 v[228:229], v33 offset:0
    v_add_f32 v25, 1.0, v25
    v_mfma_f32_16x16x32_bf16 v[84:87], v[236:239], v[208:211], v[84:87]
    v_rcp_f32 v24, v24
    v_mfma_f32_16x16x32_bf16 v[88:91], v[232:235], v[212:215], v[88:91]
    ds_read_b64_tr_b16 v[230:231], v33 offset:256
    v_mul_f32 v24, v24, v28
    v_cvt_pk_bf16_f32 v24, 0, v24
    v_mfma_f32_16x16x32_bf16 v[92:95], v[236:239], v[212:215], v[92:95]
    s_waitcnt lgkmcnt(4)
    v_rcp_f32 v25, v25
    v_mfma_f32_16x16x32_bf16 v[64:67], v[12:15], a[136:139], v[64:67]
    ds_read_b64_tr_b16 v[232:233], v2 offset:2048
    v_mul_f32 v25, v25, v29
    v_mfma_f32_16x16x32_bf16 v[68:71], v[36:39], a[136:139], v[68:71]
    v_cvt_pk_bf16_f32 v25, 0, v25
    v_mul_f32 v24, v24, v26
    v_mfma_f32_16x16x32_bf16 v[72:75], v[12:15], a[140:143], v[72:75]
    ds_read_b64_tr_b16 v[234:235], v2 offset:2304
    v_mul_f32 v25, v25, v27
    v_mfma_f32_16x16x32_bf16 v[76:79], v[36:39], a[140:143], v[76:79]
    v_cvt_pk_bf16_f32 v47, v24, v25
    v_mfma_f32_16x16x32_bf16 v[80:83], v[12:15], v[216:219], v[80:83]
    ds_read_b64_tr_b16 v[236:237], v33 offset:2048
    buffer_store_dwordx4 v[44:47], v7, s[20:23], s39 offen offset:1024 sc0 sc1
    v_mfma_f32_16x16x32_bf16 v[84:87], v[36:39], v[216:219], v[84:87]
    v_mfma_f32_16x16x32_bf16 v[88:91], v[12:15], v[220:223], v[88:91]
    ds_read_b64_tr_b16 v[238:239], v33 offset:2304
    v_mfma_f32_16x16x32_bf16 v[92:95], v[36:39], v[220:223], v[92:95]
    s_waitcnt lgkmcnt(4)
    v_mfma_f32_16x16x32_bf16 v[96:99], v[224:227], a[0:3], 0
    ds_read_b64_tr_b16 v[12:13], v2 offset:4096
    v_mfma_f32_16x16x32_bf16 v[100:103], v[228:231], a[0:3], 0
    s_add_u32 m0, s38, 110592
    v_mfma_f32_16x16x32_bf16 v[104:107], v[224:227], a[4:7], 0
    ds_read_b64_tr_b16 v[14:15], v2 offset:4352
    v_mfma_f32_16x16x32_bf16 v[108:111], v[228:231], a[4:7], 0
    v_mfma_f32_16x16x32_bf16 v[112:115], v[224:227], a[144:147], 0
    ds_read_b64_tr_b16 v[36:37], v33 offset:4096
    v_cvt_pk_bf16_f32 v20, 0, v144
    v_cvt_pk_bf16_f32 v21, 0, v145
    v_mfma_f32_16x16x32_bf16 v[116:119], v[228:231], a[144:147], 0
    v_mul_f32 v16, v20, v20
    v_mul_f32 v17, v21, v21
    v_fma_f32 v16, v16, v11, v10
    v_mfma_f32_16x16x32_bf16 v[120:123], v[224:227], a[148:151], 0
    ds_read_b64_tr_b16 v[38:39], v33 offset:4352
    v_fma_f32 v17, v17, v11, v10
    v_mul_f32 v16, v16, v20
    v_mfma_f32_16x16x32_bf16 v[124:127], v[228:231], a[148:151], 0
    s_waitcnt lgkmcnt(4)
    v_mul_f32 v17, v17, v21
    v_cvt_pk_bf16_f32 v18, 0, v176
    v_cvt_pk_bf16_f32 v19, 0, v177
    v_mfma_f32_16x16x32_bf16 v[96:99], v[232:235], a[8:11], v[96:99]
    ds_read_b64_tr_b16 v[224:225], v2 offset:6144
    v_exp_f32 v16, v16
    v_mfma_f32_16x16x32_bf16 v[100:103], v[236:239], a[8:11], v[100:103]
    buffer_load_dwordx4 v6, s[88:91], s47 offen lds
    v_add_f32 v16, 1.0, v16
    v_cvt_pk_bf16_f32 v28, 0, v146
    v_mfma_f32_16x16x32_bf16 v[104:107], v[232:235], a[12:15], v[104:107]
    s_add_u32 m0, m0, 4096
    ds_read_b64_tr_b16 v[226:227], v2 offset:6400
    v_cvt_pk_bf16_f32 v29, 0, v147
    v_mul_f32 v24, v28, v28
    v_mfma_f32_16x16x32_bf16 v[108:111], v[236:239], a[12:15], v[108:111]
    s_add_u32 s47, s47, s37
    v_exp_f32 v17, v17
    v_mul_f32 v25, v29, v29
    v_mfma_f32_16x16x32_bf16 v[112:115], v[232:235], a[152:155], v[112:115]
    ds_read_b64_tr_b16 v[228:229], v33 offset:6144
    v_add_f32 v17, 1.0, v17
    v_mfma_f32_16x16x32_bf16 v[116:119], v[236:239], a[152:155], v[116:119]
    s_waitcnt vmcnt(15)
    ds_read_b64_tr_b16 v[244:245], v248 offset:0
    v_fma_f32 v24, v24, v11, v10
    v_mfma_f32_16x16x32_bf16 v[120:123], v[232:235], a[156:159], v[120:123]
    ds_read_b64_tr_b16 v[230:231], v33 offset:6400
    v_fma_f32 v25, v25, v11, v10
    v_mfma_f32_16x16x32_bf16 v[124:127], v[236:239], a[156:159], v[124:127]
    s_waitcnt lgkmcnt(4)
    ds_read_b64_tr_b16 v[246:247], v248 offset:1024
    v_mul_f32 v24, v24, v28
    v_mul_f32 v25, v25, v29
    v_mfma_f32_16x16x32_bf16 v[96:99], v[12:15], a[16:19], v[96:99]
    ds_read_b64_tr_b16 v[232:233], v2 offset:8192
    v_cvt_pk_bf16_f32 v26, 0, v178
    v_mfma_f32_16x16x32_bf16 v[100:103], v[36:39], a[16:19], v[100:103]
    v_rcp_f32 v16, v16
    v_mfma_f32_16x16x32_bf16 v[104:107], v[12:15], a[20:23], v[104:107]
    ds_read_b64_tr_b16 v[234:235], v2 offset:8448
    v_mul_f32 v16, v16, v20
    v_mfma_f32_16x16x32_bf16 v[108:111], v[36:39], a[20:23], v[108:111]
    buffer_load_dwordx4 v6, s[88:91], s47 offen lds
    v_cvt_pk_bf16_f32 v16, 0, v16
    v_mul_f32 v16, v16, v18
    v_mfma_f32_16x16x32_bf16 v[112:115], v[12:15], a[160:163], v[112:115]
    s_add_u32 m0, m0, 4096
    ds_read_b64_tr_b16 v[236:237], v33 offset:8192
    v_cvt_pk_bf16_f32 v27, 0, v179
    v_mfma_f32_16x16x32_bf16 v[116:119], v[36:39], a[160:163], v[116:119]
    s_add_u32 s47, s47, s37
    v_rcp_f32 v17, v17
    v_mfma_f32_16x16x32_bf16 v[120:123], v[12:15], a[164:167], v[120:123]
    ds_read_b64_tr_b16 v[238:239], v33 offset:8448
    v_mul_f32 v17, v17, v21
    v_mfma_f32_16x16x32_bf16 v[124:127], v[36:39], a[164:167], v[124:127]
    s_waitcnt lgkmcnt(4)
    v_cvt_pk_bf16_f32 v17, 0, v17
    v_mul_f32 v17, v17, v19
    v_cvt_pk_bf16_f32 v40, v16, v17
    v_mfma_f32_16x16x32_bf16 v[96:99], v[224:227], a[24:27], v[96:99]
    ds_read_b64_tr_b16 v[12:13], v2 offset:10240
    v_exp_f32 v24, v24
    v_mfma_f32_16x16x32_bf16 v[100:103], v[228:231], a[24:27], v[100:103]
    v_exp_f32 v25, v25
    v_mfma_f32_16x16x32_bf16 v[104:107], v[224:227], a[28:31], v[104:107]
    ds_read_b64_tr_b16 v[14:15], v2 offset:10496
    v_add_f32 v24, 1.0, v24
    v_mfma_f32_16x16x32_bf16 v[108:111], v[228:231], a[28:31], v[108:111]
    buffer_store_dwordx4 v[244:247], v249, s[12:15], s8 offen offset:0 sc0 sc1
    v_add_f32 v25, 1.0, v25
    v_mfma_f32_16x16x32_bf16 v[112:115], v[224:227], a[168:171], v[112:115]
    ds_read_b64_tr_b16 v[36:37], v33 offset:10240
    v_cvt_pk_bf16_f32 v20, 0, v148
    v_mfma_f32_16x16x32_bf16 v[116:119], v[228:231], a[168:171], v[116:119]
    buffer_load_dwordx4 v6, s[88:91], s47 offen lds
    v_cvt_pk_bf16_f32 v21, 0, v149
    v_mfma_f32_16x16x32_bf16 v[120:123], v[224:227], a[172:175], v[120:123]
    s_add_u32 m0, m0, 4096
    ds_read_b64_tr_b16 v[38:39], v33 offset:10496
    v_mul_f32 v16, v20, v20
    v_mfma_f32_16x16x32_bf16 v[124:127], v[228:231], a[172:175], v[124:127]
    s_waitcnt lgkmcnt(4)
    v_rcp_f32 v24, v24
    v_mul_f32 v17, v21, v21
    v_mfma_f32_16x16x32_bf16 v[96:99], v[232:235], a[32:35], v[96:99]
    s_add_u32 s47, s47, s37
    ds_read_b64_tr_b16 v[224:225], v2 offset:12288
    v_mul_f32 v24, v24, v28
    v_mfma_f32_16x16x32_bf16 v[100:103], v[236:239], a[32:35], v[100:103]
    v_rcp_f32 v25, v25
    v_mfma_f32_16x16x32_bf16 v[104:107], v[232:235], a[36:39], v[104:107]
    ds_read_b64_tr_b16 v[226:227], v2 offset:12544
    v_mul_f32 v25, v25, v29
    v_mfma_f32_16x16x32_bf16 v[108:111], v[236:239], a[36:39], v[108:111]
    v_cvt_pk_bf16_f32 v24, 0, v24
    v_cvt_pk_bf16_f32 v25, 0, v25
    v_mul_f32 v24, v24, v26
    v_mfma_f32_16x16x32_bf16 v[112:115], v[232:235], a[176:179], v[112:115]
    ds_read_b64_tr_b16 v[228:229], v33 offset:12288
    v_mul_f32 v25, v25, v27
    v_mfma_f32_16x16x32_bf16 v[116:119], v[236:239], a[176:179], v[116:119]
    ds_read_b64_tr_b16 v[244:245], v248 offset:64
    v_cvt_pk_bf16_f32 v41, v24, v25
    v_mfma_f32_16x16x32_bf16 v[120:123], v[232:235], a[180:183], v[120:123]
    ds_read_b64_tr_b16 v[230:231], v33 offset:12544
    v_fma_f32 v16, v16, v11, v10
    v_fma_f32 v17, v17, v11, v10
    v_mfma_f32_16x16x32_bf16 v[124:127], v[236:239], a[180:183], v[124:127]
    s_waitcnt lgkmcnt(4)
    ds_read_b64_tr_b16 v[246:247], v248 offset:1088
    v_mul_f32 v16, v16, v20
    v_mfma_f32_16x16x32_bf16 v[96:99], v[12:15], a[40:43], v[96:99]
    ds_read_b64_tr_b16 v[232:233], v2 offset:14336
    v_mul_f32 v17, v17, v21
    v_mfma_f32_16x16x32_bf16 v[100:103], v[36:39], a[40:43], v[100:103]
    buffer_load_dwordx4 v6, s[88:91], s47 offen lds
    v_cvt_pk_bf16_f32 v18, 0, v180
    v_mfma_f32_16x16x32_bf16 v[104:107], v[12:15], a[44:47], v[104:107]
    s_add_u32 m0, m0, 4096
    ds_read_b64_tr_b16 v[234:235], v2 offset:14592
    v_cvt_pk_bf16_f32 v19, 0, v181
    v_exp_f32 v16, v16
    v_mfma_f32_16x16x32_bf16 v[108:111], v[36:39], a[44:47], v[108:111]
    s_add_u32 s47, s47, s37
    v_exp_f32 v17, v17
    v_mfma_f32_16x16x32_bf16 v[112:115], v[12:15], a[184:187], v[112:115]
    ds_read_b64_tr_b16 v[236:237], v33 offset:14336
    v_add_f32 v16, 1.0, v16
    v_mfma_f32_16x16x32_bf16 v[116:119], v[36:39], a[184:187], v[116:119]
    v_add_f32 v17, 1.0, v17
    v_cvt_pk_bf16_f32 v28, 0, v150
    v_mfma_f32_16x16x32_bf16 v[120:123], v[12:15], a[188:191], v[120:123]
    ds_read_b64_tr_b16 v[238:239], v33 offset:14592
    v_cvt_pk_bf16_f32 v29, 0, v151
    v_mfma_f32_16x16x32_bf16 v[124:127], v[36:39], a[188:191], v[124:127]
    s_waitcnt lgkmcnt(4)
    v_rcp_f32 v16, v16
    v_mfma_f32_16x16x32_bf16 v[96:99], v[224:227], a[48:51], v[96:99]
    ds_read_b64_tr_b16 v[12:13], v2 offset:16384
    v_mul_f32 v16, v16, v20
    v_mfma_f32_16x16x32_bf16 v[100:103], v[228:231], a[48:51], v[100:103]
    buffer_load_dwordx4 v6, s[88:91], s47 offen lds
    v_cvt_pk_bf16_f32 v16, 0, v16
    v_mfma_f32_16x16x32_bf16 v[104:107], v[224:227], a[52:55], v[104:107]
    s_add_u32 m0, m0, 4096
    ds_read_b64_tr_b16 v[14:15], v2 offset:16640
    v_mul_f32 v16, v16, v18
    v_mul_f32 v24, v28, v28
    v_mfma_f32_16x16x32_bf16 v[108:111], v[228:231], a[52:55], v[108:111]
    s_add_u32 s47, s47, s37
    buffer_store_dwordx4 v[244:247], v249, s[12:15], s8 offen offset:2048 sc0 sc1
    v_mul_f32 v25, v29, v29
    v_mfma_f32_16x16x32_bf16 v[112:115], v[224:227], a[192:195], v[112:115]
    s_add_u32 s8, s8, 4096
    ds_read_b64_tr_b16 v[36:37], v33 offset:16384
    v_fma_f32 v24, v24, v11, v10
    v_mfma_f32_16x16x32_bf16 v[116:119], v[228:231], a[192:195], v[116:119]
    v_rcp_f32 v17, v17
    v_mfma_f32_16x16x32_bf16 v[120:123], v[224:227], a[196:199], v[120:123]
    ds_read_b64_tr_b16 v[38:39], v33 offset:16640
    v_mul_f32 v17, v17, v21
    v_cvt_pk_bf16_f32 v17, 0, v17
    v_mfma_f32_16x16x32_bf16 v[124:127], v[228:231], a[196:199], v[124:127]
    s_waitcnt lgkmcnt(4)
    v_mul_f32 v17, v17, v19
    v_cvt_pk_bf16_f32 v42, v16, v17
    v_mfma_f32_16x16x32_bf16 v[96:99], v[232:235], a[56:59], v[96:99]
    ds_read_b64_tr_b16 v[224:225], v2 offset:18432
    v_fma_f32 v25, v25, v11, v10
    v_mfma_f32_16x16x32_bf16 v[100:103], v[236:239], a[56:59], v[100:103]
    v_mul_f32 v24, v24, v28
    v_mul_f32 v25, v25, v29
    v_mfma_f32_16x16x32_bf16 v[104:107], v[232:235], a[60:63], v[104:107]
    ds_read_b64_tr_b16 v[226:227], v2 offset:18688
    v_cvt_pk_bf16_f32 v26, 0, v182
    v_cvt_pk_bf16_f32 v27, 0, v183
    v_mfma_f32_16x16x32_bf16 v[108:111], v[236:239], a[60:63], v[108:111]
    buffer_load_dwordx4 v6, s[88:91], s47 offen lds
    v_exp_f32 v24, v24
    v_mfma_f32_16x16x32_bf16 v[112:115], v[232:235], a[200:203], v[112:115]
    s_add_u32 m0, m0, 4096
    ds_read_b64_tr_b16 v[228:229], v33 offset:18432
    v_add_f32 v24, 1.0, v24
    v_mfma_f32_16x16x32_bf16 v[116:119], v[236:239], a[200:203], v[116:119]
    s_add_u32 s47, s47, s37
    v_exp_f32 v25, v25
    v_mfma_f32_16x16x32_bf16 v[120:123], v[232:235], a[204:207], v[120:123]
    ds_read_b64_tr_b16 v[230:231], v33 offset:18688
    v_add_f32 v25, 1.0, v25
    v_mfma_f32_16x16x32_bf16 v[124:127], v[236:239], a[204:207], v[124:127]
    s_waitcnt lgkmcnt(4)
    v_rcp_f32 v24, v24
    v_mfma_f32_16x16x32_bf16 v[96:99], v[12:15], a[64:67], v[96:99]
    ds_read_b64_tr_b16 v[232:233], v2 offset:20480
    v_mul_f32 v24, v24, v28
    v_mfma_f32_16x16x32_bf16 v[100:103], v[36:39], a[64:67], v[100:103]
    v_rcp_f32 v25, v25
    v_mfma_f32_16x16x32_bf16 v[104:107], v[12:15], a[68:71], v[104:107]
    ds_read_b64_tr_b16 v[234:235], v2 offset:20736
    v_mul_f32 v25, v25, v29
    v_cvt_pk_bf16_f32 v24, 0, v24
    v_mfma_f32_16x16x32_bf16 v[108:111], v[36:39], a[68:71], v[108:111]
    v_cvt_pk_bf16_f32 v25, 0, v25
    v_mul_f32 v24, v24, v26
    v_mfma_f32_16x16x32_bf16 v[112:115], v[12:15], a[208:211], v[112:115]
    ds_read_b64_tr_b16 v[236:237], v33 offset:20480
    v_mul_f32 v25, v25, v27
    v_mfma_f32_16x16x32_bf16 v[116:119], v[36:39], a[208:211], v[116:119]
    buffer_load_dwordx4 v6, s[88:91], s47 offen lds
    v_cvt_pk_bf16_f32 v43, v24, v25
    v_mfma_f32_16x16x32_bf16 v[120:123], v[12:15], a[212:215], v[120:123]
    s_add_u32 m0, m0, 4096
    ds_read_b64_tr_b16 v[238:239], v33 offset:20736
    v_cvt_pk_bf16_f32 v20, 0, v152
    v_cvt_pk_bf16_f32 v21, 0, v153
    v_mfma_f32_16x16x32_bf16 v[124:127], v[36:39], a[212:215], v[124:127]
    s_waitcnt lgkmcnt(4)
    buffer_store_dwordx4 v[40:43], v7, s[20:23], s39 offen offset:2048 sc0 sc1
    v_mul_f32 v16, v20, v20
    v_mfma_f32_16x16x32_bf16 v[96:99], v[224:227], a[72:75], v[96:99]
    s_add_u32 s47, s47, s37
    ds_read_b64_tr_b16 v[12:13], v2 offset:22528
    v_mul_f32 v17, v21, v21
    v_mfma_f32_16x16x32_bf16 v[100:103], v[228:231], a[72:75], v[100:103]
    v_fma_f32 v16, v16, v11, v10
    v_fma_f32 v17, v17, v11, v10
    v_mul_f32 v16, v16, v20
    v_mfma_f32_16x16x32_bf16 v[104:107], v[224:227], a[76:79], v[104:107]
    ds_read_b64_tr_b16 v[14:15], v2 offset:22784
    v_mul_f32 v17, v17, v21
    v_mfma_f32_16x16x32_bf16 v[108:111], v[228:231], a[76:79], v[108:111]
    v_exp_f32 v16, v16
    v_mfma_f32_16x16x32_bf16 v[112:115], v[224:227], a[216:219], v[112:115]
    ds_read_b64_tr_b16 v[36:37], v33 offset:22528
    v_cvt_pk_bf16_f32 v18, 0, v184
    v_mfma_f32_16x16x32_bf16 v[116:119], v[228:231], a[216:219], v[116:119]
    v_exp_f32 v17, v17
    v_add_f32 v16, 1.0, v16
    v_mfma_f32_16x16x32_bf16 v[120:123], v[224:227], a[220:223], v[120:123]
    ds_read_b64_tr_b16 v[38:39], v33 offset:22784
    v_add_f32 v17, 1.0, v17
    v_mfma_f32_16x16x32_bf16 v[124:127], v[228:231], a[220:223], v[124:127]
    s_waitcnt lgkmcnt(4)
    buffer_load_dwordx4 v6, s[88:91], s47 offen lds
    v_cvt_pk_bf16_f32 v19, 0, v185
    v_mfma_f32_16x16x32_bf16 v[96:99], v[232:235], a[80:83], v[96:99]
    s_add_u32 m0, m0, 4096
    ds_read_b64_tr_b16 v[224:225], v2 offset:24576
    v_cvt_pk_bf16_f32 v28, 0, v154
    v_mfma_f32_16x16x32_bf16 v[100:103], v[236:239], a[80:83], v[100:103]
    s_add_u32 s47, s47, s37
    v_rcp_f32 v16, v16
    v_cvt_pk_bf16_f32 v29, 0, v155
    v_mfma_f32_16x16x32_bf16 v[104:107], v[232:235], a[84:87], v[104:107]
    ds_read_b64_tr_b16 v[226:227], v2 offset:24832
    v_mul_f32 v16, v16, v20
    v_mfma_f32_16x16x32_bf16 v[108:111], v[236:239], a[84:87], v[108:111]
    v_rcp_f32 v17, v17
    v_mfma_f32_16x16x32_bf16 v[112:115], v[232:235], a[224:227], v[112:115]
    ds_read_b64_tr_b16 v[228:229], v33 offset:24576
    v_mul_f32 v17, v17, v21
    v_mfma_f32_16x16x32_bf16 v[116:119], v[236:239], a[224:227], v[116:119]
    v_cvt_pk_bf16_f32 v16, 0, v16
    v_cvt_pk_bf16_f32 v17, 0, v17
    v_mul_f32 v16, v16, v18
    v_mfma_f32_16x16x32_bf16 v[120:123], v[232:235], a[228:231], v[120:123]
    ds_read_b64_tr_b16 v[230:231], v33 offset:24832
    v_mul_f32 v17, v17, v19
    v_mfma_f32_16x16x32_bf16 v[124:127], v[236:239], a[228:231], v[124:127]
    s_waitcnt lgkmcnt(4)
    v_cvt_pk_bf16_f32 v44, v16, v17
    v_mul_f32 v24, v28, v28
    v_mfma_f32_16x16x32_bf16 v[96:99], v[12:15], a[88:91], v[96:99]
    ds_read_b64_tr_b16 v[232:233], v2 offset:26624
    v_mul_f32 v25, v29, v29
    v_mfma_f32_16x16x32_bf16 v[100:103], v[36:39], a[88:91], v[100:103]
    buffer_load_dwordx4 v6, s[88:91], s47 offen lds
    v_fma_f32 v24, v24, v11, v10
    v_fma_f32 v25, v25, v11, v10
    v_mfma_f32_16x16x32_bf16 v[104:107], v[12:15], a[92:95], v[104:107]
    s_add_u32 m0, m0, 4096
    ds_read_b64_tr_b16 v[234:235], v2 offset:26880
    v_mul_f32 v24, v24, v28
    v_mfma_f32_16x16x32_bf16 v[108:111], v[36:39], a[92:95], v[108:111]
    s_add_u32 s47, s47, s37
    v_mul_f32 v25, v25, v29
    v_cvt_pk_bf16_f32 v26, 0, v186
    v_mfma_f32_16x16x32_bf16 v[112:115], v[12:15], a[232:235], v[112:115]
    ds_read_b64_tr_b16 v[236:237], v33 offset:26624
    v_cvt_pk_bf16_f32 v27, 0, v187
    v_mfma_f32_16x16x32_bf16 v[116:119], v[36:39], a[232:235], v[116:119]
    v_exp_f32 v24, v24
    v_exp_f32 v25, v25
    v_mfma_f32_16x16x32_bf16 v[120:123], v[12:15], a[236:239], v[120:123]
    ds_read_b64_tr_b16 v[238:239], v33 offset:26880
    v_add_f32 v24, 1.0, v24
    v_mfma_f32_16x16x32_bf16 v[124:127], v[36:39], a[236:239], v[124:127]
    s_waitcnt lgkmcnt(4)
    v_add_f32 v25, 1.0, v25
    v_cvt_pk_bf16_f32 v20, 0, v156
    v_mfma_f32_16x16x32_bf16 v[96:99], v[224:227], a[96:99], v[96:99]
    ds_read_b64_tr_b16 v[12:13], v2 offset:28672
    v_cvt_pk_bf16_f32 v21, 0, v157
    v_mfma_f32_16x16x32_bf16 v[100:103], v[228:231], a[96:99], v[100:103]
    s_add_u32 m0, s9, 0
    v_rcp_f32 v24, v24
    v_mfma_f32_16x16x32_bf16 v[104:107], v[224:227], a[100:103], v[104:107]
    s_add_u32 s10, s76, 9216
    ds_read_b64_tr_b16 v[14:15], v2 offset:28928
    v_mul_f32 v24, v24, v28
    v_mfma_f32_16x16x32_bf16 v[108:111], v[228:231], a[100:103], v[108:111]
    buffer_load_dwordx4 v254, s[68:71], s76 offen lds
    v_cvt_pk_bf16_f32 v24, 0, v24
    v_mfma_f32_16x16x32_bf16 v[112:115], v[224:227], a[240:243], v[112:115]
    s_add_u32 m0, s9, 1024
    ds_read_b64_tr_b16 v[36:37], v33 offset:28672
    v_mul_f32 v24, v24, v26
    v_mfma_f32_16x16x32_bf16 v[116:119], v[228:231], a[240:243], v[116:119]
    s_add_u32 s76, s76, 128
    buffer_load_dwordx4 v254, s[68:71], s10 offen lds
    v_mul_f32 v16, v20, v20
    v_mul_f32 v17, v21, v21
    v_mfma_f32_16x16x32_bf16 v[120:123], v[224:227], a[244:247], v[120:123]
    ds_read_b64_tr_b16 v[38:39], v33 offset:28928
    v_fma_f32 v16, v16, v11, v10
    v_mfma_f32_16x16x32_bf16 v[124:127], v[228:231], a[244:247], v[124:127]
    s_waitcnt lgkmcnt(4)
    v_rcp_f32 v25, v25
    v_mfma_f32_16x16x32_bf16 v[96:99], v[232:235], a[104:107], v[96:99]
    ds_read_b64_tr_b16 v[224:225], v2 offset:30720
    v_mul_f32 v25, v25, v29
    v_mfma_f32_16x16x32_bf16 v[100:103], v[236:239], a[104:107], v[100:103]
    v_cvt_pk_bf16_f32 v25, 0, v25
    v_mul_f32 v25, v25, v27
    v_cvt_pk_bf16_f32 v45, v24, v25
    v_mfma_f32_16x16x32_bf16 v[104:107], v[232:235], a[108:111], v[104:107]
    ds_read_b64_tr_b16 v[226:227], v2 offset:30976
    v_fma_f32 v17, v17, v11, v10
    v_mfma_f32_16x16x32_bf16 v[108:111], v[236:239], a[108:111], v[108:111]
    v_mul_f32 v16, v16, v20
    v_mul_f32 v17, v17, v21
    v_mfma_f32_16x16x32_bf16 v[112:115], v[232:235], a[248:251], v[112:115]
    ds_read_b64_tr_b16 v[228:229], v33 offset:30720
    v_cvt_pk_bf16_f32 v18, 0, v188
    v_cvt_pk_bf16_f32 v19, 0, v189
    v_mfma_f32_16x16x32_bf16 v[116:119], v[236:239], a[248:251], v[116:119]
    v_exp_f32 v16, v16
    v_mfma_f32_16x16x32_bf16 v[120:123], v[232:235], a[252:255], v[120:123]
    ds_read_b64_tr_b16 v[230:231], v33 offset:30976
    v_add_f32 v16, 1.0, v16
    v_mfma_f32_16x16x32_bf16 v[124:127], v[236:239], a[252:255], v[124:127]
    s_waitcnt lgkmcnt(4)
    v_exp_f32 v17, v17
    v_mfma_f32_16x16x32_bf16 v[96:99], v[12:15], a[112:115], v[96:99]
    ds_read_b64_tr_b16 v[232:233], v2 offset:32768
    v_add_f32 v17, 1.0, v17
    v_cvt_pk_bf16_f32 v28, 0, v158
    v_mfma_f32_16x16x32_bf16 v[100:103], v[36:39], a[112:115], v[100:103]
    v_rcp_f32 v16, v16
    v_mfma_f32_16x16x32_bf16 v[104:107], v[12:15], a[116:119], v[104:107]
    ds_read_b64_tr_b16 v[234:235], v2 offset:33024
    v_mul_f32 v16, v16, v20
    v_mfma_f32_16x16x32_bf16 v[108:111], v[36:39], a[116:119], v[108:111]
    v_rcp_f32 v17, v17
    v_mfma_f32_16x16x32_bf16 v[112:115], v[12:15], v[192:195], v[112:115]
    ds_read_b64_tr_b16 v[236:237], v33 offset:32768
    v_mul_f32 v17, v17, v21
    v_cvt_pk_bf16_f32 v16, 0, v16
    v_mfma_f32_16x16x32_bf16 v[116:119], v[36:39], v[192:195], v[116:119]
    v_cvt_pk_bf16_f32 v17, 0, v17
    v_mul_f32 v16, v16, v18
    v_mfma_f32_16x16x32_bf16 v[120:123], v[12:15], v[196:199], v[120:123]
    ds_read_b64_tr_b16 v[238:239], v33 offset:33024
    v_mul_f32 v17, v17, v19
    v_mfma_f32_16x16x32_bf16 v[124:127], v[36:39], v[196:199], v[124:127]
    s_waitcnt lgkmcnt(4)
    v_cvt_pk_bf16_f32 v46, v16, v17
    v_cvt_pk_bf16_f32 v29, 0, v159
    v_mfma_f32_16x16x32_bf16 v[96:99], v[224:227], a[120:123], v[96:99]
    ds_read_b64_tr_b16 v[12:13], v2 offset:34816
    v_mul_f32 v24, v28, v28
    v_mul_f32 v25, v29, v29
    v_mfma_f32_16x16x32_bf16 v[100:103], v[228:231], a[120:123], v[100:103]
    v_fma_f32 v24, v24, v11, v10
    v_fma_f32 v25, v25, v11, v10
    v_mfma_f32_16x16x32_bf16 v[104:107], v[224:227], a[124:127], v[104:107]
    ds_read_b64_tr_b16 v[14:15], v2 offset:35072
    v_mul_f32 v24, v24, v28
    v_mfma_f32_16x16x32_bf16 v[108:111], v[228:231], a[124:127], v[108:111]
    v_mul_f32 v25, v25, v29
    v_cvt_pk_bf16_f32 v26, 0, v190
    v_mfma_f32_16x16x32_bf16 v[112:115], v[224:227], v[200:203], v[112:115]
    ds_read_b64_tr_b16 v[36:37], v33 offset:34816
    v_cvt_pk_bf16_f32 v27, 0, v191
    v_exp_f32 v24, v24
    v_mfma_f32_16x16x32_bf16 v[116:119], v[228:231], v[200:203], v[116:119]
    v_exp_f32 v25, v25
    v_mfma_f32_16x16x32_bf16 v[120:123], v[224:227], v[204:207], v[120:123]
    ds_read_b64_tr_b16 v[38:39], v33 offset:35072
    v_add_f32 v24, 1.0, v24
    v_mfma_f32_16x16x32_bf16 v[124:127], v[228:231], v[204:207], v[124:127]
    s_waitcnt lgkmcnt(4)
    v_add_f32 v25, 1.0, v25
    s_waitcnt vmcnt(18)
    s_barrier
    v_mfma_f32_16x16x32_bf16 v[96:99], v[232:235], a[128:131], v[96:99]
    ds_read_b64_tr_b16 v[224:225], v3 offset:0
    v_rcp_f32 v24, v24
    v_mfma_f32_16x16x32_bf16 v[100:103], v[236:239], a[128:131], v[100:103]
    s_cmp_eq_u32 s53, 0
    s_cbranch_scc1 L_k1_nope
    v_and_b32 v246, 15, v0
    v_lshlrev_b32 v246, 7, v246
    s_bfe_u32 s79, s2, 0x20001
    s_lshl_b32 s79, s79, 2
    s_add_u32 s79, s79, s28
    s_lshl_b32 s79, s79, 11
    s_add_u32 s79, s79, 65536
    buffer_load_dwordx2 v[244:245], v246, s[64:67], s79 offen sc1
L_k1_nope:
    v_mfma_f32_16x16x32_bf16 v[104:107], v[232:235], a[132:135], v[104:107]
    ds_read_b64_tr_b16 v[226:227], v3 offset:256
    v_mul_f32 v24, v24, v28
    v_mfma_f32_16x16x32_bf16 v[108:111], v[236:239], a[132:135], v[108:111]
    v_rcp_f32 v25, v25
    v_mfma_f32_16x16x32_bf16 v[112:115], v[232:235], v[208:211], v[112:115]
    ds_read_b64_tr_b16 v[228:229], v34 offset:0
    v_mul_f32 v25, v25, v29
    v_mfma_f32_16x16x32_bf16 v[116:119], v[236:239], v[208:211], v[116:119]
    v_cvt_pk_bf16_f32 v24, 0, v24
    v_cvt_pk_bf16_f32 v25, 0, v25
    v_mfma_f32_16x16x32_bf16 v[120:123], v[232:235], v[212:215], v[120:123]
    ds_read_b64_tr_b16 v[230:231], v34 offset:256
    v_mul_f32 v24, v24, v26
    v_mfma_f32_16x16x32_bf16 v[124:127], v[236:239], v[212:215], v[124:127]
    s_waitcnt lgkmcnt(4)
    v_mul_f32 v25, v25, v27
    v_cvt_pk_bf16_f32 v47, v24, v25
    v_mfma_f32_16x16x32_bf16 v[96:99], v[12:15], a[136:139], v[96:99]
    ds_read_b64_tr_b16 v[232:233], v3 offset:2048
    v_mfma_f32_16x16x32_bf16 v[100:103], v[36:39], a[136:139], v[100:103]
    buffer_store_dwordx4 v[44:47], v7, s[20:23], s39 offen offset:3072 sc0 sc1
    v_mfma_f32_16x16x32_bf16 v[104:107], v[12:15], a[140:143], v[104:107]
    s_add_u32 s39, s39, s33
    ds_read_b64_tr_b16 v[234:235], v3 offset:2304
    v_mfma_f32_16x16x32_bf16 v[108:111], v[36:39], a[140:143], v[108:111]
    v_mfma_f32_16x16x32_bf16 v[112:115], v[12:15], v[216:219], v[112:115]
    ds_read_b64_tr_b16 v[236:237], v34 offset:2048
    v_mfma_f32_16x16x32_bf16 v[116:119], v[36:39], v[216:219], v[116:119]
    v_mfma_f32_16x16x32_bf16 v[120:123], v[12:15], v[220:223], v[120:123]
    ds_read_b64_tr_b16 v[238:239], v34 offset:2304
    v_mfma_f32_16x16x32_bf16 v[124:127], v[36:39], v[220:223], v[124:127]
    s_cmp_lg_u32 s53, 0
    s_cbranch_scc1 L_k1_tail
    s_waitcnt lgkmcnt(4)
    v_mfma_f32_16x16x32_bf16 v[128:131], v[224:227], a[0:3], 0
    ds_read_b64_tr_b16 v[12:13], v3 offset:4096
    v_mfma_f32_16x16x32_bf16 v[132:135], v[228:231], a[0:3], 0
    s_add_u32 m0, s38, 0
    v_mfma_f32_16x16x32_bf16 v[136:139], v[224:227], a[4:7], 0
    ds_read_b64_tr_b16 v[14:15], v3 offset:4352
    v_mfma_f32_16x16x32_bf16 v[140:143], v[228:231], a[4:7], 0
    v_mfma_f32_16x16x32_bf16 v[144:147], v[224:227], a[144:147], 0
    ds_read_b64_tr_b16 v[36:37], v34 offset:4096
    v_cvt_pk_bf16_f32 v20, 0, v64
    v_cvt_pk_bf16_f32 v21, 0, v65
    v_mfma_f32_16x16x32_bf16 v[148:151], v[228:231], a[144:147], 0
    v_mul_f32 v16, v20, v20
    v_mul_f32 v17, v21, v21
    v_fma_f32 v16, v16, v11, v10
    v_mfma_f32_16x16x32_bf16 v[152:155], v[224:227], a[148:151], 0
    ds_read_b64_tr_b16 v[38:39], v34 offset:4352
    v_fma_f32 v17, v17, v11, v10
    v_mul_f32 v16, v16, v20
    v_mfma_f32_16x16x32_bf16 v[156:159], v[228:231], a[148:151], 0
    s_waitcnt lgkmcnt(4)
    v_mul_f32 v17, v17, v21
    v_cvt_pk_bf16_f32 v18, 0, v96
    v_cvt_pk_bf16_f32 v19, 0, v97
    v_mfma_f32_16x16x32_bf16 v[128:131], v[232:235], a[8:11], v[128:131]
    ds_read_b64_tr_b16 v[224:225], v3 offset:6144
    v_exp_f32 v16, v16
    v_mfma_f32_16x16x32_bf16 v[132:135], v[236:239], a[8:11], v[132:135]
    buffer_load_dwordx4 v253, s[60:63], s48 offen lds
    v_add_f32 v16, 1.0, v16
    v_cvt_pk_bf16_f32 v28, 0, v66
    v_mfma_f32_16x16x32_bf16 v[136:139], v[232:235], a[12:15], v[136:139]
    s_add_u32 m0, m0, 4096
    ds_read_b64_tr_b16 v[226:227], v3 offset:6400
    v_cvt_pk_bf16_f32 v29, 0, v67
    v_mul_f32 v24, v28, v28
    v_mfma_f32_16x16x32_bf16 v[140:143], v[236:239], a[12:15], v[140:143]
    s_add_u32 s48, s48, s51
    v_exp_f32 v17, v17
    v_mfma_f32_16x16x32_bf16 v[144:147], v[232:235], a[152:155], v[144:147]
    ds_read_b64_tr_b16 v[228:229], v34 offset:6144
    v_add_f32 v17, 1.0, v17
    v_mfma_f32_16x16x32_bf16 v[148:151], v[236:239], a[152:155], v[148:151]
    s_waitcnt vmcnt(16)
    ds_read_b64_tr_b16 v[244:245], v248 offset:2048
    v_mul_f32 v25, v29, v29
    v_mfma_f32_16x16x32_bf16 v[152:155], v[232:235], a[156:159], v[152:155]
    ds_read_b64_tr_b16 v[230:231], v34 offset:6400
    v_fma_f32 v24, v24, v11, v10
    v_mfma_f32_16x16x32_bf16 v[156:159], v[236:239], a[156:159], v[156:159]
    s_waitcnt lgkmcnt(4)
    ds_read_b64_tr_b16 v[246:247], v248 offset:3072
    v_fma_f32 v25, v25, v11, v10
    v_mfma_f32_16x16x32_bf16 v[128:131], v[12:15], a[16:19], v[128:131]
    ds_read_b64_tr_b16 v[232:233], v3 offset:8192
    v_mul_f32 v24, v24, v28
    v_mul_f32 v25, v25, v29
    v_mfma_f32_16x16x32_bf16 v[132:135], v[36:39], a[16:19], v[132:135]
    v_rcp_f32 v16, v16
    v_mfma_f32_16x16x32_bf16 v[136:139], v[12:15], a[20:23], v[136:139]
    ds_read_b64_tr_b16 v[234:235], v3 offset:8448
    v_mul_f32 v16, v16, v20
    v_mfma_f32_16x16x32_bf16 v[140:143], v[36:39], a[20:23], v[140:143]
    buffer_load_dwordx4 v253, s[60:63], s48 offen lds
    v_cvt_pk_bf16_f32 v16, 0, v16
    v_mfma_f32_16x16x32_bf16 v[144:147], v[12:15], a[160:163], v[144:147]
    s_add_u32 m0, m0, 4096
    ds_read_b64_tr_b16 v[236:237], v34 offset:8192
    v_mul_f32 v16, v16, v18
    v_mfma_f32_16x16x32_bf16 v[148:151], v[36:39], a[160:163], v[148:151]
    s_add_u32 s48, s48, s51
    v_rcp_f32 v17, v17
    v_cvt_pk_bf16_f32 v26, 0, v98
    v_mfma_f32_16x16x32_bf16 v[152:155], v[12:15], a[164:167], v[152:155]
    ds_read_b64_tr_b16 v[238:239], v34 offset:8448
    v_mul_f32 v17, v17, v21
    v_mfma_f32_16x16x32_bf16 v[156:159], v[36:39], a[164:167], v[156:159]
    s_waitcnt lgkmcnt(4)
    v_cvt_pk_bf16_f32 v17, 0, v17
    v_mul_f32 v17, v17, v19
    v_mfma_f32_16x16x32_bf16 v[128:131], v[224:227], a[24:27], v[128:131]
    ds_read_b64_tr_b16 v[12:13], v3 offset:10240
    v_cvt_pk_bf16_f32 v40, v16, v17
    v_mfma_f32_16x16x32_bf16 v[132:135], v[228:231], a[24:27], v[132:135]
    v_exp_f32 v24, v24
    v_mfma_f32_16x16x32_bf16 v[136:139], v[224:227], a[28:31], v[136:139]
    ds_read_b64_tr_b16 v[14:15], v3 offset:10496
    v_add_f32 v24, 1.0, v24
    v_cvt_pk_bf16_f32 v27, 0, v99
    v_mfma_f32_16x16x32_bf16 v[140:143], v[228:231], a[28:31], v[140:143]
    buffer_store_dwordx4 v[244:247], v249, s[12:15], s8 offen offset:0 sc0 sc1
    v_cvt_pk_bf16_f32 v20, 0, v68
    v_mfma_f32_16x16x32_bf16 v[144:147], v[224:227], a[168:171], v[144:147]
    ds_read_b64_tr_b16 v[36:37], v34 offset:10240
    v_cvt_pk_bf16_f32 v21, 0, v69
    v_mfma_f32_16x16x32_bf16 v[148:151], v[228:231], a[168:171], v[148:151]
    buffer_load_dwordx4 v253, s[60:63], s48 offen lds
    v_mul_f32 v16, v20, v20
    v_mfma_f32_16x16x32_bf16 v[152:155], v[224:227], a[172:175], v[152:155]
    s_add_u32 m0, m0, 4096
    ds_read_b64_tr_b16 v[38:39], v34 offset:10496
    v_mul_f32 v17, v21, v21
    v_mfma_f32_16x16x32_bf16 v[156:159], v[228:231], a[172:175], v[156:159]
    s_waitcnt lgkmcnt(4)
    v_exp_f32 v25, v25
    v_mfma_f32_16x16x32_bf16 v[128:131], v[232:235], a[32:35], v[128:131]
    s_add_u32 s48, s48, s51
    ds_read_b64_tr_b16 v[224:225], v3 offset:12288
    v_add_f32 v25, 1.0, v25
    v_fma_f32 v16, v16, v11, v10
    v_mfma_f32_16x16x32_bf16 v[132:135], v[236:239], a[32:35], v[132:135]
    v_rcp_f32 v24, v24
    v_mfma_f32_16x16x32_bf16 v[136:139], v[232:235], a[36:39], v[136:139]
    ds_read_b64_tr_b16 v[226:227], v3 offset:12544
    v_mul_f32 v24, v24, v28
    v_mfma_f32_16x16x32_bf16 v[140:143], v[236:239], a[36:39], v[140:143]
    v_rcp_f32 v25, v25
    v_mfma_f32_16x16x32_bf16 v[144:147], v[232:235], a[176:179], v[144:147]
    ds_read_b64_tr_b16 v[228:229], v34 offset:12288
    v_mul_f32 v25, v25, v29
    v_mfma_f32_16x16x32_bf16 v[148:151], v[236:239], a[176:179], v[148:151]
    ds_read_b64_tr_b16 v[244:245], v248 offset:2112
    v_cvt_pk_bf16_f32 v24, 0, v24
    v_cvt_pk_bf16_f32 v25, 0, v25
    v_mfma_f32_16x16x32_bf16 v[152:155], v[232:235], a[180:183], v[152:155]
    ds_read_b64_tr_b16 v[230:231], v34 offset:12544
    v_mul_f32 v24, v24, v26
    v_mfma_f32_16x16x32_bf16 v[156:159], v[236:239], a[180:183], v[156:159]
    s_waitcnt lgkmcnt(4)
    ds_read_b64_tr_b16 v[246:247], v248 offset:3136
    v_mul_f32 v25, v25, v27
    v_mfma_f32_16x16x32_bf16 v[128:131], v[12:15], a[40:43], v[128:131]
    ds_read_b64_tr_b16 v[232:233], v3 offset:14336
    v_cvt_pk_bf16_f32 v41, v24, v25
    v_mfma_f32_16x16x32_bf16 v[132:135], v[36:39], a[40:43], v[132:135]
    buffer_load_dwordx4 v253, s[60:63], s48 offen lds
    v_fma_f32 v17, v17, v11, v10
    v_mfma_f32_16x16x32_bf16 v[136:139], v[12:15], a[44:47], v[136:139]
    s_add_u32 m0, m0, 4096
    ds_read_b64_tr_b16 v[234:235], v3 offset:14592
    v_mul_f32 v16, v16, v20
    v_mfma_f32_16x16x32_bf16 v[140:143], v[36:39], a[44:47], v[140:143]
    s_add_u32 s48, s48, s51
    v_mul_f32 v17, v17, v21
    v_cvt_pk_bf16_f32 v18, 0, v100
    v_cvt_pk_bf16_f32 v19, 0, v101
    v_mfma_f32_16x16x32_bf16 v[144:147], v[12:15], a[184:187], v[144:147]
    ds_read_b64_tr_b16 v[236:237], v34 offset:14336
    v_exp_f32 v16, v16
    v_mfma_f32_16x16x32_bf16 v[148:151], v[36:39], a[184:187], v[148:151]
    v_exp_f32 v17, v17
    v_mfma_f32_16x16x32_bf16 v[152:155], v[12:15], a[188:191], v[152:155]
    ds_read_b64_tr_b16 v[238:239], v34 offset:14592
    v_add_f32 v16, 1.0, v16
    v_mfma_f32_16x16x32_bf16 v[156:159], v[36:39], a[188:191], v[156:159]
    s_waitcnt lgkmcnt(4)
    v_add_f32 v17, 1.0, v17
    v_cvt_pk_bf16_f32 v28, 0, v70
    v_mfma_f32_16x16x32_bf16 v[128:131], v[224:227], a[48:51], v[128:131]
    ds_read_b64_tr_b16 v[12:13], v3 offset:16384
    v_cvt_pk_bf16_f32 v29, 0, v71
    v_mfma_f32_16x16x32_bf16 v[132:135], v[228:231], a[48:51], v[132:135]
    buffer_load_dwordx4 v253, s[60:63], s48 offen lds
    v_mul_f32 v24, v28, v28
    v_mfma_f32_16x16x32_bf16 v[136:139], v[224:227], a[52:55], v[136:139]
    s_add_u32 m0, m0, 4096
    ds_read_b64_tr_b16 v[14:15], v3 offset:16640
    v_mul_f32 v25, v29, v29
    v_mfma_f32_16x16x32_bf16 v[140:143], v[228:231], a[52:55], v[140:143]
    s_add_u32 s48, s48, s51
    buffer_store_dwordx4 v[244:247], v249, s[12:15], s8 offen offset:2048 sc0 sc1
    v_fma_f32 v24, v24, v11, v10
    v_mfma_f32_16x16x32_bf16 v[144:147], v[224:227], a[192:195], v[144:147]
    s_add_u32 s8, s8, 4096
    ds_read_b64_tr_b16 v[36:37], v34 offset:16384
    v_fma_f32 v25, v25, v11, v10
    v_mfma_f32_16x16x32_bf16 v[148:151], v[228:231], a[192:195], v[148:151]
    v_rcp_f32 v16, v16
    v_mul_f32 v24, v24, v28
    v_mfma_f32_16x16x32_bf16 v[152:155], v[224:227], a[196:199], v[152:155]
    ds_read_b64_tr_b16 v[38:39], v34 offset:16640
    v_mul_f32 v16, v16, v20
    v_mfma_f32_16x16x32_bf16 v[156:159], v[228:231], a[196:199], v[156:159]
    s_waitcnt lgkmcnt(4)
    v_rcp_f32 v17, v17
    v_mfma_f32_16x16x32_bf16 v[128:131], v[232:235], a[56:59], v[128:131]
    ds_read_b64_tr_b16 v[224:225], v3 offset:18432
    v_mul_f32 v17, v17, v21
    v_mfma_f32_16x16x32_bf16 v[132:135], v[236:239], a[56:59], v[132:135]
    v_cvt_pk_bf16_f32 v16, 0, v16
    v_cvt_pk_bf16_f32 v17, 0, v17
    v_mfma_f32_16x16x32_bf16 v[136:139], v[232:235], a[60:63], v[136:139]
    ds_read_b64_tr_b16 v[226:227], v3 offset:18688
    v_mul_f32 v16, v16, v18
    v_mfma_f32_16x16x32_bf16 v[140:143], v[236:239], a[60:63], v[140:143]
    buffer_load_dwordx4 v253, s[60:63], s48 offen lds
    v_mul_f32 v17, v17, v19
    v_cvt_pk_bf16_f32 v42, v16, v17
    v_mfma_f32_16x16x32_bf16 v[144:147], v[232:235], a[200:203], v[144:147]
    s_add_u32 m0, m0, 4096
    ds_read_b64_tr_b16 v[228:229], v34 offset:18432
    v_mul_f32 v25, v25, v29
    v_mfma_f32_16x16x32_bf16 v[148:151], v[236:239], a[200:203], v[148:151]
    s_add_u32 s48, s48, s51
    v_exp_f32 v24, v24
    v_mfma_f32_16x16x32_bf16 v[152:155], v[232:235], a[204:207], v[152:155]
    ds_read_b64_tr_b16 v[230:231], v34 offset:18688
    v_cvt_pk_bf16_f32 v26, 0, v102
    v_mfma_f32_16x16x32_bf16 v[156:159], v[236:239], a[204:207], v[156:159]
    s_waitcnt lgkmcnt(4)
    v_exp_f32 v25, v25
    v_mfma_f32_16x16x32_bf16 v[128:131], v[12:15], a[64:67], v[128:131]
    ds_read_b64_tr_b16 v[232:233], v3 offset:20480
    v_add_f32 v24, 1.0, v24
    v_add_f32 v25, 1.0, v25
    v_mfma_f32_16x16x32_bf16 v[132:135], v[36:39], a[64:67], v[132:135]
    v_rcp_f32 v24, v24
    v_mfma_f32_16x16x32_bf16 v[136:139], v[12:15], a[68:71], v[136:139]
    ds_read_b64_tr_b16 v[234:235], v3 offset:20736
    v_cvt_pk_bf16_f32 v27, 0, v103
    v_mfma_f32_16x16x32_bf16 v[140:143], v[36:39], a[68:71], v[140:143]
    v_rcp_f32 v25, v25
    v_mfma_f32_16x16x32_bf16 v[144:147], v[12:15], a[208:211], v[144:147]
    ds_read_b64_tr_b16 v[236:237], v34 offset:20480
    v_mul_f32 v24, v24, v28
    v_mfma_f32_16x16x32_bf16 v[148:151], v[36:39], a[208:211], v[148:151]
    buffer_load_dwordx4 v253, s[60:63], s48 offen lds
    v_mul_f32 v25, v25, v29
    v_mfma_f32_16x16x32_bf16 v[152:155], v[12:15], a[212:215], v[152:155]
    s_add_u32 m0, m0, 4096
    ds_read_b64_tr_b16 v[238:239], v34 offset:20736
    v_cvt_pk_bf16_f32 v24, 0, v24
    v_cvt_pk_bf16_f32 v25, 0, v25
    v_mfma_f32_16x16x32_bf16 v[156:159], v[36:39], a[212:215], v[156:159]
    s_waitcnt lgkmcnt(4)
    v_mul_f32 v24, v24, v26
    v_mul_f32 v25, v25, v27
    v_mfma_f32_16x16x32_bf16 v[128:131], v[224:227], a[72:75], v[128:131]
    s_add_u32 s48, s48, s51
    ds_read_b64_tr_b16 v[12:13], v3 offset:22528
    v_cvt_pk_bf16_f32 v43, v24, v25
    v_mfma_f32_16x16x32_bf16 v[132:135], v[228:231], a[72:75], v[132:135]
    buffer_store_dwordx4 v[40:43], v7, s[20:23], s39 offen offset:0 sc0 sc1
    v_cvt_pk_bf16_f32 v20, 0, v72
    v_mfma_f32_16x16x32_bf16 v[136:139], v[224:227], a[76:79], v[136:139]
    ds_read_b64_tr_b16 v[14:15], v3 offset:22784
    v_cvt_pk_bf16_f32 v21, 0, v73
    v_mfma_f32_16x16x32_bf16 v[140:143], v[228:231], a[76:79], v[140:143]
    v_mul_f32 v16, v20, v20
    v_mul_f32 v17, v21, v21
    v_fma_f32 v16, v16, v11, v10
    v_mfma_f32_16x16x32_bf16 v[144:147], v[224:227], a[216:219], v[144:147]
    ds_read_b64_tr_b16 v[36:37], v34 offset:22528
    v_fma_f32 v17, v17, v11, v10
    v_mfma_f32_16x16x32_bf16 v[148:151], v[228:231], a[216:219], v[148:151]
    v_mul_f32 v16, v16, v20
    v_mul_f32 v17, v17, v21
    v_mfma_f32_16x16x32_bf16 v[152:155], v[224:227], a[220:223], v[152:155]
    ds_read_b64_tr_b16 v[38:39], v34 offset:22784
    v_cvt_pk_bf16_f32 v18, 0, v104
    v_mfma_f32_16x16x32_bf16 v[156:159], v[228:231], a[220:223], v[156:159]
    s_waitcnt lgkmcnt(4)
    buffer_load_dwordx4 v253, s[60:63], s48 offen lds
    v_cvt_pk_bf16_f32 v19, 0, v105
    v_mfma_f32_16x16x32_bf16 v[128:131], v[232:235], a[80:83], v[128:131]
    s_add_u32 m0, m0, 4096
    ds_read_b64_tr_b16 v[224:225], v3 offset:24576
    v_exp_f32 v16, v16
    v_mfma_f32_16x16x32_bf16 v[132:135], v[236:239], a[80:83], v[132:135]
    s_add_u32 s48, s48, s51
    v_exp_f32 v17, v17
    v_mfma_f32_16x16x32_bf16 v[136:139], v[232:235], a[84:87], v[136:139]
    ds_read_b64_tr_b16 v[226:227], v3 offset:24832
    v_add_f32 v16, 1.0, v16
    v_mfma_f32_16x16x32_bf16 v[140:143], v[236:239], a[84:87], v[140:143]
    v_add_f32 v17, 1.0, v17
    v_cvt_pk_bf16_f32 v28, 0, v74
    v_mfma_f32_16x16x32_bf16 v[144:147], v[232:235], a[224:227], v[144:147]
    ds_read_b64_tr_b16 v[228:229], v34 offset:24576
    v_cvt_pk_bf16_f32 v29, 0, v75
    v_mfma_f32_16x16x32_bf16 v[148:151], v[236:239], a[224:227], v[148:151]
    v_rcp_f32 v16, v16
    v_mfma_f32_16x16x32_bf16 v[152:155], v[232:235], a[228:231], v[152:155]
    ds_read_b64_tr_b16 v[230:231], v34 offset:24832
    v_mul_f32 v16, v16, v20
    v_cvt_pk_bf16_f32 v16, 0, v16
    v_mfma_f32_16x16x32_bf16 v[156:159], v[236:239], a[228:231], v[156:159]
    s_waitcnt lgkmcnt(4)
    v_rcp_f32 v17, v17
    v_mfma_f32_16x16x32_bf16 v[128:131], v[12:15], a[88:91], v[128:131]
    ds_read_b64_tr_b16 v[232:233], v3 offset:26624
    v_mul_f32 v17, v17, v21
    v_mfma_f32_16x16x32_bf16 v[132:135], v[36:39], a[88:91], v[132:135]
    buffer_load_dwordx4 v253, s[60:63], s48 offen lds
    v_cvt_pk_bf16_f32 v17, 0, v17
    v_mfma_f32_16x16x32_bf16 v[136:139], v[12:15], a[92:95], v[136:139]
    s_add_u32 m0, m0, 4096
    ds_read_b64_tr_b16 v[234:235], v3 offset:26880
    v_mul_f32 v16, v16, v18
    v_mfma_f32_16x16x32_bf16 v[140:143], v[36:39], a[92:95], v[140:143]
    s_add_u32 s48, s48, s51
    v_mul_f32 v17, v17, v19
    v_cvt_pk_bf16_f32 v44, v16, v17
    v_mul_f32 v24, v28, v28
    v_mfma_f32_16x16x32_bf16 v[144:147], v[12:15], a[232:235], v[144:147]
    ds_read_b64_tr_b16 v[236:237], v34 offset:26624
    v_mul_f32 v25, v29, v29
    v_mfma_f32_16x16x32_bf16 v[148:151], v[36:39], a[232:235], v[148:151]
    v_fma_f32 v24, v24, v11, v10
    v_fma_f32 v25, v25, v11, v10
    v_mfma_f32_16x16x32_bf16 v[152:155], v[12:15], a[236:239], v[152:155]
    ds_read_b64_tr_b16 v[238:239], v34 offset:26880
    v_mul_f32 v24, v24, v28
    v_mfma_f32_16x16x32_bf16 v[156:159], v[36:39], a[236:239], v[156:159]
    s_waitcnt lgkmcnt(4)
    v_mul_f32 v25, v25, v29
    v_cvt_pk_bf16_f32 v26, 0, v106
    v_mfma_f32_16x16x32_bf16 v[128:131], v[224:227], a[96:99], v[128:131]
    ds_read_b64_tr_b16 v[12:13], v3 offset:28672
    v_cvt_pk_bf16_f32 v27, 0, v107
    v_exp_f32 v24, v24
    v_mfma_f32_16x16x32_bf16 v[132:135], v[228:231], a[96:99], v[132:135]
    s_mov_b32 s24, s80
    v_exp_f32 v25, v25
    v_mfma_f32_16x16x32_bf16 v[136:139], v[224:227], a[100:103], v[136:139]
    s_mov_b32 s25, s81
    ds_read_b64_tr_b16 v[14:15], v3 offset:28928
    v_add_f32 v24, 1.0, v24
    v_mfma_f32_16x16x32_bf16 v[140:143], v[228:231], a[100:103], v[140:143]
    s_mov_b32 s26, s55
    v_add_f32 v25, 1.0, v25
    v_cvt_pk_bf16_f32 v20, 0, v76
    v_mfma_f32_16x16x32_bf16 v[144:147], v[224:227], a[240:243], v[144:147]
    s_mov_b32 s46, s54
    ds_read_b64_tr_b16 v[36:37], v34 offset:28672
    v_cvt_pk_bf16_f32 v21, 0, v77
    v_mfma_f32_16x16x32_bf16 v[148:151], v[228:231], a[240:243], v[148:151]
    s_mov_b32 s50, s36
    v_mov_b32 v252, v5
    v_mul_f32 v16, v20, v20
    v_mfma_f32_16x16x32_bf16 v[152:155], v[224:227], a[244:247], v[152:155]
    ds_read_b64_tr_b16 v[38:39], v34 offset:28928
    v_mul_f32 v17, v21, v21
    v_mfma_f32_16x16x32_bf16 v[156:159], v[228:231], a[244:247], v[156:159]
    s_waitcnt lgkmcnt(4)
    v_rcp_f32 v24, v24
    v_mfma_f32_16x16x32_bf16 v[128:131], v[232:235], a[104:107], v[128:131]
    s_mov_b32 s90, 0
    ds_read_b64_tr_b16 v[224:225], v3 offset:30720
    v_mul_f32 v24, v24, v28
    v_mfma_f32_16x16x32_bf16 v[132:135], v[236:239], a[104:107], v[132:135]
    s_mov_b32 s53, 1
    v_rcp_f32 v25, v25
    v_mfma_f32_16x16x32_bf16 v[136:139], v[232:235], a[108:111], v[136:139]
    s_mov_b32 s70, 0
    ds_read_b64_tr_b16 v[226:227], v3 offset:30976
    v_mul_f32 v25, v25, v29
    v_mfma_f32_16x16x32_bf16 v[140:143], v[236:239], a[108:111], v[140:143]
    v_cvt_pk_bf16_f32 v24, 0, v24
    v_cvt_pk_bf16_f32 v25, 0, v25
    v_mul_f32 v24, v24, v26
    v_mfma_f32_16x16x32_bf16 v[144:147], v[232:235], a[248:251], v[144:147]
    ds_read_b64_tr_b16 v[228:229], v34 offset:30720
    v_mul_f32 v25, v25, v27
    v_mfma_f32_16x16x32_bf16 v[148:151], v[236:239], a[248:251], v[148:151]
    v_cvt_pk_bf16_f32 v45, v24, v25
    v_fma_f32 v16, v16, v11, v10
    v_mfma_f32_16x16x32_bf16 v[152:155], v[232:235], a[252:255], v[152:155]
    ds_read_b64_tr_b16 v[230:231], v34 offset:30976
    v_fma_f32 v17, v17, v11, v10
    v_mfma_f32_16x16x32_bf16 v[156:159], v[236:239], a[252:255], v[156:159]
    s_waitcnt lgkmcnt(4)
    v_mul_f32 v16, v16, v20
    v_mul_f32 v17, v17, v21
    v_mfma_f32_16x16x32_bf16 v[128:131], v[12:15], a[112:115], v[128:131]
    ds_read_b64_tr_b16 v[232:233], v3 offset:32768
    v_cvt_pk_bf16_f32 v18, 0, v108
    v_mfma_f32_16x16x32_bf16 v[132:135], v[36:39], a[112:115], v[132:135]
    v_exp_f32 v16, v16
    v_cvt_pk_bf16_f32 v19, 0, v109
    v_mfma_f32_16x16x32_bf16 v[136:139], v[12:15], a[116:119], v[136:139]
    ds_read_b64_tr_b16 v[234:235], v3 offset:33024
    v_add_f32 v16, 1.0, v16
    v_mfma_f32_16x16x32_bf16 v[140:143], v[36:39], a[116:119], v[140:143]
    v_exp_f32 v17, v17
    v_mfma_f32_16x16x32_bf16 v[144:147], v[12:15], v[192:195], v[144:147]
    ds_read_b64_tr_b16 v[236:237], v34 offset:32768
    v_add_f32 v17, 1.0, v17
    v_mfma_f32_16x16x32_bf16 v[148:151], v[36:39], v[192:195], v[148:151]
    v_rcp_f32 v16, v16
    v_mfma_f32_16x16x32_bf16 v[152:155], v[12:15], v[196:199], v[152:155]
    ds_read_b64_tr_b16 v[238:239], v34 offset:33024
    v_mul_f32 v16, v16, v20
    v_cvt_pk_bf16_f32 v16, 0, v16
    v_mfma_f32_16x16x32_bf16 v[156:159], v[36:39], v[196:199], v[156:159]
    s_waitcnt lgkmcnt(4)
    v_rcp_f32 v17, v17
    v_mfma_f32_16x16x32_bf16 v[128:131], v[224:227], a[120:123], v[128:131]
    ds_read_b64_tr_b16 v[12:13], v3 offset:34816
    v_mul_f32 v17, v17, v21
    v_mfma_f32_16x16x32_bf16 v[132:135], v[228:231], a[120:123], v[132:135]
    v_cvt_pk_bf16_f32 v17, 0, v17
    v_mul_f32 v16, v16, v18
    v_mfma_f32_16x16x32_bf16 v[136:139], v[224:227], a[124:127], v[136:139]
    ds_read_b64_tr_b16 v[14:15], v3 offset:35072
    v_mul_f32 v17, v17, v19
    v_mfma_f32_16x16x32_bf16 v[140:143], v[228:231], a[124:127], v[140:143]
    v_cvt_pk_bf16_f32 v46, v16, v17
    v_cvt_pk_bf16_f32 v28, 0, v78
    v_cvt_pk_bf16_f32 v29, 0, v79
    v_mfma_f32_16x16x32_bf16 v[144:147], v[224:227], v[200:203], v[144:147]
    ds_read_b64_tr_b16 v[36:37], v34 offset:34816
    v_mul_f32 v24, v28, v28
    v_mfma_f32_16x16x32_bf16 v[148:151], v[228:231], v[200:203], v[148:151]
    v_mul_f32 v25, v29, v29
    v_fma_f32 v24, v24, v11, v10
    v_mfma_f32_16x16x32_bf16 v[152:155], v[224:227], v[204:207], v[152:155]
    ds_read_b64_tr_b16 v[38:39], v34 offset:35072
    v_fma_f32 v25, v25, v11, v10
    v_mfma_f32_16x16x32_bf16 v[156:159], v[228:231], v[204:207], v[156:159]
    s_waitcnt lgkmcnt(4)
    v_mul_f32 v24, v24, v28
    v_mul_f32 v25, v25, v29
    s_waitcnt vmcnt(15)
    s_barrier
    v_mfma_f32_16x16x32_bf16 v[128:131], v[232:235], a[128:131], v[128:131]
    ds_read_b64_tr_b16 v[224:225], v4 offset:0
    v_cvt_pk_bf16_f32 v26, 0, v110
    v_mfma_f32_16x16x32_bf16 v[132:135], v[236:239], a[128:131], v[132:135]
    v_exp_f32 v24, v24
    v_cvt_pk_bf16_f32 v27, 0, v111
    v_mfma_f32_16x16x32_bf16 v[136:139], v[232:235], a[132:135], v[136:139]
    ds_read_b64_tr_b16 v[226:227], v4 offset:256
    v_add_f32 v24, 1.0, v24
    v_mfma_f32_16x16x32_bf16 v[140:143], v[236:239], a[132:135], v[140:143]
    v_exp_f32 v25, v25
    v_mfma_f32_16x16x32_bf16 v[144:147], v[232:235], v[208:211], v[144:147]
    ds_read_b64_tr_b16 v[228:229], v35 offset:0
    v_add_f32 v25, 1.0, v25
    v_mfma_f32_16x16x32_bf16 v[148:151], v[236:239], v[208:211], v[148:151]
    v_rcp_f32 v24, v24
    v_mfma_f32_16x16x32_bf16 v[152:155], v[232:235], v[212:215], v[152:155]
    ds_read_b64_tr_b16 v[230:231], v35 offset:256
    v_mul_f32 v24, v24, v28
    v_cvt_pk_bf16_f32 v24, 0, v24
    v_mfma_f32_16x16x32_bf16 v[156:159], v[236:239], v[212:215], v[156:159]
    s_waitcnt lgkmcnt(4)
    v_rcp_f32 v25, v25
    v_mfma_f32_16x16x32_bf16 v[128:131], v[12:15], a[136:139], v[128:131]
    ds_read_b64_tr_b16 v[232:233], v4 offset:2048
    v_mul_f32 v25, v25, v29
    v_mfma_f32_16x16x32_bf16 v[132:135], v[36:39], a[136:139], v[132:135]
    v_cvt_pk_bf16_f32 v25, 0, v25
    v_mul_f32 v24, v24, v26
    v_mfma_f32_16x16x32_bf16 v[136:139], v[12:15], a[140:143], v[136:139]
    ds_read_b64_tr_b16 v[234:235], v4 offset:2304
    v_mul_f32 v25, v25, v27
    v_mfma_f32_16x16x32_bf16 v[140:143], v[36:39], a[140:143], v[140:143]
    v_cvt_pk_bf16_f32 v47, v24, v25
    v_mfma_f32_16x16x32_bf16 v[144:147], v[12:15], v[216:219], v[144:147]
    ds_read_b64_tr_b16 v[236:237], v35 offset:2048
    buffer_store_dwordx4 v[44:47], v7, s[20:23], s39 offen offset:1024 sc0 sc1
    v_mfma_f32_16x16x32_bf16 v[148:151], v[36:39], v[216:219], v[148:151]
    v_mfma_f32_16x16x32_bf16 v[152:155], v[12:15], v[220:223], v[152:155]
    ds_read_b64_tr_b16 v[238:239], v35 offset:2304
    v_mfma_f32_16x16x32_bf16 v[156:159], v[36:39], v[220:223], v[156:159]
    s_waitcnt lgkmcnt(4)
    v_mfma_f32_16x16x32_bf16 v[160:163], v[224:227], a[0:3], 0
    ds_read_b64_tr_b16 v[12:13], v4 offset:4096
    v_mfma_f32_16x16x32_bf16 v[164:167], v[228:231], a[0:3], 0
    s_add_u32 m0, s38, 36864
    v_mfma_f32_16x16x32_bf16 v[168:171], v[224:227], a[4:7], 0
    ds_read_b64_tr_b16 v[14:15], v4 offset:4352
    v_mfma_f32_16x16x32_bf16 v[172:175], v[228:231], a[4:7], 0
    v_mfma_f32_16x16x32_bf16 v[176:179], v[224:227], a[144:147], 0
    ds_read_b64_tr_b16 v[36:37], v35 offset:4096
    v_cvt_pk_bf16_f32 v20, 0, v80
    v_cvt_pk_bf16_f32 v21, 0, v81
    v_mfma_f32_16x16x32_bf16 v[180:183], v[228:231], a[144:147], 0
    v_mul_f32 v16, v20, v20
    v_mul_f32 v17, v21, v21
    v_fma_f32 v16, v16, v11, v10
    v_mfma_f32_16x16x32_bf16 v[184:187], v[224:227], a[148:151], 0
    ds_read_b64_tr_b16 v[38:39], v35 offset:4352
    v_fma_f32 v17, v17, v11, v10
    v_mul_f32 v16, v16, v20
    v_mfma_f32_16x16x32_bf16 v[188:191], v[228:231], a[148:151], 0
    s_waitcnt lgkmcnt(4)
    v_mul_f32 v17, v17, v21
    v_cvt_pk_bf16_f32 v18, 0, v112
    v_cvt_pk_bf16_f32 v19, 0, v113
    v_mfma_f32_16x16x32_bf16 v[160:163], v[232:235], a[8:11], v[160:163]
    ds_read_b64_tr_b16 v[224:225], v4 offset:6144
    v_exp_f32 v16, v16
    v_mfma_f32_16x16x32_bf16 v[164:167], v[236:239], a[8:11], v[164:167]
    buffer_load_dwordx4 v253, s[72:75], s49 offen lds
    v_add_f32 v16, 1.0, v16
    v_cvt_pk_bf16_f32 v28, 0, v82
    v_mfma_f32_16x16x32_bf16 v[168:171], v[232:235], a[12:15], v[168:171]
    s_add_u32 m0, m0, 4096
    ds_read_b64_tr_b16 v[226:227], v4 offset:6400
    v_cvt_pk_bf16_f32 v29, 0, v83
    v_mfma_f32_16x16x32_bf16 v[172:175], v[236:239], a[12:15], v[172:175]
    s_add_u32 s49, s49, s51
    v_exp_f32 v17, v17
    v_mul_f32 v24, v28, v28
    v_mfma_f32_16x16x32_bf16 v[176:179], v[232:235], a[152:155], v[176:179]
    ds_read_b64_tr_b16 v[228:229], v35 offset:6144
    v_add_f32 v17, 1.0, v17
    v_mfma_f32_16x16x32_bf16 v[180:183], v[236:239], a[152:155], v[180:183]
    s_waitcnt vmcnt(14)
    ds_read_b64_tr_b16 v[244:245], v248 offset:0
    v_mul_f32 v25, v29, v29
    v_mfma_f32_16x16x32_bf16 v[184:187], v[232:235], a[156:159], v[184:187]
    ds_read_b64_tr_b16 v[230:231], v35 offset:6400
    v_fma_f32 v24, v24, v11, v10
    v_mfma_f32_16x16x32_bf16 v[188:191], v[236:239], a[156:159], v[188:191]
    s_waitcnt lgkmcnt(4)
    ds_read_b64_tr_b16 v[246:247], v248 offset:1024
    v_fma_f32 v25, v25, v11, v10
    v_mfma_f32_16x16x32_bf16 v[160:163], v[12:15], a[16:19], v[160:163]
    ds_read_b64_tr_b16 v[232:233], v4 offset:8192
    v_mul_f32 v24, v24, v28
    v_mul_f32 v25, v25, v29
    v_mfma_f32_16x16x32_bf16 v[164:167], v[36:39], a[16:19], v[164:167]
    v_rcp_f32 v16, v16
    v_mfma_f32_16x16x32_bf16 v[168:171], v[12:15], a[20:23], v[168:171]
    ds_read_b64_tr_b16 v[234:235], v4 offset:8448
    v_mul_f32 v16, v16, v20
    v_mfma_f32_16x16x32_bf16 v[172:175], v[36:39], a[20:23], v[172:175]
    buffer_load_dwordx4 v253, s[72:75], s49 offen lds
    v_cvt_pk_bf16_f32 v16, 0, v16
    v_mfma_f32_16x16x32_bf16 v[176:179], v[12:15], a[160:163], v[176:179]
    s_add_u32 m0, m0, 4096
    ds_read_b64_tr_b16 v[236:237], v35 offset:8192
    v_mul_f32 v16, v16, v18
    v_mfma_f32_16x16x32_bf16 v[180:183], v[36:39], a[160:163], v[180:183]
    s_add_u32 s49, s49, s51
    v_rcp_f32 v17, v17
    v_mfma_f32_16x16x32_bf16 v[184:187], v[12:15], a[164:167], v[184:187]
    ds_read_b64_tr_b16 v[238:239], v35 offset:8448
    v_mul_f32 v17, v17, v21
    v_cvt_pk_bf16_f32 v17, 0, v17
    v_mfma_f32_16x16x32_bf16 v[188:191], v[36:39], a[164:167], v[188:191]
    s_waitcnt lgkmcnt(4)
    v_mul_f32 v17, v17, v19
    v_cvt_pk_bf16_f32 v40, v16, v17
    v_mfma_f32_16x16x32_bf16 v[160:163], v[224:227], a[24:27], v[160:163]
    ds_read_b64_tr_b16 v[12:13], v4 offset:10240
    v_cvt_pk_bf16_f32 v26, 0, v114
    v_mfma_f32_16x16x32_bf16 v[164:167], v[228:231], a[24:27], v[164:167]
    v_exp_f32 v24, v24
    v_mfma_f32_16x16x32_bf16 v[168:171], v[224:227], a[28:31], v[168:171]
    ds_read_b64_tr_b16 v[14:15], v4 offset:10496
    v_add_f32 v24, 1.0, v24
    v_mfma_f32_16x16x32_bf16 v[172:175], v[228:231], a[28:31], v[172:175]
    buffer_store_dwordx4 v[244:247], v249, s[12:15], s8 offen offset:0 sc0 sc1
    v_cvt_pk_bf16_f32 v27, 0, v115
    v_mfma_f32_16x16x32_bf16 v[176:179], v[224:227], a[168:171], v[176:179]
    ds_read_b64_tr_b16 v[36:37], v35 offset:10240
    v_cvt_pk_bf16_f32 v20, 0, v84
    v_cvt_pk_bf16_f32 v21, 0, v85
    v_mfma_f32_16x16x32_bf16 v[180:183], v[228:231], a[168:171], v[180:183]
    buffer_load_dwordx4 v253, s[72:75], s49 offen lds
    v_mul_f32 v16, v20, v20
    v_mfma_f32_16x16x32_bf16 v[184:187], v[224:227], a[172:175], v[184:187]
    s_add_u32 m0, m0, 4096
    ds_read_b64_tr_b16 v[38:39], v35 offset:10496
    v_mul_f32 v17, v21, v21
    v_mfma_f32_16x16x32_bf16 v[188:191], v[228:231], a[172:175], v[188:191]
    s_waitcnt lgkmcnt(4)
    v_exp_f32 v25, v25
    v_mfma_f32_16x16x32_bf16 v[160:163], v[232:235], a[32:35], v[160:163]
    s_add_u32 s49, s49, s51
    ds_read_b64_tr_b16 v[224:225], v4 offset:12288
    v_add_f32 v25, 1.0, v25
    v_mfma_f32_16x16x32_bf16 v[164:167], v[236:239], a[32:35], v[164:167]
    v_rcp_f32 v24, v24
    v_fma_f32 v16, v16, v11, v10
    v_mfma_f32_16x16x32_bf16 v[168:171], v[232:235], a[36:39], v[168:171]
    ds_read_b64_tr_b16 v[226:227], v4 offset:12544
    v_mul_f32 v24, v24, v28
    v_mfma_f32_16x16x32_bf16 v[172:175], v[236:239], a[36:39], v[172:175]
    v_rcp_f32 v25, v25
    v_mfma_f32_16x16x32_bf16 v[176:179], v[232:235], a[176:179], v[176:179]
    ds_read_b64_tr_b16 v[228:229], v35 offset:12288
    v_mul_f32 v25, v25, v29
    v_mfma_f32_16x16x32_bf16 v[180:183], v[236:239], a[176:179], v[180:183]
    ds_read_b64_tr_b16 v[244:245], v248 offset:64
    v_cvt_pk_bf16_f32 v24, 0, v24
    v_mfma_f32_16x16x32_bf16 v[184:187], v[232:235], a[180:183], v[184:187]
    ds_read_b64_tr_b16 v[230:231], v35 offset:12544
    v_cvt_pk_bf16_f32 v25, 0, v25
    v_mfma_f32_16x16x32_bf16 v[188:191], v[236:239], a[180:183], v[188:191]
    s_waitcnt lgkmcnt(4)
    ds_read_b64_tr_b16 v[246:247], v248 offset:1088
    v_mul_f32 v24, v24, v26
    v_mul_f32 v25, v25, v27
    v_mfma_f32_16x16x32_bf16 v[160:163], v[12:15], a[40:43], v[160:163]
    ds_read_b64_tr_b16 v[232:233], v4 offset:14336
    v_cvt_pk_bf16_f32 v41, v24, v25
    v_mfma_f32_16x16x32_bf16 v[164:167], v[36:39], a[40:43], v[164:167]
    buffer_load_dwordx4 v253, s[72:75], s49 offen lds
    v_fma_f32 v17, v17, v11, v10
    v_mfma_f32_16x16x32_bf16 v[168:171], v[12:15], a[44:47], v[168:171]
    s_add_u32 m0, m0, 4096
    ds_read_b64_tr_b16 v[234:235], v4 offset:14592
    v_mul_f32 v16, v16, v20
    v_mfma_f32_16x16x32_bf16 v[172:175], v[36:39], a[44:47], v[172:175]
    s_add_u32 s49, s49, s51
    v_mul_f32 v17, v17, v21
    v_cvt_pk_bf16_f32 v18, 0, v116
    v_mfma_f32_16x16x32_bf16 v[176:179], v[12:15], a[184:187], v[176:179]
    ds_read_b64_tr_b16 v[236:237], v35 offset:14336
    v_cvt_pk_bf16_f32 v19, 0, v117
    v_exp_f32 v16, v16
    v_mfma_f32_16x16x32_bf16 v[180:183], v[36:39], a[184:187], v[180:183]
    v_exp_f32 v17, v17
    v_mfma_f32_16x16x32_bf16 v[184:187], v[12:15], a[188:191], v[184:187]
    ds_read_b64_tr_b16 v[238:239], v35 offset:14592
    v_add_f32 v16, 1.0, v16
    v_mfma_f32_16x16x32_bf16 v[188:191], v[36:39], a[188:191], v[188:191]
    s_waitcnt lgkmcnt(4)
    v_add_f32 v17, 1.0, v17
    v_cvt_pk_bf16_f32 v28, 0, v86
    v_mfma_f32_16x16x32_bf16 v[160:163], v[224:227], a[48:51], v[160:163]
    ds_read_b64_tr_b16 v[12:13], v4 offset:16384
    v_cvt_pk_bf16_f32 v29, 0, v87
    v_mfma_f32_16x16x32_bf16 v[164:167], v[228:231], a[48:51], v[164:167]
    buffer_load_dwordx4 v253, s[72:75], s49 offen lds
    v_mul_f32 v24, v28, v28
    v_mfma_f32_16x16x32_bf16 v[168:171], v[224:227], a[52:55], v[168:171]
    s_add_u32 m0, m0, 4096
    ds_read_b64_tr_b16 v[14:15], v4 offset:16640
    v_mul_f32 v25, v29, v29
    v_mfma_f32_16x16x32_bf16 v[172:175], v[228:231], a[52:55], v[172:175]
    s_add_u32 s49, s49, s51
    buffer_store_dwordx4 v[244:247], v249, s[12:15], s8 offen offset:2048 sc0 sc1
    v_fma_f32 v24, v24, v11, v10
    v_mfma_f32_16x16x32_bf16 v[176:179], v[224:227], a[192:195], v[176:179]
    s_add_u32 s8, s8, 4096
    ds_read_b64_tr_b16 v[36:37], v35 offset:16384
    v_fma_f32 v25, v25, v11, v10
    v_mfma_f32_16x16x32_bf16 v[180:183], v[228:231], a[192:195], v[180:183]
    v_rcp_f32 v16, v16
    v_mfma_f32_16x16x32_bf16 v[184:187], v[224:227], a[196:199], v[184:187]
    ds_read_b64_tr_b16 v[38:39], v35 offset:16640
    v_mul_f32 v16, v16, v20
    v_mfma_f32_16x16x32_bf16 v[188:191], v[228:231], a[196:199], v[188:191]
    s_waitcnt lgkmcnt(4)
    v_rcp_f32 v17, v17
    v_mfma_f32_16x16x32_bf16 v[160:163], v[232:235], a[56:59], v[160:163]
    ds_read_b64_tr_b16 v[224:225], v4 offset:18432
    v_mul_f32 v17, v17, v21
    v_cvt_pk_bf16_f32 v16, 0, v16
    v_mfma_f32_16x16x32_bf16 v[164:167], v[236:239], a[56:59], v[164:167]
    v_cvt_pk_bf16_f32 v17, 0, v17
    v_mul_f32 v16, v16, v18
    v_mfma_f32_16x16x32_bf16 v[168:171], v[232:235], a[60:63], v[168:171]
    ds_read_b64_tr_b16 v[226:227], v4 offset:18688
    v_mul_f32 v17, v17, v19
    v_mfma_f32_16x16x32_bf16 v[172:175], v[236:239], a[60:63], v[172:175]
    buffer_load_dwordx4 v253, s[72:75], s49 offen lds
    v_cvt_pk_bf16_f32 v42, v16, v17
    v_mfma_f32_16x16x32_bf16 v[176:179], v[232:235], a[200:203], v[176:179]
    s_add_u32 m0, m0, 4096
    ds_read_b64_tr_b16 v[228:229], v35 offset:18432
    v_mul_f32 v24, v24, v28
    v_mfma_f32_16x16x32_bf16 v[180:183], v[236:239], a[200:203], v[180:183]
    s_add_u32 s49, s49, s51
    v_mul_f32 v25, v25, v29
    v_cvt_pk_bf16_f32 v26, 0, v118
    v_cvt_pk_bf16_f32 v27, 0, v119
    v_mfma_f32_16x16x32_bf16 v[184:187], v[232:235], a[204:207], v[184:187]
    ds_read_b64_tr_b16 v[230:231], v35 offset:18688
    v_exp_f32 v24, v24
    v_mfma_f32_16x16x32_bf16 v[188:191], v[236:239], a[204:207], v[188:191]
    s_waitcnt lgkmcnt(4)
    v_exp_f32 v25, v25
    v_mfma_f32_16x16x32_bf16 v[160:163], v[12:15], a[64:67], v[160:163]
    ds_read_b64_tr_b16 v[232:233], v4 offset:20480
    v_add_f32 v24, 1.0, v24
    v_mfma_f32_16x16x32_bf16 v[164:167], v[36:39], a[64:67], v[164:167]
    v_add_f32 v25, 1.0, v25
    v_cvt_pk_bf16_f32 v20, 0, v88
    v_mfma_f32_16x16x32_bf16 v[168:171], v[12:15], a[68:71], v[168:171]
    ds_read_b64_tr_b16 v[234:235], v4 offset:20736
    v_cvt_pk_bf16_f32 v21, 0, v89
    v_mfma_f32_16x16x32_bf16 v[172:175], v[36:39], a[68:71], v[172:175]
    v_rcp_f32 v24, v24
    v_mfma_f32_16x16x32_bf16 v[176:179], v[12:15], a[208:211], v[176:179]
    ds_read_b64_tr_b16 v[236:237], v35 offset:20480
    v_mul_f32 v24, v24, v28
    v_mfma_f32_16x16x32_bf16 v[180:183], v[36:39], a[208:211], v[180:183]
    buffer_load_dwordx4 v253, s[72:75], s49 offen lds
    v_cvt_pk_bf16_f32 v24, 0, v24
    v_mfma_f32_16x16x32_bf16 v[184:187], v[12:15], a[212:215], v[184:187]
    s_add_u32 m0, m0, 4096
    ds_read_b64_tr_b16 v[238:239], v35 offset:20736
    v_mul_f32 v24, v24, v26
    v_mfma_f32_16x16x32_bf16 v[188:191], v[36:39], a[212:215], v[188:191]
    s_waitcnt lgkmcnt(4)
    v_rcp_f32 v25, v25
    v_mfma_f32_16x16x32_bf16 v[160:163], v[224:227], a[72:75], v[160:163]
    s_add_u32 s49, s49, s51
    ds_read_b64_tr_b16 v[12:13], v4 offset:22528
    v_mul_f32 v25, v25, v29
    v_cvt_pk_bf16_f32 v25, 0, v25
    v_mfma_f32_16x16x32_bf16 v[164:167], v[228:231], a[72:75], v[164:167]
    v_mul_f32 v25, v25, v27
    v_cvt_pk_bf16_f32 v43, v24, v25
    v_mfma_f32_16x16x32_bf16 v[168:171], v[224:227], a[76:79], v[168:171]
    ds_read_b64_tr_b16 v[14:15], v4 offset:22784
    v_mul_f32 v16, v20, v20
    v_mfma_f32_16x16x32_bf16 v[172:175], v[228:231], a[76:79], v[172:175]
    buffer_store_dwordx4 v[40:43], v7, s[20:23], s39 offen offset:2048 sc0 sc1
    v_mul_f32 v17, v21, v21
    v_mfma_f32_16x16x32_bf16 v[176:179], v[224:227], a[216:219], v[176:179]
    ds_read_b64_tr_b16 v[36:37], v35 offset:22528
    v_fma_f32 v16, v16, v11, v10
    v_mfma_f32_16x16x32_bf16 v[180:183], v[228:231], a[216:219], v[180:183]
    v_fma_f32 v17, v17, v11, v10
    v_mul_f32 v16, v16, v20
    v_mfma_f32_16x16x32_bf16 v[184:187], v[224:227], a[220:223], v[184:187]
    ds_read_b64_tr_b16 v[38:39], v35 offset:22784
    v_mul_f32 v17, v17, v21
    v_cvt_pk_bf16_f32 v18, 0, v120
    v_mfma_f32_16x16x32_bf16 v[188:191], v[228:231], a[220:223], v[188:191]
    s_waitcnt lgkmcnt(4)
    buffer_load_dwordx4 v253, s[72:75], s49 offen lds
    v_cvt_pk_bf16_f32 v19, 0, v121
    v_mfma_f32_16x16x32_bf16 v[160:163], v[232:235], a[80:83], v[160:163]
    s_add_u32 m0, m0, 4096
    ds_read_b64_tr_b16 v[224:225], v4 offset:24576
    v_exp_f32 v16, v16
    v_mfma_f32_16x16x32_bf16 v[164:167], v[236:239], a[80:83], v[164:167]
    s_add_u32 s49, s49, s51
    v_exp_f32 v17, v17
    v_mfma_f32_16x16x32_bf16 v[168:171], v[232:235], a[84:87], v[168:171]
    ds_read_b64_tr_b16 v[226:227], v4 offset:24832
    v_add_f32 v16, 1.0, v16
    v_mfma_f32_16x16x32_bf16 v[172:175], v[236:239], a[84:87], v[172:175]
    v_add_f32 v17, 1.0, v17
    v_cvt_pk_bf16_f32 v28, 0, v90
    v_mfma_f32_16x16x32_bf16 v[176:179], v[232:235], a[224:227], v[176:179]
    ds_read_b64_tr_b16 v[228:229], v35 offset:24576
    v_cvt_pk_bf16_f32 v29, 0, v91
    v_mfma_f32_16x16x32_bf16 v[180:183], v[236:239], a[224:227], v[180:183]
    v_rcp_f32 v16, v16
    v_mfma_f32_16x16x32_bf16 v[184:187], v[232:235], a[228:231], v[184:187]
    ds_read_b64_tr_b16 v[230:231], v35 offset:24832
    v_mul_f32 v16, v16, v20
    v_mfma_f32_16x16x32_bf16 v[188:191], v[236:239], a[228:231], v[188:191]
    s_waitcnt lgkmcnt(4)
    v_rcp_f32 v17, v17
    v_mfma_f32_16x16x32_bf16 v[160:163], v[12:15], a[88:91], v[160:163]
    ds_read_b64_tr_b16 v[232:233], v4 offset:26624
    v_mul_f32 v17, v17, v21
    v_mfma_f32_16x16x32_bf16 v[164:167], v[36:39], a[88:91], v[164:167]
    buffer_load_dwordx4 v253, s[72:75], s49 offen lds
    v_cvt_pk_bf16_f32 v16, 0, v16
    v_cvt_pk_bf16_f32 v17, 0, v17
    v_mfma_f32_16x16x32_bf16 v[168:171], v[12:15], a[92:95], v[168:171]
    s_add_u32 m0, m0, 4096
    ds_read_b64_tr_b16 v[234:235], v4 offset:26880
    v_mul_f32 v16, v16, v18
    v_mfma_f32_16x16x32_bf16 v[172:175], v[36:39], a[92:95], v[172:175]
    s_add_u32 s49, s49, s51
    v_mul_f32 v17, v17, v19
    v_cvt_pk_bf16_f32 v44, v16, v17
    v_mfma_f32_16x16x32_bf16 v[176:179], v[12:15], a[232:235], v[176:179]
    ds_read_b64_tr_b16 v[236:237], v35 offset:26624
    v_mul_f32 v24, v28, v28
    v_mfma_f32_16x16x32_bf16 v[180:183], v[36:39], a[232:235], v[180:183]
    v_mul_f32 v25, v29, v29
    v_fma_f32 v24, v24, v11, v10
    v_mfma_f32_16x16x32_bf16 v[184:187], v[12:15], a[236:239], v[184:187]
    ds_read_b64_tr_b16 v[238:239], v35 offset:26880
    v_fma_f32 v25, v25, v11, v10
    v_mfma_f32_16x16x32_bf16 v[188:191], v[36:39], a[236:239], v[188:191]
    s_waitcnt lgkmcnt(4)
    v_mul_f32 v24, v24, v28
    v_mul_f32 v25, v25, v29
    v_cvt_pk_bf16_f32 v26, 0, v122
    v_mfma_f32_16x16x32_bf16 v[160:163], v[224:227], a[96:99], v[160:163]
    ds_read_b64_tr_b16 v[12:13], v4 offset:28672
    v_cvt_pk_bf16_f32 v27, 0, v123
    v_mfma_f32_16x16x32_bf16 v[164:167], v[228:231], a[96:99], v[164:167]
    s_mov_b32 s14, 0
    v_exp_f32 v24, v24
    v_mfma_f32_16x16x32_bf16 v[168:171], v[224:227], a[100:103], v[168:171]
    ds_read_b64_tr_b16 v[14:15], v4 offset:28928
    v_add_f32 v24, 1.0, v24
    v_mfma_f32_16x16x32_bf16 v[172:175], v[228:231], a[100:103], v[172:175]
    v_exp_f32 v25, v25
    v_mfma_f32_16x16x32_bf16 v[176:179], v[224:227], a[240:243], v[176:179]
    ds_read_b64_tr_b16 v[36:37], v35 offset:28672
    v_add_f32 v25, 1.0, v25
    v_cvt_pk_bf16_f32 v20, 0, v92
    v_mfma_f32_16x16x32_bf16 v[180:183], v[228:231], a[240:243], v[180:183]
    v_rcp_f32 v24, v24
    v_mfma_f32_16x16x32_bf16 v[184:187], v[224:227], a[244:247], v[184:187]
    ds_read_b64_tr_b16 v[38:39], v35 offset:28928
    v_mul_f32 v24, v24, v28
    v_mfma_f32_16x16x32_bf16 v[188:191], v[228:231], a[244:247], v[188:191]
    s_waitcnt lgkmcnt(4)
    v_rcp_f32 v25, v25
    v_mfma_f32_16x16x32_bf16 v[160:163], v[232:235], a[104:107], v[160:163]
    ds_read_b64_tr_b16 v[224:225], v4 offset:30720
    v_mul_f32 v25, v25, v29
    v_mfma_f32_16x16x32_bf16 v[164:167], v[236:239], a[104:107], v[164:167]
    v_cvt_pk_bf16_f32 v24, 0, v24
    v_cvt_pk_bf16_f32 v25, 0, v25
    v_mfma_f32_16x16x32_bf16 v[168:171], v[232:235], a[108:111], v[168:171]
    ds_read_b64_tr_b16 v[226:227], v4 offset:30976
    v_mul_f32 v24, v24, v26
    v_mul_f32 v25, v25, v27
    v_mfma_f32_16x16x32_bf16 v[172:175], v[236:239], a[108:111], v[172:175]
    v_cvt_pk_bf16_f32 v45, v24, v25
    v_cvt_pk_bf16_f32 v21, 0, v93
    v_mfma_f32_16x16x32_bf16 v[176:179], v[232:235], a[248:251], v[176:179]
    ds_read_b64_tr_b16 v[228:229], v35 offset:30720
    v_mul_f32 v16, v20, v20
    v_mfma_f32_16x16x32_bf16 v[180:183], v[236:239], a[248:251], v[180:183]
    v_mul_f32 v17, v21, v21
    v_fma_f32 v16, v16, v11, v10
    v_mfma_f32_16x16x32_bf16 v[184:187], v[232:235], a[252:255], v[184:187]
    ds_read_b64_tr_b16 v[230:231], v35 offset:30976
    v_fma_f32 v17, v17, v11, v10
    v_mfma_f32_16x16x32_bf16 v[188:191], v[236:239], a[252:255], v[188:191]
    s_waitcnt lgkmcnt(4)
    v_mul_f32 v16, v16, v20
    v_mul_f32 v17, v17, v21
    v_mfma_f32_16x16x32_bf16 v[160:163], v[12:15], a[112:115], v[160:163]
    ds_read_b64_tr_b16 v[232:233], v4 offset:32768
    v_cvt_pk_bf16_f32 v18, 0, v124
    v_cvt_pk_bf16_f32 v19, 0, v125
    v_mfma_f32_16x16x32_bf16 v[164:167], v[36:39], a[112:115], v[164:167]
    v_exp_f32 v16, v16
    v_mfma_f32_16x16x32_bf16 v[168:171], v[12:15], a[116:119], v[168:171]
    ds_read_b64_tr_b16 v[234:235], v4 offset:33024
    v_add_f32 v16, 1.0, v16
    v_mfma_f32_16x16x32_bf16 v[172:175], v[36:39], a[116:119], v[172:175]
    v_exp_f32 v17, v17
    v_mfma_f32_16x16x32_bf16 v[176:179], v[12:15], v[192:195], v[176:179]
    ds_read_b64_tr_b16 v[236:237], v35 offset:32768
    v_add_f32 v17, 1.0, v17
    v_mfma_f32_16x16x32_bf16 v[180:183], v[36:39], v[192:195], v[180:183]
    v_rcp_f32 v16, v16
    v_cvt_pk_bf16_f32 v28, 0, v94
    v_mfma_f32_16x16x32_bf16 v[184:187], v[12:15], v[196:199], v[184:187]
    ds_read_b64_tr_b16 v[238:239], v35 offset:33024
    v_mul_f32 v16, v16, v20
    v_mfma_f32_16x16x32_bf16 v[188:191], v[36:39], v[196:199], v[188:191]
    s_waitcnt lgkmcnt(4)
    v_rcp_f32 v17, v17
    v_mfma_f32_16x16x32_bf16 v[160:163], v[224:227], a[120:123], v[160:163]
    ds_read_b64_tr_b16 v[12:13], v4 offset:34816
    v_mul_f32 v17, v17, v21
    v_mfma_f32_16x16x32_bf16 v[164:167], v[228:231], a[120:123], v[164:167]
    v_cvt_pk_bf16_f32 v16, 0, v16
    v_cvt_pk_bf16_f32 v17, 0, v17
    v_mfma_f32_16x16x32_bf16 v[168:171], v[224:227], a[124:127], v[168:171]
    ds_read_b64_tr_b16 v[14:15], v4 offset:35072
    v_mul_f32 v16, v16, v18
    v_mfma_f32_16x16x32_bf16 v[172:175], v[228:231], a[124:127], v[172:175]
    v_mul_f32 v17, v17, v19
    v_cvt_pk_bf16_f32 v46, v16, v17
    v_cvt_pk_bf16_f32 v29, 0, v95
    v_mfma_f32_16x16x32_bf16 v[176:179], v[224:227], v[200:203], v[176:179]
    ds_read_b64_tr_b16 v[36:37], v35 offset:34816
    v_mul_f32 v24, v28, v28
    v_mfma_f32_16x16x32_bf16 v[180:183], v[228:231], v[200:203], v[180:183]
    v_mul_f32 v25, v29, v29
    v_fma_f32 v24, v24, v11, v10
    v_mfma_f32_16x16x32_bf16 v[184:187], v[224:227], v[204:207], v[184:187]
    ds_read_b64_tr_b16 v[38:39], v35 offset:35072
    v_fma_f32 v25, v25, v11, v10
    v_mfma_f32_16x16x32_bf16 v[188:191], v[228:231], v[204:207], v[188:191]
    s_waitcnt lgkmcnt(4)
    v_mul_f32 v24, v24, v28
    v_mul_f32 v25, v25, v29
    s_waitcnt vmcnt(13)
    s_barrier
    v_mfma_f32_16x16x32_bf16 v[160:163], v[232:235], a[128:131], v[160:163]
    ds_read_b64_tr_b16 v[224:225], v1 offset:0
    v_cvt_pk_bf16_f32 v26, 0, v126
    v_cvt_pk_bf16_f32 v27, 0, v127
    v_mfma_f32_16x16x32_bf16 v[164:167], v[236:239], a[128:131], v[164:167]
    v_exp_f32 v24, v24
    v_mfma_f32_16x16x32_bf16 v[168:171], v[232:235], a[132:135], v[168:171]
    ds_read_b64_tr_b16 v[226:227], v1 offset:256
    v_add_f32 v24, 1.0, v24
    v_mfma_f32_16x16x32_bf16 v[172:175], v[236:239], a[132:135], v[172:175]
    v_exp_f32 v25, v25
    v_mfma_f32_16x16x32_bf16 v[176:179], v[232:235], v[208:211], v[176:179]
    ds_read_b64_tr_b16 v[228:229], v32 offset:0
    v_add_f32 v25, 1.0, v25
    v_mfma_f32_16x16x32_bf16 v[180:183], v[236:239], v[208:211], v[180:183]
    v_rcp_f32 v24, v24
    v_mfma_f32_16x16x32_bf16 v[184:187], v[232:235], v[212:215], v[184:187]
    ds_read_b64_tr_b16 v[230:231], v32 offset:256
    v_mul_f32 v24, v24, v28
    v_cvt_pk_bf16_f32 v24, 0, v24
    v_mfma_f32_16x16x32_bf16 v[188:191], v[236:239], v[212:215], v[188:191]
    s_waitcnt lgkmcnt(4)
    v_rcp_f32 v25, v25
    v_mfma_f32_16x16x32_bf16 v[160:163], v[12:15], a[136:139], v[160:163]
    ds_read_b64_tr_b16 v[232:233], v1 offset:2048
    v_mul_f32 v25, v25, v29
    v_mfma_f32_16x16x32_bf16 v[164:167], v[36:39], a[136:139], v[164:167]
    v_cvt_pk_bf16_f32 v25, 0, v25
    v_mul_f32 v24, v24, v26
    v_mfma_f32_16x16x32_bf16 v[168:171], v[12:15], a[140:143], v[168:171]
    ds_read_b64_tr_b16 v[234:235], v1 offset:2304
    v_mul_f32 v25, v25, v27
    v_mfma_f32_16x16x32_bf16 v[172:175], v[36:39], a[140:143], v[172:175]
    v_cvt_pk_bf16_f32 v47, v24, v25
    v_mfma_f32_16x16x32_bf16 v[176:179], v[12:15], v[216:219], v[176:179]
    ds_read_b64_tr_b16 v[236:237], v32 offset:2048
    buffer_store_dwordx4 v[44:47], v7, s[20:23], s39 offen offset:3072 sc0 sc1
    s_add_u32 s39, s39, 32768
    v_mfma_f32_16x16x32_bf16 v[180:183], v[36:39], v[216:219], v[180:183]
    v_mfma_f32_16x16x32_bf16 v[184:187], v[12:15], v[220:223], v[184:187]
    ds_read_b64_tr_b16 v[238:239], v32 offset:2304
    v_mfma_f32_16x16x32_bf16 v[188:191], v[36:39], v[220:223], v[188:191]
    s_branch L_k1_abody
L_k1_tail:
    s_cmp_eq_u32 s30, 5
    s_cbranch_scc0 L_k1_q4
    s_mov_b32 s39, s40
    s_waitcnt lgkmcnt(4)
    v_mfma_f32_16x16x32_bf16 v[128:131], v[224:227], a[0:3], 0
    ds_read_b64_tr_b16 v[12:13], v3 offset:4096
    v_mfma_f32_16x16x32_bf16 v[132:135], v[228:231], a[0:3], 0
    s_mov_b64 s[88:89], s[64:65]
    v_mfma_f32_16x16x32_bf16 v[136:139], v[224:227], a[4:7], 0
    s_mov_b64 s[90:91], s[66:67]
    ds_read_b64_tr_b16 v[14:15], v3 offset:4352
    v_mfma_f32_16x16x32_bf16 v[140:143], v[228:231], a[4:7], 0
    s_mov_b64 s[66:67], s[4:5]
    v_mfma_f32_16x16x32_bf16 v[144:147], v[224:227], a[144:147], 0
    s_mov_b64 s[70:71], s[6:7]
    ds_read_b64_tr_b16 v[36:37], v34 offset:4096
    v_cvt_pk_bf16_f32 v20, 0, v64
    v_cvt_pk_bf16_f32 v21, 0, v65
    v_mfma_f32_16x16x32_bf16 v[148:151], v[228:231], a[144:147], 0
    s_load_dwordx2 s[4:5], s[0:1], 0
    v_mul_f32 v16, v20, v20
    v_mul_f32 v17, v21, v21
    v_fma_f32 v16, v16, v11, v10
    v_mfma_f32_16x16x32_bf16 v[152:155], v[224:227], a[148:151], 0
    s_load_dwordx2 s[58:59], s[0:1], 56
    ds_read_b64_tr_b16 v[38:39], v34 offset:4352
    v_fma_f32 v17, v17, v11, v10
    v_mul_f32 v16, v16, v20
    v_mfma_f32_16x16x32_bf16 v[156:159], v[228:231], a[148:151], 0
    s_waitcnt lgkmcnt(4)
    v_mul_f32 v17, v17, v21
    v_cvt_pk_bf16_f32 v18, 0, v96
    v_cvt_pk_bf16_f32 v19, 0, v97
    v_mfma_f32_16x16x32_bf16 v[128:131], v[232:235], a[8:11], v[128:131]
    s_bfe_u32 s29, s2, 0x20001
    ds_read_b64_tr_b16 v[224:225], v3 offset:6144
    v_exp_f32 v16, v16
    v_mfma_f32_16x16x32_bf16 v[132:135], v[236:239], a[8:11], v[132:135]
    s_and_b32 s30, s2, 1
    s_lshl_b32 s30, s30, 3
    s_lshr_b32 s35, s2, 5
    s_add_u32 s30, s30, s35
    s_bfe_u32 s31, s2, 0x20003
    s_and_b32 s32, s28, 1
    s_lshr_b32 s36, s28, 1
    v_mfma_f32_16x16x32_bf16 v[136:139], v[232:235], a[12:15], v[136:139]
    s_mul_i32 s52, s32, 9216
    ds_read_b64_tr_b16 v[226:227], v3 offset:6400
    v_add_f32 v16, 1.0, v16
    v_cvt_pk_bf16_f32 v28, 0, v66
    v_mfma_f32_16x16x32_bf16 v[140:143], v[236:239], a[12:15], v[140:143]
    s_mul_i32 s3, s36, 4608
    s_add_u32 s52, s52, s3
    s_mul_i32 s33, s32, 36864
    s_add_u32 s33, s33, s3
    s_mul_i32 s35, s31, 9216
    s_add_u32 s33, s33, s35
    s_mul_i32 s55, s29, 1327104
    s_add_u32 s55, s55, s33
    s_add_u32 s33, s33, 5308416
    s_add_u32 s24, s6, 0x03400000
    s_addc_u32 s25, s7, 0
    s_and_b32 s25, s25, 0xffff
    s_mov_b32 s26, 0x005b2000
    s_mov_b32 s27, 0x00020000
    v_mfma_f32_16x16x32_bf16 v[144:147], v[232:235], a[152:155], v[144:147]
    s_lshl_b32 s3, s30, 1
    ds_read_b64_tr_b16 v[228:229], v34 offset:6144
    v_cvt_pk_bf16_f32 v29, 0, v67
    v_mul_f32 v24, v28, v28
    v_mfma_f32_16x16x32_bf16 v[148:151], v[236:239], a[152:155], v[148:151]
    s_add_u32 s3, s3, s36
    v_exp_f32 v17, v17
    v_mul_f32 v25, v29, v29
    v_mfma_f32_16x16x32_bf16 v[152:155], v[232:235], a[156:159], v[152:155]
    s_mul_i32 s3, s3, 162
    ds_read_b64_tr_b16 v[230:231], v34 offset:6400
    v_add_f32 v17, 1.0, v17
    v_fma_f32 v24, v24, v11, v10
    v_mfma_f32_16x16x32_bf16 v[156:159], v[236:239], a[156:159], v[156:159]
    s_waitcnt lgkmcnt(4)
    s_mul_i32 s35, s29, 36
    s_add_u32 s3, s3, s35
    s_lshl_b32 s3, s3, 12
    s_lshl_b32 s35, s32, 11
    s_add_u32 s53, s3, s35
    s_add_u32 s54, s53, 4096
    s_waitcnt vmcnt(1)
    v_xor_b32 v244, s66, v244
    v_xor_b32 v245, s67, v245
    v_or_b32 v244, v244, v245
    v_cmp_ne_u32 vcc, 0, v244
    s_lshl_b32 s77, s28, 2
    s_add_u32 s77, s77, 36848
    v_mov_b32 v247, s77
    s_nop 1
    s_cmp_eq_u64 vcc, 0
    s_cselect_b32 s77, 1, 0
    v_mov_b32 v244, s77
    ds_write_b32 v247, v244
    v_mov_b32 v247, 36848
    v_mfma_f32_16x16x32_bf16 v[128:131], v[12:15], a[16:19], v[128:131]
    ds_read_b64_tr_b16 v[232:233], v3 offset:8192
    v_fma_f32 v25, v25, v11, v10
    v_mfma_f32_16x16x32_bf16 v[132:135], v[36:39], a[16:19], v[132:135]
    s_waitcnt lgkmcnt(1)
    s_barrier
    ds_read_b128 v[240:243], v247
    s_mov_b64 s[60:61], s[20:21]
    s_mov_b32 s63, s23
    v_mfma_f32_16x16x32_bf16 v[136:139], v[12:15], a[20:23], v[136:139]
    ds_read_b64_tr_b16 v[234:235], v3 offset:8448
    v_mul_f32 v24, v24, v28
    v_mul_f32 v25, v25, v29
    v_mfma_f32_16x16x32_bf16 v[140:143], v[36:39], a[20:23], v[140:143]
    v_rcp_f32 v16, v16
    v_cvt_pk_bf16_f32 v26, 0, v98
    v_mfma_f32_16x16x32_bf16 v[144:147], v[12:15], a[160:163], v[144:147]
    ds_read_b64_tr_b16 v[236:237], v34 offset:8192
    v_mul_f32 v16, v16, v20
    v_cvt_pk_bf16_f32 v16, 0, v16
    v_mfma_f32_16x16x32_bf16 v[148:151], v[36:39], a[160:163], v[148:151]
    s_waitcnt lgkmcnt(2)
    v_and_b32 v240, v240, v241
    v_and_b32 v242, v242, v243
    v_and_b32 v240, v240, v242
    s_nop 0
    v_readfirstlane_b32 s37, v240
    s_nop 3
    s_cmp_lg_u32 s37, 0
    s_cselect_b32 s62, s22, 0
    s_cselect_b32 s26, s26, 0
    v_mfma_f32_16x16x32_bf16 v[152:155], v[12:15], a[164:167], v[152:155]
    ds_read_b64_tr_b16 v[238:239], v34 offset:8448
    v_mul_f32 v16, v16, v18
    v_mfma_f32_16x16x32_bf16 v[156:159], v[36:39], a[164:167], v[156:159]
    s_waitcnt lgkmcnt(4)
    v_rcp_f32 v17, v17
    v_cvt_pk_bf16_f32 v27, 0, v99
    v_mfma_f32_16x16x32_bf16 v[128:131], v[224:227], a[24:27], v[128:131]
    s_add_u32 m0, s52, 0
    ds_read_b64_tr_b16 v[12:13], v3 offset:10240
    v_mul_f32 v17, v17, v21
    v_cvt_pk_bf16_f32 v17, 0, v17
    v_mfma_f32_16x16x32_bf16 v[132:135], v[228:231], a[24:27], v[132:135]
    s_nop 0
    buffer_load_dwordx4 v9, s[24:27], s55 offen sc1 lds
    v_mul_f32 v17, v17, v19
    v_cvt_pk_bf16_f32 v40, v16, v17
    v_mfma_f32_16x16x32_bf16 v[136:139], v[224:227], a[28:31], v[136:139]
    ds_read_b64_tr_b16 v[14:15], v3 offset:10496
    v_exp_f32 v24, v24
    v_mfma_f32_16x16x32_bf16 v[140:143], v[228:231], a[28:31], v[140:143]
    buffer_load_dwordx4 v9, s[24:27], s55 offen offset:1024 sc1 lds
    v_add_f32 v24, 1.0, v24
    v_cvt_pk_bf16_f32 v20, 0, v68
    v_mfma_f32_16x16x32_bf16 v[144:147], v[224:227], a[168:171], v[144:147]
    ds_read_b64_tr_b16 v[36:37], v34 offset:10240
    v_cvt_pk_bf16_f32 v21, 0, v69
    v_mul_f32 v16, v20, v20
    v_mfma_f32_16x16x32_bf16 v[148:151], v[228:231], a[168:171], v[148:151]
    v_exp_f32 v25, v25
    v_mul_f32 v17, v21, v21
    v_mfma_f32_16x16x32_bf16 v[152:155], v[224:227], a[172:175], v[152:155]
    ds_read_b64_tr_b16 v[38:39], v34 offset:10496
    v_add_f32 v25, 1.0, v25
    v_fma_f32 v16, v16, v11, v10
    v_mfma_f32_16x16x32_bf16 v[156:159], v[228:231], a[172:175], v[156:159]
    s_waitcnt lgkmcnt(4)
    buffer_load_dwordx4 v9, s[24:27], s55 offen offset:2048 sc1 lds
    v_fma_f32 v17, v17, v11, v10
    v_mul_f32 v16, v16, v20
    v_mfma_f32_16x16x32_bf16 v[128:131], v[232:235], a[32:35], v[128:131]
    ds_read_b64_tr_b16 v[224:225], v3 offset:12288
    v_mul_f32 v17, v17, v21
    v_cvt_pk_bf16_f32 v18, 0, v100
    v_mfma_f32_16x16x32_bf16 v[132:135], v[236:239], a[32:35], v[132:135]
    v_rcp_f32 v24, v24
    v_rcp_f32 v25, v25
    v_mfma_f32_16x16x32_bf16 v[136:139], v[232:235], a[36:39], v[136:139]
    ds_read_b64_tr_b16 v[226:227], v3 offset:12544
    v_mul_f32 v24, v24, v28
    v_mul_f32 v25, v25, v29
    v_mfma_f32_16x16x32_bf16 v[140:143], v[236:239], a[36:39], v[140:143]
    buffer_load_dwordx4 v9, s[24:27], s55 offen offset:3072 sc1 lds
    v_cvt_pk_bf16_f32 v24, 0, v24
    v_cvt_pk_bf16_f32 v25, 0, v25
    v_mfma_f32_16x16x32_bf16 v[144:147], v[232:235], a[176:179], v[144:147]
    ds_read_b64_tr_b16 v[228:229], v34 offset:12288
    v_mul_f32 v24, v24, v26
    v_mul_f32 v25, v25, v27
    v_mfma_f32_16x16x32_bf16 v[148:151], v[236:239], a[176:179], v[148:151]
    v_cvt_pk_bf16_f32 v41, v24, v25
    v_cvt_pk_bf16_f32 v19, 0, v101
    v_exp_f32 v16, v16
    v_mfma_f32_16x16x32_bf16 v[152:155], v[232:235], a[180:183], v[152:155]
    ds_read_b64_tr_b16 v[230:231], v34 offset:12544
    v_add_f32 v16, 1.0, v16
    v_cvt_pk_bf16_f32 v28, 0, v70
    v_mfma_f32_16x16x32_bf16 v[156:159], v[236:239], a[180:183], v[156:159]
    s_waitcnt lgkmcnt(4)
    s_add_u32 m0, s52, 4096
    s_add_u32 s38, s55, 4096
    s_mov_b32 exec_hi, 0
    buffer_load_dwordx4 v9, s[24:27], s38 offen sc1 lds
    s_mov_b32 exec_hi, -1
    s_add_u32 s55, s55, 73728
    v_mfma_f32_16x16x32_bf16 v[128:131], v[12:15], a[40:43], v[128:131]
    ds_read_b64_tr_b16 v[232:233], v3 offset:14336
    v_cvt_pk_bf16_f32 v29, 0, v71
    v_mul_f32 v24, v28, v28
    v_mfma_f32_16x16x32_bf16 v[132:135], v[36:39], a[40:43], v[132:135]
    v_exp_f32 v17, v17
    v_mul_f32 v25, v29, v29
    v_mfma_f32_16x16x32_bf16 v[136:139], v[12:15], a[44:47], v[136:139]
    ds_read_b64_tr_b16 v[234:235], v3 offset:14592
    v_add_f32 v17, 1.0, v17
    v_fma_f32 v24, v24, v11, v10
    v_mfma_f32_16x16x32_bf16 v[140:143], v[36:39], a[44:47], v[140:143]
    buffer_load_dwordx4 a[0:3], v9, s[60:63], s53 offen offset:0 sc1
    v_fma_f32 v25, v25, v11, v10
    v_mul_f32 v24, v24, v28
    v_mfma_f32_16x16x32_bf16 v[144:147], v[12:15], a[184:187], v[144:147]
    ds_read_b64_tr_b16 v[236:237], v34 offset:14336
    v_mul_f32 v25, v25, v29
    v_cvt_pk_bf16_f32 v26, 0, v102
    v_mfma_f32_16x16x32_bf16 v[148:151], v[36:39], a[184:187], v[148:151]
    v_rcp_f32 v16, v16
    v_rcp_f32 v17, v17
    v_mfma_f32_16x16x32_bf16 v[152:155], v[12:15], a[188:191], v[152:155]
    ds_read_b64_tr_b16 v[238:239], v34 offset:14592
    v_mul_f32 v16, v16, v20
    v_mul_f32 v17, v17, v21
    v_mfma_f32_16x16x32_bf16 v[156:159], v[36:39], a[188:191], v[156:159]
    s_waitcnt lgkmcnt(4)
    buffer_load_dwordx4 a[4:7], v9, s[60:63], s53 offen offset:1024 sc1
    v_cvt_pk_bf16_f32 v16, 0, v16
    v_cvt_pk_bf16_f32 v17, 0, v17
    v_mfma_f32_16x16x32_bf16 v[128:131], v[224:227], a[48:51], v[128:131]
    s_add_u32 s53, s53, 8192
    ds_read_b64_tr_b16 v[12:13], v3 offset:16384
    v_mul_f32 v16, v16, v18
    v_mul_f32 v17, v17, v19
    v_mfma_f32_16x16x32_bf16 v[132:135], v[228:231], a[48:51], v[132:135]
    v_cvt_pk_bf16_f32 v42, v16, v17
    v_cvt_pk_bf16_f32 v27, 0, v103
    v_exp_f32 v24, v24
    v_mfma_f32_16x16x32_bf16 v[136:139], v[224:227], a[52:55], v[136:139]
    ds_read_b64_tr_b16 v[14:15], v3 offset:16640
    v_add_f32 v24, 1.0, v24
    v_exp_f32 v25, v25
    v_mfma_f32_16x16x32_bf16 v[140:143], v[228:231], a[52:55], v[140:143]
    buffer_load_dwordx4 a[144:147], v9, s[60:63], s54 offen offset:0 sc1
    v_add_f32 v25, 1.0, v25
    v_cvt_pk_bf16_f32 v20, 0, v72
    v_mfma_f32_16x16x32_bf16 v[144:147], v[224:227], a[192:195], v[144:147]
    ds_read_b64_tr_b16 v[36:37], v34 offset:16384
    v_cvt_pk_bf16_f32 v21, 0, v73
    v_mul_f32 v16, v20, v20
    v_mfma_f32_16x16x32_bf16 v[148:151], v[228:231], a[192:195], v[148:151]
    v_rcp_f32 v24, v24
    v_mul_f32 v17, v21, v21
    v_mfma_f32_16x16x32_bf16 v[152:155], v[224:227], a[196:199], v[152:155]
    ds_read_b64_tr_b16 v[38:39], v34 offset:16640
    v_mul_f32 v24, v24, v28
    v_cvt_pk_bf16_f32 v24, 0, v24
    v_mfma_f32_16x16x32_bf16 v[156:159], v[228:231], a[196:199], v[156:159]
    s_waitcnt lgkmcnt(4)
    buffer_load_dwordx4 a[148:151], v9, s[60:63], s54 offen offset:1024 sc1
    v_mul_f32 v24, v24, v26
    v_fma_f32 v16, v16, v11, v10
    v_mfma_f32_16x16x32_bf16 v[128:131], v[232:235], a[56:59], v[128:131]
    s_add_u32 s54, s54, 8192
    ds_read_b64_tr_b16 v[224:225], v3 offset:18432
    v_fma_f32 v17, v17, v11, v10
    v_mul_f32 v16, v16, v20
    v_mfma_f32_16x16x32_bf16 v[132:135], v[236:239], a[56:59], v[132:135]
    v_rcp_f32 v25, v25
    v_mul_f32 v17, v17, v21
    v_mfma_f32_16x16x32_bf16 v[136:139], v[232:235], a[60:63], v[136:139]
    ds_read_b64_tr_b16 v[226:227], v3 offset:18688
    v_mul_f32 v25, v25, v29
    v_cvt_pk_bf16_f32 v25, 0, v25
    v_mfma_f32_16x16x32_bf16 v[140:143], v[236:239], a[60:63], v[140:143]
    v_mul_f32 v25, v25, v27
    v_cvt_pk_bf16_f32 v43, v24, v25
    v_cvt_pk_bf16_f32 v18, 0, v104
    v_mfma_f32_16x16x32_bf16 v[144:147], v[232:235], a[200:203], v[144:147]
    ds_read_b64_tr_b16 v[228:229], v34 offset:18432
    v_cvt_pk_bf16_f32 v19, 0, v105
    v_exp_f32 v16, v16
    v_mfma_f32_16x16x32_bf16 v[148:151], v[236:239], a[200:203], v[148:151]
    s_add_u32 m0, s52, 18432
    v_exp_f32 v17, v17
    v_add_f32 v16, 1.0, v16
    v_mfma_f32_16x16x32_bf16 v[152:155], v[232:235], a[204:207], v[152:155]
    s_nop 0
    ds_read_b64_tr_b16 v[230:231], v34 offset:18688
    v_add_f32 v17, 1.0, v17
    v_cvt_pk_bf16_f32 v28, 0, v74
    v_mfma_f32_16x16x32_bf16 v[156:159], v[236:239], a[204:207], v[156:159]
    s_waitcnt lgkmcnt(4)
    buffer_load_dwordx4 v9, s[24:27], s55 offen sc1 lds
    v_cvt_pk_bf16_f32 v29, 0, v75
    v_mul_f32 v24, v28, v28
    v_mfma_f32_16x16x32_bf16 v[128:131], v[12:15], a[64:67], v[128:131]
    ds_read_b64_tr_b16 v[232:233], v3 offset:20480
    v_mul_f32 v25, v29, v29
    v_fma_f32 v24, v24, v11, v10
    v_mfma_f32_16x16x32_bf16 v[132:135], v[36:39], a[64:67], v[132:135]
    buffer_load_dwordx4 v9, s[24:27], s55 offen offset:1024 sc1 lds
    v_fma_f32 v25, v25, v11, v10
    v_mul_f32 v24, v24, v28
    v_mfma_f32_16x16x32_bf16 v[136:139], v[12:15], a[68:71], v[136:139]
    ds_read_b64_tr_b16 v[234:235], v3 offset:20736
    v_mul_f32 v25, v25, v29
    v_rcp_f32 v16, v16
    v_mfma_f32_16x16x32_bf16 v[140:143], v[36:39], a[68:71], v[140:143]
    buffer_store_dwordx4 v[40:43], v7, s[20:23], s39 offen offset:0 sc0 sc1
    v_mul_f32 v16, v16, v20
    v_cvt_pk_bf16_f32 v16, 0, v16
    v_mfma_f32_16x16x32_bf16 v[144:147], v[12:15], a[208:211], v[144:147]
    ds_read_b64_tr_b16 v[236:237], v34 offset:20480
    v_mul_f32 v16, v16, v18
    v_cvt_pk_bf16_f32 v26, 0, v106
    v_mfma_f32_16x16x32_bf16 v[148:151], v[36:39], a[208:211], v[148:151]
    buffer_load_dwordx4 v9, s[24:27], s55 offen offset:2048 sc1 lds
    v_cvt_pk_bf16_f32 v27, 0, v107
    v_rcp_f32 v17, v17
    v_mfma_f32_16x16x32_bf16 v[152:155], v[12:15], a[212:215], v[152:155]
    ds_read_b64_tr_b16 v[238:239], v34 offset:20736
    v_mul_f32 v17, v17, v21
    v_cvt_pk_bf16_f32 v17, 0, v17
    v_mfma_f32_16x16x32_bf16 v[156:159], v[36:39], a[212:215], v[156:159]
    s_waitcnt lgkmcnt(4)
    v_mul_f32 v17, v17, v19
    v_cvt_pk_bf16_f32 v44, v16, v17
    v_exp_f32 v24, v24
    v_mfma_f32_16x16x32_bf16 v[128:131], v[224:227], a[72:75], v[128:131]
    ds_read_b64_tr_b16 v[12:13], v3 offset:22528
    v_add_f32 v24, 1.0, v24
    v_cvt_pk_bf16_f32 v20, 0, v76
    v_mfma_f32_16x16x32_bf16 v[132:135], v[228:231], a[72:75], v[132:135]
    buffer_load_dwordx4 v9, s[24:27], s55 offen offset:3072 sc1 lds
    v_cvt_pk_bf16_f32 v21, 0, v77
    v_mul_f32 v16, v20, v20
    v_mfma_f32_16x16x32_bf16 v[136:139], v[224:227], a[76:79], v[136:139]
    ds_read_b64_tr_b16 v[14:15], v3 offset:22784
    v_mul_f32 v17, v21, v21
    v_fma_f32 v16, v16, v11, v10
    v_mfma_f32_16x16x32_bf16 v[140:143], v[228:231], a[76:79], v[140:143]
    v_exp_f32 v25, v25
    v_fma_f32 v17, v17, v11, v10
    v_mfma_f32_16x16x32_bf16 v[144:147], v[224:227], a[216:219], v[144:147]
    ds_read_b64_tr_b16 v[36:37], v34 offset:22528
    v_add_f32 v25, 1.0, v25
    v_mul_f32 v16, v16, v20
    v_mfma_f32_16x16x32_bf16 v[148:151], v[228:231], a[216:219], v[148:151]
    s_add_u32 m0, s52, 22528
    s_add_u32 s38, s55, 4096
    s_mov_b32 exec_hi, 0
    buffer_load_dwordx4 v9, s[24:27], s38 offen sc1 lds
    s_mov_b32 exec_hi, -1
    s_add_u32 s55, s55, 73728
    v_mfma_f32_16x16x32_bf16 v[152:155], v[224:227], a[220:223], v[152:155]
    ds_read_b64_tr_b16 v[38:39], v34 offset:22784
    v_mul_f32 v17, v17, v21
    v_cvt_pk_bf16_f32 v18, 0, v108
    v_mfma_f32_16x16x32_bf16 v[156:159], v[228:231], a[220:223], v[156:159]
    s_waitcnt lgkmcnt(4)
    v_rcp_f32 v24, v24
    v_rcp_f32 v25, v25
    v_mfma_f32_16x16x32_bf16 v[128:131], v[232:235], a[80:83], v[128:131]
    ds_read_b64_tr_b16 v[224:225], v3 offset:24576
    v_mul_f32 v24, v24, v28
    v_mul_f32 v25, v25, v29
    v_mfma_f32_16x16x32_bf16 v[132:135], v[236:239], a[80:83], v[132:135]
    buffer_load_dwordx4 a[8:11], v9, s[60:63], s53 offen offset:0 sc1
    v_cvt_pk_bf16_f32 v24, 0, v24
    v_cvt_pk_bf16_f32 v25, 0, v25
    v_mfma_f32_16x16x32_bf16 v[136:139], v[232:235], a[84:87], v[136:139]
    ds_read_b64_tr_b16 v[226:227], v3 offset:24832
    v_mul_f32 v24, v24, v26
    v_mul_f32 v25, v25, v27
    v_mfma_f32_16x16x32_bf16 v[140:143], v[236:239], a[84:87], v[140:143]
    v_cvt_pk_bf16_f32 v45, v24, v25
    v_cvt_pk_bf16_f32 v19, 0, v109
    v_exp_f32 v16, v16
    v_mfma_f32_16x16x32_bf16 v[144:147], v[232:235], a[224:227], v[144:147]
    ds_read_b64_tr_b16 v[228:229], v34 offset:24576
    v_add_f32 v16, 1.0, v16
    v_cvt_pk_bf16_f32 v28, 0, v78
    v_mfma_f32_16x16x32_bf16 v[148:151], v[236:239], a[224:227], v[148:151]
    buffer_load_dwordx4 a[12:15], v9, s[60:63], s53 offen offset:1024 sc1
    v_cvt_pk_bf16_f32 v29, 0, v79
    v_mul_f32 v24, v28, v28
    v_mfma_f32_16x16x32_bf16 v[152:155], v[232:235], a[228:231], v[152:155]
    s_add_u32 s53, s53, 8192
    ds_read_b64_tr_b16 v[230:231], v34 offset:24832
    v_mul_f32 v25, v29, v29
    v_fma_f32 v24, v24, v11, v10
    v_mfma_f32_16x16x32_bf16 v[156:159], v[236:239], a[228:231], v[156:159]
    s_waitcnt lgkmcnt(4)
    v_exp_f32 v17, v17
    v_fma_f32 v25, v25, v11, v10
    v_mfma_f32_16x16x32_bf16 v[128:131], v[12:15], a[88:91], v[128:131]
    ds_read_b64_tr_b16 v[232:233], v3 offset:26624
    v_add_f32 v17, 1.0, v17
    v_mul_f32 v24, v24, v28
    v_mfma_f32_16x16x32_bf16 v[132:135], v[36:39], a[88:91], v[132:135]
    buffer_load_dwordx4 a[152:155], v9, s[60:63], s54 offen offset:0 sc1
    v_mul_f32 v25, v25, v29
    v_cvt_pk_bf16_f32 v26, 0, v110
    v_mfma_f32_16x16x32_bf16 v[136:139], v[12:15], a[92:95], v[136:139]
    ds_read_b64_tr_b16 v[234:235], v3 offset:26880
    v_rcp_f32 v16, v16
    v_mfma_f32_16x16x32_bf16 v[140:143], v[36:39], a[92:95], v[140:143]
    v_rcp_f32 v17, v17
    v_mul_f32 v16, v16, v20
    v_mfma_f32_16x16x32_bf16 v[144:147], v[12:15], a[232:235], v[144:147]
    ds_read_b64_tr_b16 v[236:237], v34 offset:26624
    v_mul_f32 v17, v17, v21
    v_cvt_pk_bf16_f32 v16, 0, v16
    v_mfma_f32_16x16x32_bf16 v[148:151], v[36:39], a[232:235], v[148:151]
    buffer_load_dwordx4 a[156:159], v9, s[60:63], s54 offen offset:1024 sc1
    v_cvt_pk_bf16_f32 v17, 0, v17
    v_mul_f32 v16, v16, v18
    v_mfma_f32_16x16x32_bf16 v[152:155], v[12:15], a[236:239], v[152:155]
    s_add_u32 s54, s54, 8192
    ds_read_b64_tr_b16 v[238:239], v34 offset:26880
    v_mul_f32 v17, v17, v19
    v_cvt_pk_bf16_f32 v46, v16, v17
    v_mfma_f32_16x16x32_bf16 v[156:159], v[36:39], a[236:239], v[156:159]
    s_waitcnt lgkmcnt(4)
    v_exp_f32 v24, v24
    v_cvt_pk_bf16_f32 v27, 0, v111
    v_mfma_f32_16x16x32_bf16 v[128:131], v[224:227], a[96:99], v[128:131]
    ds_read_b64_tr_b16 v[12:13], v3 offset:28672
    v_add_f32 v24, 1.0, v24
    v_exp_f32 v25, v25
    v_mfma_f32_16x16x32_bf16 v[132:135], v[228:231], a[96:99], v[132:135]
    v_add_f32 v25, 1.0, v25
    v_cvt_pk_bf16_f32 v20, 0, v80
    v_cvt_pk_bf16_f32 v21, 0, v81
    v_mfma_f32_16x16x32_bf16 v[136:139], v[224:227], a[100:103], v[136:139]
    ds_read_b64_tr_b16 v[14:15], v3 offset:28928
    v_mul_f32 v16, v20, v20
    v_mul_f32 v17, v21, v21
    v_mfma_f32_16x16x32_bf16 v[140:143], v[228:231], a[100:103], v[140:143]
    s_add_u32 m0, s52, 36864
    v_rcp_f32 v24, v24
    v_fma_f32 v16, v16, v11, v10
    v_mfma_f32_16x16x32_bf16 v[144:147], v[224:227], a[240:243], v[144:147]
    s_nop 0
    ds_read_b64_tr_b16 v[36:37], v34 offset:28672
    v_mul_f32 v24, v24, v28
    v_cvt_pk_bf16_f32 v24, 0, v24
    v_mfma_f32_16x16x32_bf16 v[148:151], v[228:231], a[240:243], v[148:151]
    buffer_load_dwordx4 v9, s[24:27], s55 offen sc1 lds
    v_mul_f32 v24, v24, v26
    v_fma_f32 v17, v17, v11, v10
    v_mfma_f32_16x16x32_bf16 v[152:155], v[224:227], a[244:247], v[152:155]
    ds_read_b64_tr_b16 v[38:39], v34 offset:28928
    v_mul_f32 v16, v16, v20
    v_mul_f32 v17, v17, v21
    v_mfma_f32_16x16x32_bf16 v[156:159], v[228:231], a[244:247], v[156:159]
    s_waitcnt lgkmcnt(4)
    buffer_load_dwordx4 v9, s[24:27], s55 offen offset:1024 sc1 lds
    v_cvt_pk_bf16_f32 v18, 0, v112
    v_rcp_f32 v25, v25
    v_mfma_f32_16x16x32_bf16 v[128:131], v[232:235], a[104:107], v[128:131]
    ds_read_b64_tr_b16 v[224:225], v3 offset:30720
    v_mul_f32 v25, v25, v29
    v_cvt_pk_bf16_f32 v25, 0, v25
    v_mfma_f32_16x16x32_bf16 v[132:135], v[236:239], a[104:107], v[132:135]
    v_mul_f32 v25, v25, v27
    v_cvt_pk_bf16_f32 v47, v24, v25
    v_cvt_pk_bf16_f32 v19, 0, v113
    v_mfma_f32_16x16x32_bf16 v[136:139], v[232:235], a[108:111], v[136:139]
    ds_read_b64_tr_b16 v[226:227], v3 offset:30976
    v_exp_f32 v16, v16
    v_mfma_f32_16x16x32_bf16 v[140:143], v[236:239], a[108:111], v[140:143]
    buffer_load_dwordx4 v9, s[24:27], s55 offen offset:2048 sc1 lds
    v_add_f32 v16, 1.0, v16
    v_exp_f32 v17, v17
    v_mfma_f32_16x16x32_bf16 v[144:147], v[232:235], a[248:251], v[144:147]
    ds_read_b64_tr_b16 v[228:229], v34 offset:30720
    v_add_f32 v17, 1.0, v17
    v_cvt_pk_bf16_f32 v28, 0, v82
    v_mfma_f32_16x16x32_bf16 v[148:151], v[236:239], a[248:251], v[148:151]
    buffer_store_dwordx4 v[44:47], v7, s[20:23], s39 offen offset:1024 sc0 sc1
    v_cvt_pk_bf16_f32 v29, 0, v83
    v_mul_f32 v24, v28, v28
    v_mfma_f32_16x16x32_bf16 v[152:155], v[232:235], a[252:255], v[152:155]
    ds_read_b64_tr_b16 v[230:231], v34 offset:30976
    v_mul_f32 v25, v29, v29
    v_fma_f32 v24, v24, v11, v10
    v_mfma_f32_16x16x32_bf16 v[156:159], v[236:239], a[252:255], v[156:159]
    s_waitcnt lgkmcnt(4)
    buffer_load_dwordx4 v9, s[24:27], s55 offen offset:3072 sc1 lds
    v_fma_f32 v25, v25, v11, v10
    v_mul_f32 v24, v24, v28
    v_mfma_f32_16x16x32_bf16 v[128:131], v[12:15], a[112:115], v[128:131]
    ds_read_b64_tr_b16 v[232:233], v3 offset:32768
    v_mul_f32 v25, v25, v29
    v_cvt_pk_bf16_f32 v26, 0, v114
    v_mfma_f32_16x16x32_bf16 v[132:135], v[36:39], a[112:115], v[132:135]
    v_rcp_f32 v16, v16
    v_rcp_f32 v17, v17
    v_mfma_f32_16x16x32_bf16 v[136:139], v[12:15], a[116:119], v[136:139]
    ds_read_b64_tr_b16 v[234:235], v3 offset:33024
    v_mul_f32 v16, v16, v20
    v_mul_f32 v17, v17, v21
    v_mfma_f32_16x16x32_bf16 v[140:143], v[36:39], a[116:119], v[140:143]
    s_add_u32 m0, s52, 40960
    s_add_u32 s38, s55, 4096
    s_mov_b32 exec_hi, 0
    buffer_load_dwordx4 v9, s[24:27], s38 offen sc1 lds
    s_mov_b32 exec_hi, -1
    s_add_u32 s55, s55, 73728
    v_mfma_f32_16x16x32_bf16 v[144:147], v[12:15], v[192:195], v[144:147]
    ds_read_b64_tr_b16 v[236:237], v34 offset:32768
    v_cvt_pk_bf16_f32 v16, 0, v16
    v_cvt_pk_bf16_f32 v17, 0, v17
    v_mfma_f32_16x16x32_bf16 v[148:151], v[36:39], v[192:195], v[148:151]
    v_mul_f32 v16, v16, v18
    v_mul_f32 v17, v17, v19
    v_cvt_pk_bf16_f32 v40, v16, v17
    v_mfma_f32_16x16x32_bf16 v[152:155], v[12:15], v[196:199], v[152:155]
    ds_read_b64_tr_b16 v[238:239], v34 offset:33024
    v_cvt_pk_bf16_f32 v27, 0, v115
    v_exp_f32 v24, v24
    v_mfma_f32_16x16x32_bf16 v[156:159], v[36:39], v[196:199], v[156:159]
    s_waitcnt lgkmcnt(4)
    buffer_load_dwordx4 a[16:19], v9, s[60:63], s53 offen offset:0 sc1
    v_add_f32 v24, 1.0, v24
    v_cvt_pk_bf16_f32 v20, 0, v84
    v_mfma_f32_16x16x32_bf16 v[128:131], v[224:227], a[120:123], v[128:131]
    ds_read_b64_tr_b16 v[12:13], v3 offset:34816
    v_cvt_pk_bf16_f32 v21, 0, v85
    v_mul_f32 v16, v20, v20
    v_mfma_f32_16x16x32_bf16 v[132:135], v[228:231], a[120:123], v[132:135]
    v_exp_f32 v25, v25
    v_mul_f32 v17, v21, v21
    v_mfma_f32_16x16x32_bf16 v[136:139], v[224:227], a[124:127], v[136:139]
    ds_read_b64_tr_b16 v[14:15], v3 offset:35072
    v_add_f32 v25, 1.0, v25
    v_fma_f32 v16, v16, v11, v10
    v_mfma_f32_16x16x32_bf16 v[140:143], v[228:231], a[124:127], v[140:143]
    buffer_load_dwordx4 a[20:23], v9, s[60:63], s53 offen offset:1024 sc1
    v_fma_f32 v17, v17, v11, v10
    v_mul_f32 v16, v16, v20
    v_mfma_f32_16x16x32_bf16 v[144:147], v[224:227], v[200:203], v[144:147]
    s_add_u32 s53, s53, 8192
    ds_read_b64_tr_b16 v[36:37], v34 offset:34816
    v_mul_f32 v17, v17, v21
    v_cvt_pk_bf16_f32 v18, 0, v116
    v_mfma_f32_16x16x32_bf16 v[148:151], v[228:231], v[200:203], v[148:151]
    v_rcp_f32 v24, v24
    v_rcp_f32 v25, v25
    v_mfma_f32_16x16x32_bf16 v[152:155], v[224:227], v[204:207], v[152:155]
    ds_read_b64_tr_b16 v[38:39], v34 offset:35072
    v_mul_f32 v24, v24, v28
    v_mul_f32 v25, v25, v29
    v_mfma_f32_16x16x32_bf16 v[156:159], v[228:231], v[204:207], v[156:159]
    s_waitcnt lgkmcnt(4)
    buffer_load_dwordx4 a[160:163], v9, s[60:63], s54 offen offset:0 sc1
    v_cvt_pk_bf16_f32 v24, 0, v24
    v_cvt_pk_bf16_f32 v25, 0, v25
    v_mfma_f32_16x16x32_bf16 v[128:131], v[232:235], a[128:131], v[128:131]
    v_mul_f32 v24, v24, v26
    v_mul_f32 v25, v25, v27
    v_cvt_pk_bf16_f32 v41, v24, v25
    v_mfma_f32_16x16x32_bf16 v[132:135], v[236:239], a[128:131], v[132:135]
    v_exp_f32 v16, v16
    v_cvt_pk_bf16_f32 v19, 0, v117
    v_mfma_f32_16x16x32_bf16 v[136:139], v[232:235], a[132:135], v[136:139]
    v_exp_f32 v17, v17
    v_add_f32 v16, 1.0, v16
    v_mfma_f32_16x16x32_bf16 v[140:143], v[236:239], a[132:135], v[140:143]
    v_add_f32 v17, 1.0, v17
    v_cvt_pk_bf16_f32 v28, 0, v86
    v_cvt_pk_bf16_f32 v29, 0, v87
    v_mfma_f32_16x16x32_bf16 v[144:147], v[232:235], v[208:211], v[144:147]
    v_rcp_f32 v16, v16
    v_mul_f32 v24, v28, v28
    v_mfma_f32_16x16x32_bf16 v[148:151], v[236:239], v[208:211], v[148:151]
    buffer_load_dwordx4 a[164:167], v9, s[60:63], s54 offen offset:1024 sc1
    v_mul_f32 v16, v16, v20
    v_cvt_pk_bf16_f32 v16, 0, v16
    v_mfma_f32_16x16x32_bf16 v[152:155], v[232:235], v[212:215], v[152:155]
    s_add_u32 s54, s54, 8192
    v_rcp_f32 v17, v17
    v_mul_f32 v16, v16, v18
    v_mfma_f32_16x16x32_bf16 v[156:159], v[236:239], v[212:215], v[156:159]
    s_waitcnt lgkmcnt(0)
    v_mul_f32 v17, v17, v21
    v_cvt_pk_bf16_f32 v17, 0, v17
    v_mul_f32 v17, v17, v19
    v_mfma_f32_16x16x32_bf16 v[128:131], v[12:15], a[136:139], v[128:131]
    v_cvt_pk_bf16_f32 v42, v16, v17
    v_mul_f32 v25, v29, v29
    v_fma_f32 v24, v24, v11, v10
    v_mfma_f32_16x16x32_bf16 v[132:135], v[36:39], a[136:139], v[132:135]
    v_fma_f32 v25, v25, v11, v10
    v_mul_f32 v24, v24, v28
    v_mul_f32 v25, v25, v29
    v_mfma_f32_16x16x32_bf16 v[136:139], v[12:15], a[140:143], v[136:139]
    v_exp_f32 v24, v24
    v_cvt_pk_bf16_f32 v26, 0, v118
    v_mfma_f32_16x16x32_bf16 v[140:143], v[36:39], a[140:143], v[140:143]
    v_exp_f32 v25, v25
    v_add_f32 v24, 1.0, v24
    v_mfma_f32_16x16x32_bf16 v[144:147], v[12:15], v[216:219], v[144:147]
    v_add_f32 v25, 1.0, v25
    v_cvt_pk_bf16_f32 v27, 0, v119
    v_cvt_pk_bf16_f32 v20, 0, v88
    v_cvt_pk_bf16_f32 v21, 0, v89
    v_mul_f32 v16, v20, v20
    v_mul_f32 v17, v21, v21
    v_fma_f32 v16, v16, v11, v10
    v_fma_f32 v17, v17, v11, v10
    v_mul_f32 v16, v16, v20
    v_mul_f32 v17, v17, v21
    v_rcp_f32 v24, v24
    v_cvt_pk_bf16_f32 v18, 0, v120
    v_mul_f32 v24, v24, v28
    v_cvt_pk_bf16_f32 v24, 0, v24
    v_mul_f32 v24, v24, v26
    v_rcp_f32 v25, v25
    v_cvt_pk_bf16_f32 v19, 0, v121
    v_mul_f32 v25, v25, v29
    v_cvt_pk_bf16_f32 v25, 0, v25
    v_mul_f32 v25, v25, v27
    v_cvt_pk_bf16_f32 v43, v24, v25
    v_exp_f32 v16, v16
    v_exp_f32 v17, v17
    v_add_f32 v16, 1.0, v16
    v_add_f32 v17, 1.0, v17
    v_cvt_pk_bf16_f32 v28, 0, v90
    v_cvt_pk_bf16_f32 v29, 0, v91
    v_mul_f32 v24, v28, v28
    v_mul_f32 v25, v29, v29
    v_fma_f32 v24, v24, v11, v10
    v_fma_f32 v25, v25, v11, v10
    v_mul_f32 v24, v24, v28
    v_mul_f32 v25, v25, v29
    v_rcp_f32 v16, v16
    v_cvt_pk_bf16_f32 v26, 0, v122
    v_mul_f32 v16, v16, v20
    v_cvt_pk_bf16_f32 v16, 0, v16
    v_mul_f32 v16, v16, v18
    v_rcp_f32 v17, v17
    v_cvt_pk_bf16_f32 v27, 0, v123
    v_mul_f32 v17, v17, v21
    v_cvt_pk_bf16_f32 v17, 0, v17
    v_mul_f32 v17, v17, v19
    v_cvt_pk_bf16_f32 v44, v16, v17
    v_exp_f32 v24, v24
    v_exp_f32 v25, v25
    v_add_f32 v24, 1.0, v24
    v_add_f32 v25, 1.0, v25
    v_cvt_pk_bf16_f32 v20, 0, v92
    v_cvt_pk_bf16_f32 v21, 0, v93
    v_mul_f32 v16, v20, v20
    v_mul_f32 v17, v21, v21
    v_fma_f32 v16, v16, v11, v10
    v_fma_f32 v17, v17, v11, v10
    v_mul_f32 v16, v16, v20
    v_mul_f32 v17, v17, v21
    v_rcp_f32 v24, v24
    v_cvt_pk_bf16_f32 v18, 0, v124
    v_mul_f32 v24, v24, v28
    v_cvt_pk_bf16_f32 v24, 0, v24
    v_mul_f32 v24, v24, v26
    v_rcp_f32 v25, v25
    v_cvt_pk_bf16_f32 v19, 0, v125
    v_mul_f32 v25, v25, v29
    v_cvt_pk_bf16_f32 v25, 0, v25
    v_mul_f32 v25, v25, v27
    v_cvt_pk_bf16_f32 v45, v24, v25
    v_exp_f32 v16, v16
    v_exp_f32 v17, v17
    v_add_f32 v16, 1.0, v16
    v_add_f32 v17, 1.0, v17
    v_cvt_pk_bf16_f32 v28, 0, v94
    v_cvt_pk_bf16_f32 v29, 0, v95
    v_mul_f32 v24, v28, v28
    v_mul_f32 v25, v29, v29
    v_fma_f32 v24, v24, v11, v10
    v_fma_f32 v25, v25, v11, v10
    v_mul_f32 v24, v24, v28
    v_mul_f32 v25, v25, v29
    v_rcp_f32 v16, v16
    v_cvt_pk_bf16_f32 v26, 0, v126
    v_mul_f32 v16, v16, v20
    v_cvt_pk_bf16_f32 v16, 0, v16
    v_mul_f32 v16, v16, v18
    v_rcp_f32 v17, v17
    v_cvt_pk_bf16_f32 v27, 0, v127
    v_mul_f32 v17, v17, v21
    v_cvt_pk_bf16_f32 v17, 0, v17
    v_mul_f32 v17, v17, v19
    v_cvt_pk_bf16_f32 v46, v16, v17
    v_exp_f32 v24, v24
    v_exp_f32 v25, v25
    v_add_f32 v24, 1.0, v24
    v_add_f32 v25, 1.0, v25
    v_rcp_f32 v24, v24
    v_rcp_f32 v25, v25
    v_mul_f32 v24, v24, v28
    v_mul_f32 v25, v25, v29
    v_cvt_pk_bf16_f32 v24, 0, v24
    v_cvt_pk_bf16_f32 v25, 0, v25
    v_mul_f32 v24, v24, v26
    v_mul_f32 v25, v25, v27
    v_cvt_pk_bf16_f32 v47, v24, v25
    buffer_store_dwordx4 v[40:43], v7, s[20:23], s39 offen offset:2048 sc0 sc1
    buffer_store_dwordx4 v[44:47], v7, s[20:23], s39 offen offset:3072 sc0 sc1
    s_add_u32 s39, s39, 32768
    v_mfma_f32_16x16x32_bf16 v[148:151], v[36:39], v[216:219], v[148:151]
    v_mfma_f32_16x16x32_bf16 v[152:155], v[12:15], v[220:223], v[152:155]
    v_mfma_f32_16x16x32_bf16 v[156:159], v[36:39], v[220:223], v[156:159]
    s_branch L_k1_qlast
L_k1_q4:
    s_cmp_eq_u32 s29, 3
    s_cbranch_scc1 L_k1_q3
    s_waitcnt lgkmcnt(0)
    s_mov_b64 s[88:89], s[64:65]
    s_mov_b64 s[90:91], s[66:67]
    s_mov_b64 s[66:67], s[4:5]
    s_mov_b64 s[70:71], s[6:7]
    s_load_dwordx2 s[4:5], s[0:1], 0
    s_load_dwordx2 s[58:59], s[0:1], 56
    s_bfe_u32 s29, s2, 0x20001
    s_and_b32 s30, s2, 1
    s_lshl_b32 s30, s30, 3
    s_lshr_b32 s35, s2, 5
    s_add_u32 s30, s30, s35
    s_bfe_u32 s31, s2, 0x20003
    s_and_b32 s32, s28, 1
    s_lshr_b32 s36, s28, 1
    s_mul_i32 s52, s32, 9216
    s_mul_i32 s3, s36, 4608
    s_add_u32 s52, s52, s3
    s_mul_i32 s33, s32, 36864
    s_add_u32 s33, s33, s3
    s_mul_i32 s35, s31, 9216
    s_add_u32 s33, s33, s35
    s_mul_i32 s55, s29, 1327104
    s_add_u32 s55, s55, s33
    s_add_u32 s33, s33, 5308416
    s_add_u32 s24, s6, 0x03400000
    s_addc_u32 s25, s7, 0
    s_and_b32 s25, s25, 0xffff
    s_mov_b32 s26, 0x005b2000
    s_mov_b32 s27, 0x00020000
    s_lshl_b32 s3, s30, 1
    s_add_u32 s3, s3, s36
    s_mul_i32 s3, s3, 162
    s_mul_i32 s35, s29, 36
    s_add_u32 s3, s3, s35
    s_lshl_b32 s3, s3, 12
    s_lshl_b32 s35, s32, 11
    s_add_u32 s53, s3, s35
    s_add_u32 s54, s53, 4096
    v_cvt_pk_bf16_f32 v48, v64, v65
    v_cvt_pk_bf16_f32 v49, v66, v67
    v_cvt_pk_bf16_f32 v50, v68, v69
    v_cvt_pk_bf16_f32 v51, v70, v71
    buffer_store_dwordx4 v[48:51], v8, s[16:19], s41 offen offset:0 sc0 sc1
    v_cvt_pk_bf16_f32 v52, v72, v73
    v_cvt_pk_bf16_f32 v53, v74, v75
    v_cvt_pk_bf16_f32 v54, v76, v77
    v_cvt_pk_bf16_f32 v55, v78, v79
    buffer_store_dwordx4 v[52:55], v8, s[16:19], s41 offen offset:128 sc0 sc1
    v_cvt_pk_bf16_f32 v56, v80, v81
    v_cvt_pk_bf16_f32 v57, v82, v83
    v_cvt_pk_bf16_f32 v58, v84, v85
    v_cvt_pk_bf16_f32 v59, v86, v87
    buffer_store_dwordx4 v[56:59], v8, s[16:19], s41 offen offset:256 sc0 sc1
    v_cvt_pk_bf16_f32 v60, v88, v89
    v_cvt_pk_bf16_f32 v61, v90, v91
    v_cvt_pk_bf16_f32 v62, v92, v93
    v_cvt_pk_bf16_f32 v63, v94, v95
    buffer_store_dwordx4 v[60:63], v8, s[16:19], s41 offen offset:384 sc0 sc1
    s_add_u32 s41, s41, 131072
    s_add_u32 s42, s42, 131072
    s_waitcnt vmcnt(5)
L_g2e1:
    v_xor_b32 v244, s66, v244
    v_xor_b32 v245, s67, v245
    v_or_b32 v244, v244, v245
    v_cmp_ne_u32 vcc, 0, v244
    s_nop 3
    s_cmp_eq_u64 vcc, 0
    s_cbranch_scc1 L_g2eok1
    s_sleep 2
    buffer_load_dwordx2 v[244:245], v246, s[88:91], s79 offen sc1
    s_waitcnt vmcnt(0)
    s_branch L_g2e1
L_g2eok1:
    s_barrier
    s_add_u32 m0, s52, 0
    s_nop 0
    buffer_load_dwordx4 v9, s[24:27], s55 offen sc1 lds
    buffer_load_dwordx4 v9, s[24:27], s55 offen offset:1024 sc1 lds
    buffer_load_dwordx4 v9, s[24:27], s55 offen offset:2048 sc1 lds
    buffer_load_dwordx4 v9, s[24:27], s55 offen offset:3072 sc1 lds
    s_add_u32 m0, s52, 4096
    s_add_u32 s38, s55, 4096
    s_mov_b32 exec_hi, 0
    buffer_load_dwordx4 v9, s[24:27], s38 offen sc1 lds
    s_mov_b32 exec_hi, -1
    s_add_u32 s55, s55, 73728
    buffer_load_dwordx4 a[0:3], v9, s[20:23], s53 offen offset:0 sc1
    buffer_load_dwordx4 a[4:7], v9, s[20:23], s53 offen offset:1024 sc1
    s_add_u32 s53, s53, 8192
    buffer_load_dwordx4 a[144:147], v9, s[20:23], s54 offen offset:0 sc1
    buffer_load_dwordx4 a[148:151], v9, s[20:23], s54 offen offset:1024 sc1
    s_add_u32 s54, s54, 8192
    s_add_u32 m0, s52, 18432
    s_nop 0
    buffer_load_dwordx4 v9, s[24:27], s55 offen sc1 lds
    buffer_load_dwordx4 v9, s[24:27], s55 offen offset:1024 sc1 lds
    buffer_load_dwordx4 v9, s[24:27], s55 offen offset:2048 sc1 lds
    buffer_load_dwordx4 v9, s[24:27], s55 offen offset:3072 sc1 lds
    s_add_u32 m0, s52, 22528
    s_add_u32 s38, s55, 4096
    s_mov_b32 exec_hi, 0
    buffer_load_dwordx4 v9, s[24:27], s38 offen sc1 lds
    s_mov_b32 exec_hi, -1
    s_add_u32 s55, s55, 73728
    buffer_load_dwordx4 a[8:11], v9, s[20:23], s53 offen offset:0 sc1
    buffer_load_dwordx4 a[12:15], v9, s[20:23], s53 offen offset:1024 sc1
    s_add_u32 s53, s53, 8192
    buffer_load_dwordx4 a[152:155], v9, s[20:23], s54 offen offset:0 sc1
    buffer_load_dwordx4 a[156:159], v9, s[20:23], s54 offen offset:1024 sc1
    s_add_u32 s54, s54, 8192
    s_add_u32 m0, s52, 36864
    s_nop 0
    buffer_load_dwordx4 v9, s[24:27], s55 offen sc1 lds
    buffer_load_dwordx4 v9, s[24:27], s55 offen offset:1024 sc1 lds
    buffer_load_dwordx4 v9, s[24:27], s55 offen offset:2048 sc1 lds
    buffer_load_dwordx4 v9, s[24:27], s55 offen offset:3072 sc1 lds
    s_add_u32 m0, s52, 40960
    s_add_u32 s38, s55, 4096
    s_mov_b32 exec_hi, 0
    buffer_load_dwordx4 v9, s[24:27], s38 offen sc1 lds
    s_mov_b32 exec_hi, -1
    s_add_u32 s55, s55, 73728
    buffer_load_dwordx4 a[16:19], v9, s[20:23], s53 offen offset:0 sc1
    buffer_load_dwordx4 a[20:23], v9, s[20:23], s53 offen offset:1024 sc1
    s_add_u32 s53, s53, 8192
    buffer_load_dwordx4 a[160:163], v9, s[20:23], s54 offen offset:0 sc1
    buffer_load_dwordx4 a[164:167], v9, s[20:23], s54 offen offset:1024 sc1
    s_add_u32 s54, s54, 8192
    v_cvt_pk_bf16_f32 v16, v96, v97
    v_cvt_pk_bf16_f32 v17, v98, v99
    v_cvt_pk_bf16_f32 v18, v100, v101
    v_cvt_pk_bf16_f32 v19, v102, v103
    buffer_store_dwordx4 v[16:19], v8, s[16:19], s41 offen offset:0 sc0 sc1
    v_cvt_pk_bf16_f32 v20, v104, v105
    v_cvt_pk_bf16_f32 v21, v106, v107
    v_cvt_pk_bf16_f32 v22, v108, v109
    v_cvt_pk_bf16_f32 v23, v110, v111
    buffer_store_dwordx4 v[20:23], v8, s[16:19], s41 offen offset:128 sc0 sc1
    v_cvt_pk_bf16_f32 v24, v112, v113
    v_cvt_pk_bf16_f32 v25, v114, v115
    v_cvt_pk_bf16_f32 v26, v116, v117
    v_cvt_pk_bf16_f32 v27, v118, v119
    buffer_store_dwordx4 v[24:27], v8, s[16:19], s41 offen offset:256 sc0 sc1
    v_cvt_pk_bf16_f32 v28, v120, v121
    v_cvt_pk_bf16_f32 v29, v122, v123
    v_cvt_pk_bf16_f32 v30, v124, v125
    v_cvt_pk_bf16_f32 v31, v126, v127
    buffer_store_dwordx4 v[28:31], v8, s[16:19], s41 offen offset:384 sc0 sc1
    s_add_u32 s41, s41, 131072
    s_add_u32 s42, s42, 131072
    s_branch L_k1_fin
L_k1_q3:
    s_waitcnt lgkmcnt(4)
    v_mfma_f32_16x16x32_bf16 v[128:131], v[224:227], a[0:3], 0
    ds_read_b64_tr_b16 v[12:13], v3 offset:4096
    v_mfma_f32_16x16x32_bf16 v[132:135], v[228:231], a[0:3], 0
    s_mov_b64 s[88:89], s[64:65]
    v_mfma_f32_16x16x32_bf16 v[136:139], v[224:227], a[4:7], 0
    s_mov_b64 s[90:91], s[66:67]
    ds_read_b64_tr_b16 v[14:15], v3 offset:4352
    v_mfma_f32_16x16x32_bf16 v[140:143], v[228:231], a[4:7], 0
    s_mov_b64 s[66:67], s[4:5]
    v_mfma_f32_16x16x32_bf16 v[144:147], v[224:227], a[144:147], 0
    s_mov_b64 s[70:71], s[6:7]
    ds_read_b64_tr_b16 v[36:37], v34 offset:4096
    v_cvt_pk_bf16_f32 v48, v64, v65
    v_cvt_pk_bf16_f32 v49, v66, v67
    v_mfma_f32_16x16x32_bf16 v[148:151], v[228:231], a[144:147], 0
    s_load_dwordx2 s[4:5], s[0:1], 0
    v_cvt_pk_bf16_f32 v50, v68, v69
    v_cvt_pk_bf16_f32 v51, v70, v71
    v_mfma_f32_16x16x32_bf16 v[152:155], v[224:227], a[148:151], 0
    s_load_dwordx2 s[58:59], s[0:1], 56
    ds_read_b64_tr_b16 v[38:39], v34 offset:4352
    v_cvt_pk_bf16_f32 v52, v72, v73
    v_mfma_f32_16x16x32_bf16 v[156:159], v[228:231], a[148:151], 0
    s_waitcnt lgkmcnt(4)
    buffer_store_dwordx4 v[48:51], v8, s[16:19], s41 offen offset:0 sc0 sc1
    v_cvt_pk_bf16_f32 v53, v74, v75
    v_mfma_f32_16x16x32_bf16 v[128:131], v[232:235], a[8:11], v[128:131]
    s_bfe_u32 s29, s2, 0x20001
    ds_read_b64_tr_b16 v[224:225], v3 offset:6144
    v_cvt_pk_bf16_f32 v54, v76, v77
    v_mfma_f32_16x16x32_bf16 v[132:135], v[236:239], a[8:11], v[132:135]
    s_and_b32 s30, s2, 1
    s_lshl_b32 s30, s30, 3
    s_lshr_b32 s35, s2, 5
    s_add_u32 s30, s30, s35
    s_bfe_u32 s31, s2, 0x20003
    s_and_b32 s32, s28, 1
    s_lshr_b32 s36, s28, 1
    v_mfma_f32_16x16x32_bf16 v[136:139], v[232:235], a[12:15], v[136:139]
    s_mul_i32 s52, s32, 9216
    ds_read_b64_tr_b16 v[226:227], v3 offset:6400
    v_cvt_pk_bf16_f32 v55, v78, v79
    v_mfma_f32_16x16x32_bf16 v[140:143], v[236:239], a[12:15], v[140:143]
    s_mul_i32 s3, s36, 4608
    buffer_store_dwordx4 v[52:55], v8, s[16:19], s41 offen offset:128 sc0 sc1
    s_add_u32 s52, s52, s3
    s_mul_i32 s33, s32, 36864
    s_add_u32 s33, s33, s3
    s_mul_i32 s35, s31, 9216
    s_add_u32 s33, s33, s35
    s_mul_i32 s55, s29, 1327104
    s_add_u32 s55, s55, s33
    s_add_u32 s33, s33, 5308416
    s_add_u32 s24, s6, 0x03400000
    s_addc_u32 s25, s7, 0
    s_and_b32 s25, s25, 0xffff
    s_mov_b32 s26, 0x005b2000
    s_mov_b32 s27, 0x00020000
    v_mfma_f32_16x16x32_bf16 v[144:147], v[232:235], a[152:155], v[144:147]
    s_lshl_b32 s3, s30, 1
    ds_read_b64_tr_b16 v[228:229], v34 offset:6144
    v_cvt_pk_bf16_f32 v56, v80, v81
    v_mfma_f32_16x16x32_bf16 v[148:151], v[236:239], a[152:155], v[148:151]
    s_add_u32 s3, s3, s36
    v_cvt_pk_bf16_f32 v57, v82, v83
    v_cvt_pk_bf16_f32 v58, v84, v85
    v_mfma_f32_16x16x32_bf16 v[152:155], v[232:235], a[156:159], v[152:155]
    s_mul_i32 s3, s3, 162
    ds_read_b64_tr_b16 v[230:231], v34 offset:6400
    v_cvt_pk_bf16_f32 v59, v86, v87
    v_mfma_f32_16x16x32_bf16 v[156:159], v[236:239], a[156:159], v[156:159]
    s_waitcnt lgkmcnt(4)
    buffer_store_dwordx4 v[56:59], v8, s[16:19], s41 offen offset:256 sc0 sc1
    s_mul_i32 s35, s29, 36
    s_add_u32 s3, s3, s35
    s_lshl_b32 s3, s3, 12
    s_lshl_b32 s35, s32, 11
    s_add_u32 s53, s3, s35
    s_add_u32 s54, s53, 4096
    s_waitcnt vmcnt(4)
    v_xor_b32 v244, s66, v244
    v_xor_b32 v245, s67, v245
    v_or_b32 v244, v244, v245
    v_cmp_ne_u32 vcc, 0, v244
    s_lshl_b32 s77, s28, 2
    s_add_u32 s77, s77, 36848
    v_mov_b32 v247, s77
    s_nop 1
    s_cmp_eq_u64 vcc, 0
    s_cselect_b32 s77, 1, 0
    v_mov_b32 v244, s77
    ds_write_b32 v247, v244
    v_mov_b32 v247, 36848
    v_mfma_f32_16x16x32_bf16 v[128:131], v[12:15], a[16:19], v[128:131]
    ds_read_b64_tr_b16 v[232:233], v3 offset:8192
    v_cvt_pk_bf16_f32 v60, v88, v89
    v_mfma_f32_16x16x32_bf16 v[132:135], v[36:39], a[16:19], v[132:135]
    s_waitcnt lgkmcnt(1)
    s_barrier
    ds_read_b128 v[240:243], v247
    s_mov_b64 s[60:61], s[20:21]
    s_mov_b32 s63, s23
    v_mfma_f32_16x16x32_bf16 v[136:139], v[12:15], a[20:23], v[136:139]
    ds_read_b64_tr_b16 v[234:235], v3 offset:8448
    v_cvt_pk_bf16_f32 v61, v90, v91
    v_mfma_f32_16x16x32_bf16 v[140:143], v[36:39], a[20:23], v[140:143]
    v_cvt_pk_bf16_f32 v62, v92, v93
    v_cvt_pk_bf16_f32 v63, v94, v95
    v_mfma_f32_16x16x32_bf16 v[144:147], v[12:15], a[160:163], v[144:147]
    ds_read_b64_tr_b16 v[236:237], v34 offset:8192
    v_mfma_f32_16x16x32_bf16 v[148:151], v[36:39], a[160:163], v[148:151]
    buffer_store_dwordx4 v[60:63], v8, s[16:19], s41 offen offset:384 sc0 sc1
    v_mfma_f32_16x16x32_bf16 v[152:155], v[12:15], a[164:167], v[152:155]
    s_add_u32 s41, s41, 131072
    ds_read_b64_tr_b16 v[238:239], v34 offset:8448
    v_mfma_f32_16x16x32_bf16 v[156:159], v[36:39], a[164:167], v[156:159]
    s_waitcnt lgkmcnt(4)
    s_waitcnt lgkmcnt(2)
    v_and_b32 v240, v240, v241
    v_and_b32 v242, v242, v243
    v_and_b32 v240, v240, v242
    s_nop 0
    v_readfirstlane_b32 s37, v240
    s_nop 3
    s_cmp_lg_u32 s37, 0
    s_cselect_b32 s62, s22, 0
    s_cselect_b32 s26, s26, 0
    v_mfma_f32_16x16x32_bf16 v[128:131], v[224:227], a[24:27], v[128:131]
    s_add_u32 m0, s52, 0
    ds_read_b64_tr_b16 v[12:13], v3 offset:10240
    v_mfma_f32_16x16x32_bf16 v[132:135], v[228:231], a[24:27], v[132:135]
    s_nop 0
    buffer_load_dwordx4 v9, s[24:27], s55 offen sc1 lds
    v_mfma_f32_16x16x32_bf16 v[136:139], v[224:227], a[28:31], v[136:139]
    s_add_u32 s42, s42, 131072
    ds_read_b64_tr_b16 v[14:15], v3 offset:10496
    v_cvt_pk_bf16_f32 v16, v96, v97
    v_mfma_f32_16x16x32_bf16 v[140:143], v[228:231], a[28:31], v[140:143]
    buffer_load_dwordx4 v9, s[24:27], s55 offen offset:1024 sc1 lds
    v_cvt_pk_bf16_f32 v17, v98, v99
    v_mfma_f32_16x16x32_bf16 v[144:147], v[224:227], a[168:171], v[144:147]
    ds_read_b64_tr_b16 v[36:37], v34 offset:10240
    v_cvt_pk_bf16_f32 v18, v100, v101
    v_mfma_f32_16x16x32_bf16 v[148:151], v[228:231], a[168:171], v[148:151]
    v_cvt_pk_bf16_f32 v19, v102, v103
    v_cvt_pk_bf16_f32 v20, v104, v105
    v_mfma_f32_16x16x32_bf16 v[152:155], v[224:227], a[172:175], v[152:155]
    ds_read_b64_tr_b16 v[38:39], v34 offset:10496
    v_cvt_pk_bf16_f32 v21, v106, v107
    v_mfma_f32_16x16x32_bf16 v[156:159], v[228:231], a[172:175], v[156:159]
    s_waitcnt lgkmcnt(4)
    buffer_load_dwordx4 v9, s[24:27], s55 offen offset:2048 sc1 lds
    v_cvt_pk_bf16_f32 v22, v108, v109
    v_mfma_f32_16x16x32_bf16 v[128:131], v[232:235], a[32:35], v[128:131]
    ds_read_b64_tr_b16 v[224:225], v3 offset:12288
    v_cvt_pk_bf16_f32 v23, v110, v111
    v_mfma_f32_16x16x32_bf16 v[132:135], v[236:239], a[32:35], v[132:135]
    buffer_store_dwordx4 v[16:19], v8, s[16:19], s41 offen offset:0 sc0 sc1
    v_cvt_pk_bf16_f32 v24, v112, v113
    v_mfma_f32_16x16x32_bf16 v[136:139], v[232:235], a[36:39], v[136:139]
    ds_read_b64_tr_b16 v[226:227], v3 offset:12544
    v_cvt_pk_bf16_f32 v25, v114, v115
    v_mfma_f32_16x16x32_bf16 v[140:143], v[236:239], a[36:39], v[140:143]
    buffer_load_dwordx4 v9, s[24:27], s55 offen offset:3072 sc1 lds
    v_cvt_pk_bf16_f32 v26, v116, v117
    v_mfma_f32_16x16x32_bf16 v[144:147], v[232:235], a[176:179], v[144:147]
    ds_read_b64_tr_b16 v[228:229], v34 offset:12288
    v_cvt_pk_bf16_f32 v27, v118, v119
    v_mfma_f32_16x16x32_bf16 v[148:151], v[236:239], a[176:179], v[148:151]
    buffer_store_dwordx4 v[20:23], v8, s[16:19], s41 offen offset:128 sc0 sc1
    v_cvt_pk_bf16_f32 v28, v120, v121
    v_mfma_f32_16x16x32_bf16 v[152:155], v[232:235], a[180:183], v[152:155]
    ds_read_b64_tr_b16 v[230:231], v34 offset:12544
    v_cvt_pk_bf16_f32 v29, v122, v123
    v_mfma_f32_16x16x32_bf16 v[156:159], v[236:239], a[180:183], v[156:159]
    s_waitcnt lgkmcnt(4)
    buffer_store_dwordx4 v[24:27], v8, s[16:19], s41 offen offset:256 sc0 sc1
    v_cvt_pk_bf16_f32 v30, v124, v125
    v_mfma_f32_16x16x32_bf16 v[128:131], v[12:15], a[40:43], v[128:131]
    ds_read_b64_tr_b16 v[232:233], v3 offset:14336
    v_cvt_pk_bf16_f32 v31, v126, v127
    v_mfma_f32_16x16x32_bf16 v[132:135], v[36:39], a[40:43], v[132:135]
    buffer_store_dwordx4 v[28:31], v8, s[16:19], s41 offen offset:384 sc0 sc1
    v_mfma_f32_16x16x32_bf16 v[136:139], v[12:15], a[44:47], v[136:139]
    s_add_u32 s41, s41, 131072
    ds_read_b64_tr_b16 v[234:235], v3 offset:14592
    s_add_u32 m0, s52, 4096
    s_add_u32 s38, s55, 4096
    s_mov_b32 exec_hi, 0
    buffer_load_dwordx4 v9, s[24:27], s38 offen sc1 lds
    s_mov_b32 exec_hi, -1
    s_add_u32 s55, s55, 73728
    v_mfma_f32_16x16x32_bf16 v[140:143], v[36:39], a[44:47], v[140:143]
    s_add_u32 s42, s42, 131072
    buffer_load_dwordx4 a[0:3], v9, s[60:63], s53 offen offset:0 sc1
    v_mfma_f32_16x16x32_bf16 v[144:147], v[12:15], a[184:187], v[144:147]
    ds_read_b64_tr_b16 v[236:237], v34 offset:14336
    v_mfma_f32_16x16x32_bf16 v[148:151], v[36:39], a[184:187], v[148:151]
    v_mfma_f32_16x16x32_bf16 v[152:155], v[12:15], a[188:191], v[152:155]
    ds_read_b64_tr_b16 v[238:239], v34 offset:14592
    v_mfma_f32_16x16x32_bf16 v[156:159], v[36:39], a[188:191], v[156:159]
    s_waitcnt lgkmcnt(4)
    buffer_load_dwordx4 a[4:7], v9, s[60:63], s53 offen offset:1024 sc1
    v_mfma_f32_16x16x32_bf16 v[128:131], v[224:227], a[48:51], v[128:131]
    s_add_u32 s53, s53, 8192
    ds_read_b64_tr_b16 v[12:13], v3 offset:16384
    v_mfma_f32_16x16x32_bf16 v[132:135], v[228:231], a[48:51], v[132:135]
    v_mfma_f32_16x16x32_bf16 v[136:139], v[224:227], a[52:55], v[136:139]
    ds_read_b64_tr_b16 v[14:15], v3 offset:16640
    v_mfma_f32_16x16x32_bf16 v[140:143], v[228:231], a[52:55], v[140:143]
    buffer_load_dwordx4 a[144:147], v9, s[60:63], s54 offen offset:0 sc1
    v_mfma_f32_16x16x32_bf16 v[144:147], v[224:227], a[192:195], v[144:147]
    ds_read_b64_tr_b16 v[36:37], v34 offset:16384
    v_mfma_f32_16x16x32_bf16 v[148:151], v[228:231], a[192:195], v[148:151]
    v_mfma_f32_16x16x32_bf16 v[152:155], v[224:227], a[196:199], v[152:155]
    ds_read_b64_tr_b16 v[38:39], v34 offset:16640
    v_mfma_f32_16x16x32_bf16 v[156:159], v[228:231], a[196:199], v[156:159]
    s_waitcnt lgkmcnt(4)
    buffer_load_dwordx4 a[148:151], v9, s[60:63], s54 offen offset:1024 sc1
    v_mfma_f32_16x16x32_bf16 v[128:131], v[232:235], a[56:59], v[128:131]
    s_add_u32 s54, s54, 8192
    ds_read_b64_tr_b16 v[224:225], v3 offset:18432
    v_mfma_f32_16x16x32_bf16 v[132:135], v[236:239], a[56:59], v[132:135]
    v_mfma_f32_16x16x32_bf16 v[136:139], v[232:235], a[60:63], v[136:139]
    ds_read_b64_tr_b16 v[226:227], v3 offset:18688
    v_mfma_f32_16x16x32_bf16 v[140:143], v[236:239], a[60:63], v[140:143]
    v_mfma_f32_16x16x32_bf16 v[144:147], v[232:235], a[200:203], v[144:147]
    ds_read_b64_tr_b16 v[228:229], v34 offset:18432
    v_mfma_f32_16x16x32_bf16 v[148:151], v[236:239], a[200:203], v[148:151]
    s_add_u32 m0, s52, 18432
    v_mfma_f32_16x16x32_bf16 v[152:155], v[232:235], a[204:207], v[152:155]
    s_nop 0
    ds_read_b64_tr_b16 v[230:231], v34 offset:18688
    v_mfma_f32_16x16x32_bf16 v[156:159], v[236:239], a[204:207], v[156:159]
    s_waitcnt lgkmcnt(4)
    buffer_load_dwordx4 v9, s[24:27], s55 offen sc1 lds
    v_mfma_f32_16x16x32_bf16 v[128:131], v[12:15], a[64:67], v[128:131]
    ds_read_b64_tr_b16 v[232:233], v3 offset:20480
    v_mfma_f32_16x16x32_bf16 v[132:135], v[36:39], a[64:67], v[132:135]
    buffer_load_dwordx4 v9, s[24:27], s55 offen offset:1024 sc1 lds
    v_mfma_f32_16x16x32_bf16 v[136:139], v[12:15], a[68:71], v[136:139]
    ds_read_b64_tr_b16 v[234:235], v3 offset:20736
    v_mfma_f32_16x16x32_bf16 v[140:143], v[36:39], a[68:71], v[140:143]
    v_mfma_f32_16x16x32_bf16 v[144:147], v[12:15], a[208:211], v[144:147]
    ds_read_b64_tr_b16 v[236:237], v34 offset:20480
    v_mfma_f32_16x16x32_bf16 v[148:151], v[36:39], a[208:211], v[148:151]
    buffer_load_dwordx4 v9, s[24:27], s55 offen offset:2048 sc1 lds
    v_mfma_f32_16x16x32_bf16 v[152:155], v[12:15], a[212:215], v[152:155]
    ds_read_b64_tr_b16 v[238:239], v34 offset:20736
    v_mfma_f32_16x16x32_bf16 v[156:159], v[36:39], a[212:215], v[156:159]
    s_waitcnt lgkmcnt(4)
    v_mfma_f32_16x16x32_bf16 v[128:131], v[224:227], a[72:75], v[128:131]
    ds_read_b64_tr_b16 v[12:13], v3 offset:22528
    v_mfma_f32_16x16x32_bf16 v[132:135], v[228:231], a[72:75], v[132:135]
    buffer_load_dwordx4 v9, s[24:27], s55 offen offset:3072 sc1 lds
    v_mfma_f32_16x16x32_bf16 v[136:139], v[224:227], a[76:79], v[136:139]
    ds_read_b64_tr_b16 v[14:15], v3 offset:22784
    v_mfma_f32_16x16x32_bf16 v[140:143], v[228:231], a[76:79], v[140:143]
    v_mfma_f32_16x16x32_bf16 v[144:147], v[224:227], a[216:219], v[144:147]
    ds_read_b64_tr_b16 v[36:37], v34 offset:22528
    v_mfma_f32_16x16x32_bf16 v[148:151], v[228:231], a[216:219], v[148:151]
    s_add_u32 m0, s52, 22528
    s_add_u32 s38, s55, 4096
    s_mov_b32 exec_hi, 0
    buffer_load_dwordx4 v9, s[24:27], s38 offen sc1 lds
    s_mov_b32 exec_hi, -1
    s_add_u32 s55, s55, 73728
    v_mfma_f32_16x16x32_bf16 v[152:155], v[224:227], a[220:223], v[152:155]
    ds_read_b64_tr_b16 v[38:39], v34 offset:22784
    v_mfma_f32_16x16x32_bf16 v[156:159], v[228:231], a[220:223], v[156:159]
    s_waitcnt lgkmcnt(4)
    v_mfma_f32_16x16x32_bf16 v[128:131], v[232:235], a[80:83], v[128:131]
    ds_read_b64_tr_b16 v[224:225], v3 offset:24576
    v_mfma_f32_16x16x32_bf16 v[132:135], v[236:239], a[80:83], v[132:135]
    buffer_load_dwordx4 a[8:11], v9, s[60:63], s53 offen offset:0 sc1
    v_mfma_f32_16x16x32_bf16 v[136:139], v[232:235], a[84:87], v[136:139]
    ds_read_b64_tr_b16 v[226:227], v3 offset:24832
    v_mfma_f32_16x16x32_bf16 v[140:143], v[236:239], a[84:87], v[140:143]
    v_mfma_f32_16x16x32_bf16 v[144:147], v[232:235], a[224:227], v[144:147]
    ds_read_b64_tr_b16 v[228:229], v34 offset:24576
    v_mfma_f32_16x16x32_bf16 v[148:151], v[236:239], a[224:227], v[148:151]
    buffer_load_dwordx4 a[12:15], v9, s[60:63], s53 offen offset:1024 sc1
    v_mfma_f32_16x16x32_bf16 v[152:155], v[232:235], a[228:231], v[152:155]
    s_add_u32 s53, s53, 8192
    ds_read_b64_tr_b16 v[230:231], v34 offset:24832
    v_mfma_f32_16x16x32_bf16 v[156:159], v[236:239], a[228:231], v[156:159]
    s_waitcnt lgkmcnt(4)
    v_mfma_f32_16x16x32_bf16 v[128:131], v[12:15], a[88:91], v[128:131]
    ds_read_b64_tr_b16 v[232:233], v3 offset:26624
    v_mfma_f32_16x16x32_bf16 v[132:135], v[36:39], a[88:91], v[132:135]
    buffer_load_dwordx4 a[152:155], v9, s[60:63], s54 offen offset:0 sc1
    v_mfma_f32_16x16x32_bf16 v[136:139], v[12:15], a[92:95], v[136:139]
    ds_read_b64_tr_b16 v[234:235], v3 offset:26880
    v_mfma_f32_16x16x32_bf16 v[140:143], v[36:39], a[92:95], v[140:143]
    v_mfma_f32_16x16x32_bf16 v[144:147], v[12:15], a[232:235], v[144:147]
    ds_read_b64_tr_b16 v[236:237], v34 offset:26624
    v_mfma_f32_16x16x32_bf16 v[148:151], v[36:39], a[232:235], v[148:151]
    buffer_load_dwordx4 a[156:159], v9, s[60:63], s54 offen offset:1024 sc1
    v_mfma_f32_16x16x32_bf16 v[152:155], v[12:15], a[236:239], v[152:155]
    s_add_u32 s54, s54, 8192
    ds_read_b64_tr_b16 v[238:239], v34 offset:26880
    v_mfma_f32_16x16x32_bf16 v[156:159], v[36:39], a[236:239], v[156:159]
    s_waitcnt lgkmcnt(4)
    v_mfma_f32_16x16x32_bf16 v[128:131], v[224:227], a[96:99], v[128:131]
    ds_read_b64_tr_b16 v[12:13], v3 offset:28672
    v_mfma_f32_16x16x32_bf16 v[132:135], v[228:231], a[96:99], v[132:135]
    v_mfma_f32_16x16x32_bf16 v[136:139], v[224:227], a[100:103], v[136:139]
    ds_read_b64_tr_b16 v[14:15], v3 offset:28928
    v_mfma_f32_16x16x32_bf16 v[140:143], v[228:231], a[100:103], v[140:143]
    s_add_u32 m0, s52, 36864
    v_mfma_f32_16x16x32_bf16 v[144:147], v[224:227], a[240:243], v[144:147]
    s_nop 0
    ds_read_b64_tr_b16 v[36:37], v34 offset:28672
    v_mfma_f32_16x16x32_bf16 v[148:151], v[228:231], a[240:243], v[148:151]
    buffer_load_dwordx4 v9, s[24:27], s55 offen sc1 lds
    v_mfma_f32_16x16x32_bf16 v[152:155], v[224:227], a[244:247], v[152:155]
    ds_read_b64_tr_b16 v[38:39], v34 offset:28928
    v_mfma_f32_16x16x32_bf16 v[156:159], v[228:231], a[244:247], v[156:159]
    s_waitcnt lgkmcnt(4)
    buffer_load_dwordx4 v9, s[24:27], s55 offen offset:1024 sc1 lds
    v_mfma_f32_16x16x32_bf16 v[128:131], v[232:235], a[104:107], v[128:131]
    ds_read_b64_tr_b16 v[224:225], v3 offset:30720
    v_mfma_f32_16x16x32_bf16 v[132:135], v[236:239], a[104:107], v[132:135]
    v_mfma_f32_16x16x32_bf16 v[136:139], v[232:235], a[108:111], v[136:139]
    ds_read_b64_tr_b16 v[226:227], v3 offset:30976
    v_mfma_f32_16x16x32_bf16 v[140:143], v[236:239], a[108:111], v[140:143]
    buffer_load_dwordx4 v9, s[24:27], s55 offen offset:2048 sc1 lds
    v_mfma_f32_16x16x32_bf16 v[144:147], v[232:235], a[248:251], v[144:147]
    ds_read_b64_tr_b16 v[228:229], v34 offset:30720
    v_mfma_f32_16x16x32_bf16 v[148:151], v[236:239], a[248:251], v[148:151]
    v_mfma_f32_16x16x32_bf16 v[152:155], v[232:235], a[252:255], v[152:155]
    ds_read_b64_tr_b16 v[230:231], v34 offset:30976
    v_mfma_f32_16x16x32_bf16 v[156:159], v[236:239], a[252:255], v[156:159]
    s_waitcnt lgkmcnt(4)
    buffer_load_dwordx4 v9, s[24:27], s55 offen offset:3072 sc1 lds
    v_mfma_f32_16x16x32_bf16 v[128:131], v[12:15], a[112:115], v[128:131]
    ds_read_b64_tr_b16 v[232:233], v3 offset:32768
    v_mfma_f32_16x16x32_bf16 v[132:135], v[36:39], a[112:115], v[132:135]
    v_mfma_f32_16x16x32_bf16 v[136:139], v[12:15], a[116:119], v[136:139]
    ds_read_b64_tr_b16 v[234:235], v3 offset:33024
    v_mfma_f32_16x16x32_bf16 v[140:143], v[36:39], a[116:119], v[140:143]
    s_add_u32 m0, s52, 40960
    s_add_u32 s38, s55, 4096
    s_mov_b32 exec_hi, 0
    buffer_load_dwordx4 v9, s[24:27], s38 offen sc1 lds
    s_mov_b32 exec_hi, -1
    s_add_u32 s55, s55, 73728
    v_mfma_f32_16x16x32_bf16 v[144:147], v[12:15], v[192:195], v[144:147]
    ds_read_b64_tr_b16 v[236:237], v34 offset:32768
    v_mfma_f32_16x16x32_bf16 v[148:151], v[36:39], v[192:195], v[148:151]
    v_mfma_f32_16x16x32_bf16 v[152:155], v[12:15], v[196:199], v[152:155]
    ds_read_b64_tr_b16 v[238:239], v34 offset:33024
    v_mfma_f32_16x16x32_bf16 v[156:159], v[36:39], v[196:199], v[156:159]
    s_waitcnt lgkmcnt(4)
    buffer_load_dwordx4 a[16:19], v9, s[60:63], s53 offen offset:0 sc1
    v_mfma_f32_16x16x32_bf16 v[128:131], v[224:227], a[120:123], v[128:131]
    ds_read_b64_tr_b16 v[12:13], v3 offset:34816
    v_mfma_f32_16x16x32_bf16 v[132:135], v[228:231], a[120:123], v[132:135]
    v_mfma_f32_16x16x32_bf16 v[136:139], v[224:227], a[124:127], v[136:139]
    ds_read_b64_tr_b16 v[14:15], v3 offset:35072
    v_mfma_f32_16x16x32_bf16 v[140:143], v[228:231], a[124:127], v[140:143]
    buffer_load_dwordx4 a[20:23], v9, s[60:63], s53 offen offset:1024 sc1
    v_mfma_f32_16x16x32_bf16 v[144:147], v[224:227], v[200:203], v[144:147]
    s_add_u32 s53, s53, 8192
    ds_read_b64_tr_b16 v[36:37], v34 offset:34816
    v_mfma_f32_16x16x32_bf16 v[148:151], v[228:231], v[200:203], v[148:151]
    v_mfma_f32_16x16x32_bf16 v[152:155], v[224:227], v[204:207], v[152:155]
    ds_read_b64_tr_b16 v[38:39], v34 offset:35072
    v_mfma_f32_16x16x32_bf16 v[156:159], v[228:231], v[204:207], v[156:159]
    s_waitcnt lgkmcnt(4)
    buffer_load_dwordx4 a[160:163], v9, s[60:63], s54 offen offset:0 sc1
    v_mfma_f32_16x16x32_bf16 v[128:131], v[232:235], a[128:131], v[128:131]
    v_mfma_f32_16x16x32_bf16 v[132:135], v[236:239], a[128:131], v[132:135]
    v_mfma_f32_16x16x32_bf16 v[136:139], v[232:235], a[132:135], v[136:139]
    v_mfma_f32_16x16x32_bf16 v[140:143], v[236:239], a[132:135], v[140:143]
    v_mfma_f32_16x16x32_bf16 v[144:147], v[232:235], v[208:211], v[144:147]
    v_mfma_f32_16x16x32_bf16 v[148:151], v[236:239], v[208:211], v[148:151]
    buffer_load_dwordx4 a[164:167], v9, s[60:63], s54 offen offset:1024 sc1
    v_mfma_f32_16x16x32_bf16 v[152:155], v[232:235], v[212:215], v[152:155]
    s_add_u32 s54, s54, 8192
    v_mfma_f32_16x16x32_bf16 v[156:159], v[236:239], v[212:215], v[156:159]
    s_waitcnt lgkmcnt(0)
    v_mfma_f32_16x16x32_bf16 v[128:131], v[12:15], a[136:139], v[128:131]
    v_mfma_f32_16x16x32_bf16 v[132:135], v[36:39], a[136:139], v[132:135]
    v_mfma_f32_16x16x32_bf16 v[136:139], v[12:15], a[140:143], v[136:139]
    v_mfma_f32_16x16x32_bf16 v[140:143], v[36:39], a[140:143], v[140:143]
    v_mfma_f32_16x16x32_bf16 v[144:147], v[12:15], v[216:219], v[144:147]
    v_mfma_f32_16x16x32_bf16 v[148:151], v[36:39], v[216:219], v[148:151]
    v_mfma_f32_16x16x32_bf16 v[152:155], v[12:15], v[220:223], v[152:155]
    v_mfma_f32_16x16x32_bf16 v[156:159], v[36:39], v[220:223], v[156:159]
L_k1_qlast:
    s_nop 7
    s_nop 7
    v_cvt_pk_bf16_f32 v48, v128, v129
    v_cvt_pk_bf16_f32 v49, v130, v131
    v_cvt_pk_bf16_f32 v50, v132, v133
    v_cvt_pk_bf16_f32 v51, v134, v135
    buffer_store_dwordx4 v[48:51], v8, s[16:19], s41 offen offset:0 sc0 sc1
    v_cvt_pk_bf16_f32 v52, v136, v137
    v_cvt_pk_bf16_f32 v53, v138, v139
    v_cvt_pk_bf16_f32 v54, v140, v141
    v_cvt_pk_bf16_f32 v55, v142, v143
    buffer_store_dwordx4 v[52:55], v8, s[16:19], s41 offen offset:128 sc0 sc1
    v_cvt_pk_bf16_f32 v56, v144, v145
    v_cvt_pk_bf16_f32 v57, v146, v147
    v_cvt_pk_bf16_f32 v58, v148, v149
    v_cvt_pk_bf16_f32 v59, v150, v151
    buffer_store_dwordx4 v[56:59], v8, s[16:19], s41 offen offset:256 sc0 sc1
    v_cvt_pk_bf16_f32 v60, v152, v153
    v_cvt_pk_bf16_f32 v61, v154, v155
    v_cvt_pk_bf16_f32 v62, v156, v157
    v_cvt_pk_bf16_f32 v63, v158, v159
    buffer_store_dwordx4 v[60:63], v8, s[16:19], s41 offen offset:384 sc0 sc1
    s_add_u32 s41, s41, 131072
    s_add_u32 s42, s42, 131072
    s_cmp_lg_u32 s37, 0
    s_cbranch_scc1 L_k1_fin
    buffer_load_dwordx2 v[244:245], v246, s[88:91], s79 offen sc1
    s_waitcnt vmcnt(0)
L_g2e3:
    v_xor_b32 v244, s66, v244
    v_xor_b32 v245, s67, v245
    v_or_b32 v244, v244, v245
    v_cmp_ne_u32 vcc, 0, v244
    s_nop 3
    s_cmp_eq_u64 vcc, 0
    s_cbranch_scc1 L_g2eok3
    s_sleep 2
    buffer_load_dwordx2 v[244:245], v246, s[88:91], s79 offen sc1
    s_waitcnt vmcnt(0)
    s_branch L_g2e3
L_g2eok3:
    s_barrier
    s_mov_b32 s26, 0x005b2000
    s_sub_u32 s55, s55, 221184
    s_sub_u32 s53, s53, 24576
    s_sub_u32 s54, s54, 24576
    s_add_u32 m0, s52, 0
    s_nop 0
    buffer_load_dwordx4 v9, s[24:27], s55 offen sc1 lds
    buffer_load_dwordx4 v9, s[24:27], s55 offen offset:1024 sc1 lds
    buffer_load_dwordx4 v9, s[24:27], s55 offen offset:2048 sc1 lds
    buffer_load_dwordx4 v9, s[24:27], s55 offen offset:3072 sc1 lds
    s_add_u32 m0, s52, 4096
    s_add_u32 s38, s55, 4096
    s_mov_b32 exec_hi, 0
    buffer_load_dwordx4 v9, s[24:27], s38 offen sc1 lds
    s_mov_b32 exec_hi, -1
    s_add_u32 s55, s55, 73728
    buffer_load_dwordx4 a[0:3], v9, s[20:23], s53 offen offset:0 sc1
    buffer_load_dwordx4 a[4:7], v9, s[20:23], s53 offen offset:1024 sc1
    s_add_u32 s53, s53, 8192
    buffer_load_dwordx4 a[144:147], v9, s[20:23], s54 offen offset:0 sc1
    buffer_load_dwordx4 a[148:151], v9, s[20:23], s54 offen offset:1024 sc1
    s_add_u32 s54, s54, 8192
    s_add_u32 m0, s52, 18432
    s_nop 0
    buffer_load_dwordx4 v9, s[24:27], s55 offen sc1 lds
    buffer_load_dwordx4 v9, s[24:27], s55 offen offset:1024 sc1 lds
    buffer_load_dwordx4 v9, s[24:27], s55 offen offset:2048 sc1 lds
    buffer_load_dwordx4 v9, s[24:27], s55 offen offset:3072 sc1 lds
    s_add_u32 m0, s52, 22528
    s_add_u32 s38, s55, 4096
    s_mov_b32 exec_hi, 0
    buffer_load_dwordx4 v9, s[24:27], s38 offen sc1 lds
    s_mov_b32 exec_hi, -1
    s_add_u32 s55, s55, 73728
    buffer_load_dwordx4 a[8:11], v9, s[20:23], s53 offen offset:0 sc1
    buffer_load_dwordx4 a[12:15], v9, s[20:23], s53 offen offset:1024 sc1
    s_add_u32 s53, s53, 8192
    buffer_load_dwordx4 a[152:155], v9, s[20:23], s54 offen offset:0 sc1
    buffer_load_dwordx4 a[156:159], v9, s[20:23], s54 offen offset:1024 sc1
    s_add_u32 s54, s54, 8192
    s_add_u32 m0, s52, 36864
    s_nop 0
    buffer_load_dwordx4 v9, s[24:27], s55 offen sc1 lds
    buffer_load_dwordx4 v9, s[24:27], s55 offen offset:1024 sc1 lds
    buffer_load_dwordx4 v9, s[24:27], s55 offen offset:2048 sc1 lds
    buffer_load_dwordx4 v9, s[24:27], s55 offen offset:3072 sc1 lds
    s_add_u32 m0, s52, 40960
    s_add_u32 s38, s55, 4096
    s_mov_b32 exec_hi, 0
    buffer_load_dwordx4 v9, s[24:27], s38 offen sc1 lds
    s_mov_b32 exec_hi, -1
    s_add_u32 s55, s55, 73728
    buffer_load_dwordx4 a[16:19], v9, s[20:23], s53 offen offset:0 sc1
    buffer_load_dwordx4 a[20:23], v9, s[20:23], s53 offen offset:1024 sc1
    s_add_u32 s53, s53, 8192
    buffer_load_dwordx4 a[160:163], v9, s[20:23], s54 offen offset:0 sc1
    buffer_load_dwordx4 a[164:167], v9, s[20:23], s54 offen offset:1024 sc1
    s_add_u32 s54, s54, 8192
    s_mov_b32 s62, 0
    buffer_load_dword v240, v9, s[60:63], 0 offen
    buffer_load_dword v240, v9, s[60:63], 0 offen
    buffer_load_dword v240, v9, s[60:63], 0 offen
    buffer_load_dword v240, v9, s[60:63], 0 offen
L_k1_fin:
k3_gemm2_kernel:
    v_mov_b32 v191, v9
    s_lshl_b32 s35, s28, 6
    v_add_u32 v255, s35, v0
    v_lshlrev_b32 v178, 7, v255
    s_mov_b32 s65, 98304
    v_add_u32 v243, 0, v9
    v_add_u32 v244, 55296, v9
    v_add_u32 v245, 110592, v9
    s_add_u32 m0, s52, 55296
    s_nop 0
    buffer_load_dwordx4 v191, s[24:27], s55 offen sc1 lds
    buffer_load_dwordx4 v191, s[24:27], s55 offen offset:1024 sc1 lds
    buffer_load_dwordx4 v191, s[24:27], s55 offen offset:2048 sc1 lds
    buffer_load_dwordx4 v191, s[24:27], s55 offen offset:3072 sc1 lds
    s_waitcnt vmcnt(30) lgkmcnt(0)
    s_barrier
    ds_read_b128 a[200:203], v243 offset:0
    ds_read_b128 a[204:207], v243 offset:1024
    ds_read_b128 a[208:211], v243 offset:2048
    ds_read_b128 a[212:215], v243 offset:3072
    ds_read_b128 a[216:219], v243 offset:4096
    ds_read_b128 a[220:223], v243 offset:5120
    ds_read_b128 a[224:227], v243 offset:6144
    ds_read_b128 a[228:231], v243 offset:7168
    ds_read_b128 a[232:235], v243 offset:8192
    s_waitcnt vmcnt(26)
    s_waitcnt lgkmcnt(8)
    v_mfma_f32_16x16x32_bf16 v[16:19], a[200:203], a[0:3], 0
    s_add_u32 m0, s52, 59392
    s_add_u32 s38, s55, 4096
    s_mov_b32 exec_hi, 0
    buffer_load_dwordx4 v191, s[24:27], s38 offen sc1 lds
    s_mov_b32 exec_hi, -1
    s_add_u32 s55, s55, 73728
    v_mfma_f32_16x16x32_bf16 v[52:55], a[200:203], a[4:7], 0
    ds_read_b128 a[200:203], v243 offset:9216
    s_waitcnt lgkmcnt(8)
    v_mfma_f32_16x16x32_bf16 v[56:59], a[204:207], a[4:7], 0
    buffer_load_dwordx4 a[24:27], v191, s[20:23], s53 offen offset:0 sc1
    v_mfma_f32_16x16x32_bf16 v[20:23], a[204:207], a[0:3], 0
    ds_read_b128 a[204:207], v243 offset:10240
    s_waitcnt lgkmcnt(8)
    v_mfma_f32_16x16x32_bf16 v[24:27], a[208:211], a[0:3], 0
    buffer_load_dwordx4 a[28:31], v191, s[20:23], s53 offen offset:1024 sc1
    s_add_u32 s53, s53, 8192
    v_mfma_f32_16x16x32_bf16 v[60:63], a[208:211], a[4:7], 0
    ds_read_b128 a[208:211], v243 offset:11264
    s_waitcnt lgkmcnt(8)
    v_mfma_f32_16x16x32_bf16 v[64:67], a[212:215], a[4:7], 0
    buffer_load_dwordx4 a[168:171], v191, s[20:23], s54 offen offset:0 sc1
    v_mfma_f32_16x16x32_bf16 v[28:31], a[212:215], a[0:3], 0
    ds_read_b128 a[212:215], v243 offset:12288
    s_waitcnt lgkmcnt(8)
    v_mfma_f32_16x16x32_bf16 v[32:35], a[216:219], a[0:3], 0
    s_lshl_b32 s42, s30, 2
    s_add_u32 s42, s42, s31
    s_mov_b32 s86, s28
    s_and_b32 s68, s29, 1
    s_and_b32 s35, s2, 7
    s_lshl_b32 s35, s35, 12
    v_mov_b32 v178, s35
    s_sub_u32 s36, s35, 4096
    s_and_b32 s36, s36, 0x7000
    s_cmp_lt_u32 s2, 16
    s_cselect_b32 s35, s36, s35
    s_mov_b32 exec_lo, 0xff00
    s_mov_b32 exec_hi, 0xff00
    v_mov_b32 v178, s35
    s_lshr_b32 s35, s30, 1
    s_lshl_b32 s35, s35, 12
    s_mov_b32 exec_lo, 0xff0000
    s_mov_b32 exec_hi, 0xff0000
    v_mov_b32 v178, s35
    s_mul_i32 s35, s28, 7168
    s_add_u32 s35, s35, 39680
    s_mov_b32 exec_lo, 0xff000000
    s_mov_b32 exec_hi, 0xff000000
    v_mov_b32 v178, s35
    s_mov_b64 exec, -1
    v_mfma_f32_16x16x32_bf16 v[68:71], a[216:219], a[4:7], 0
    ds_read_b128 a[216:219], v243 offset:13312
    s_waitcnt lgkmcnt(8)
    v_mfma_f32_16x16x32_bf16 v[72:75], a[220:223], a[4:7], 0
    buffer_load_dwordx4 a[172:175], v191, s[20:23], s54 offen offset:1024 sc1
    s_add_u32 s54, s54, 8192
    v_mfma_f32_16x16x32_bf16 v[36:39], a[220:223], a[0:3], 0
    ds_read_b128 a[220:223], v243 offset:14336
    s_waitcnt lgkmcnt(8)
    v_mfma_f32_16x16x32_bf16 v[40:43], a[224:227], a[0:3], 0
    v_and_b32 v177, 7, v0
    v_lshl_add_u32 v178, v177, 7, v178
    v_lshl_add_u32 v178, s28, 10, v178
    s_cmp_eq_u32 s32, 0
    s_cselect_b32 s35, 54, 36
    v_lshl_add_u32 v88, s35, 11, v191
    s_cmp_eq_u32 s32, 0
    s_cselect_b32 s35, 45, 0
    v_mfma_f32_16x16x32_bf16 v[76:79], a[224:227], a[4:7], 0
    ds_read_b128 a[224:227], v243 offset:15360
    s_waitcnt lgkmcnt(8)
    v_mfma_f32_16x16x32_bf16 v[80:83], a[228:231], a[4:7], 0
    s_add_u32 m0, s52, 110592
    s_nop 0
    buffer_load_dwordx4 v191, s[24:27], s55 offen sc1 lds
    v_mfma_f32_16x16x32_bf16 v[44:47], a[228:231], a[0:3], 0
    ds_read_b128 a[228:231], v243 offset:16384
    s_waitcnt lgkmcnt(8)
    v_mfma_f32_16x16x32_bf16 v[48:51], a[232:235], a[0:3], 0
    v_lshl_add_u32 v89, s35, 11, v191
    s_cmp_eq_u32 s32, 0
    s_cselect_b32 s35, 9, 18
    v_lshl_add_u32 v90, s35, 11, v191
    s_mov_b32 s44, s4
    s_mov_b32 s45, s5
    s_and_b32 s45, s45, 0xffff
    s_mov_b32 s46, 0x00240000
    s_mov_b32 s47, 0x00020000
    s_mov_b32 s48, s58
    s_mov_b32 s49, s59
    s_and_b32 s49, s49, 0xffff
    s_mov_b32 s50, 0x00240000
    s_mov_b32 s51, 0x00020000
    s_add_u32 s16, s70, 0x02000000
    s_addc_u32 s17, s71, 0
    v_mfma_f32_16x16x32_bf16 v[84:87], a[232:235], a[4:7], 0
    ds_read_b128 a[232:235], v243 offset:17408
    s_waitcnt vmcnt(10)
    s_barrier
    s_cmp_eq_u32 s28, 0
    v_mov_b32 v92, s66
    v_mov_b32 v93, s67
    v_lshlrev_b32 v94, 3, v0
    s_cselect_b32 exec_lo, 0xffff, 0
    s_mov_b32 exec_hi, 0
    s_and_b32 s64, s2, 7
    s_lshl_b32 s64, s64, 2
    s_add_u32 s64, s64, s31
    s_and_b32 s65, s2, 0xe0
    s_add_u32 s64, s64, s65
    s_lshl_b32 s64, s64, 7
    s_add_u32 s64, s64, 32768
    buffer_store_dwordx2 v[92:93], v94, s[88:91], s64 offen sc0 sc1
    s_mov_b64 exec, -1
    s_waitcnt lgkmcnt(8)
    v_mfma_f32_16x16x32_bf16 v[16:19], a[200:203], a[144:147], v[16:19]
    buffer_load_dwordx4 v191, s[24:27], s55 offen offset:1024 sc1 lds
    v_mfma_f32_16x16x32_bf16 v[52:55], a[200:203], a[148:151], v[52:55]
    ds_read_b128 a[200:203], v243 offset:18432
    s_waitcnt lgkmcnt(8)
    v_mfma_f32_16x16x32_bf16 v[56:59], a[204:207], a[148:151], v[56:59]
    buffer_load_dwordx4 v191, s[24:27], s55 offen offset:2048 sc1 lds
    v_mfma_f32_16x16x32_bf16 v[20:23], a[204:207], a[144:147], v[20:23]
    ds_read_b128 a[204:207], v243 offset:19456
    s_waitcnt lgkmcnt(8)
    v_mfma_f32_16x16x32_bf16 v[24:27], a[208:211], a[144:147], v[24:27]
    buffer_load_dwordx4 v191, s[24:27], s55 offen offset:3072 sc1 lds
    v_mfma_f32_16x16x32_bf16 v[60:63], a[208:211], a[148:151], v[60:63]
    ds_read_b128 a[208:211], v243 offset:20480
    s_waitcnt lgkmcnt(8)
    v_mfma_f32_16x16x32_bf16 v[64:67], a[212:215], a[148:151], v[64:67]
    s_add_u32 m0, s52, 114688
    s_add_u32 s38, s55, 4096
    s_mov_b32 exec_hi, 0
    buffer_load_dwordx4 v191, s[24:27], s38 offen sc1 lds
    s_mov_b32 exec_hi, -1
    s_add_u32 s55, s55, 73728
    v_mfma_f32_16x16x32_bf16 v[28:31], a[212:215], a[144:147], v[28:31]
    ds_read_b128 a[212:215], v243 offset:21504
    s_waitcnt lgkmcnt(8)
    v_mfma_f32_16x16x32_bf16 v[32:35], a[216:219], a[144:147], v[32:35]
    buffer_load_dwordx4 a[32:35], v191, s[20:23], s53 offen offset:0 sc1
    v_mfma_f32_16x16x32_bf16 v[68:71], a[216:219], a[148:151], v[68:71]
    ds_read_b128 a[216:219], v243 offset:22528
    s_waitcnt lgkmcnt(8)
    v_mfma_f32_16x16x32_bf16 v[72:75], a[220:223], a[148:151], v[72:75]
    s_and_b32 s17, s17, 0xffff
    s_mov_b32 s18, 0x01200000
    s_mov_b32 s19, 0x00020000
    s_add_u32 s60, s70, 0x01f40000
    s_addc_u32 s61, s71, 0
    s_and_b32 s61, s61, 0xffff
    s_mov_b32 s62, 0x00040000
    s_mov_b32 s63, 0x00020000
    s_lshl_b32 s35, s30, 1
    s_lshr_b32 s36, s29, 1
    s_add_u32 s35, s35, s36
    s_mul_i32 s34, s35, 162
    s_add_u32 s34, s34, s32
    s_add_u32 s34, s34, 144
    s_lshl_b32 s34, s34, 2
    v_mfma_f32_16x16x32_bf16 v[36:39], a[220:223], a[144:147], v[36:39]
    ds_read_b128 a[220:223], v243 offset:23552
    s_waitcnt lgkmcnt(8)
    v_mfma_f32_16x16x32_bf16 v[40:43], a[224:227], a[144:147], v[40:43]
    buffer_load_dwordx4 a[36:39], v191, s[20:23], s53 offen offset:1024 sc1
    s_add_u32 s53, s53, 8192
    v_mfma_f32_16x16x32_bf16 v[76:79], a[224:227], a[148:151], v[76:79]
    ds_read_b128 a[224:227], v243 offset:24576
    s_waitcnt lgkmcnt(8)
    v_mfma_f32_16x16x32_bf16 v[80:83], a[228:231], a[148:151], v[80:83]
    s_lshl_b32 s1, s35, 12
    s_add_u32 s1, s1, 458752
    v_and_b32 v91, 31, v0
    v_lshlrev_b32 v91, 7, v91
    s_lshl_b32 s34, s34, 10
    v_lshl_add_u32 v239, s28, 10, v191
    v_xor_b32 v250, 1024, v239
    s_lshl_b32 s35, s35, 2
    s_add_u32 s35, s35, s28
    s_lshl_b32 s35, s35, 4
    v_and_b32 v5, 7, v0
    v_bfe_u32 v4, v0, 3, 1
    v_lshl_add_u32 v5, v5, 1, v4
    v_add_u32 v5, s35, v5
    v_mul_u32_u24 v5, 1152, v5
    v_lshrrev_b32 v4, 4, v0
    v_mfma_f32_16x16x32_bf16 v[44:47], a[228:231], a[144:147], v[44:47]
    ds_read_b128 a[228:231], v243 offset:25600
    s_waitcnt lgkmcnt(8)
    v_mfma_f32_16x16x32_bf16 v[48:51], a[232:235], a[144:147], v[48:51]
    buffer_load_dwordx4 a[176:179], v191, s[20:23], s54 offen offset:0 sc1
    v_mfma_f32_16x16x32_bf16 v[84:87], a[232:235], a[148:151], v[84:87]
    ds_read_b128 a[232:235], v243 offset:26624
    s_waitcnt vmcnt(30)
    s_waitcnt lgkmcnt(8)
    v_mfma_f32_16x16x32_bf16 v[16:19], a[200:203], a[8:11], v[16:19]
    buffer_load_dwordx4 a[180:183], v191, s[20:23], s54 offen offset:1024 sc1
    s_add_u32 s54, s54, 8192
    v_mfma_f32_16x16x32_bf16 v[52:55], a[200:203], a[12:15], v[52:55]
    ds_read_b128 a[200:203], v243 offset:27648
    s_waitcnt lgkmcnt(8)
    v_mfma_f32_16x16x32_bf16 v[56:59], a[204:207], a[12:15], v[56:59]
    s_add_u32 m0, s52, 73728
    s_nop 0
    buffer_load_dwordx4 v191, s[24:27], s55 offen sc1 lds
    v_mfma_f32_16x16x32_bf16 v[20:23], a[204:207], a[8:11], v[20:23]
    ds_read_b128 a[204:207], v243 offset:28672
    s_waitcnt lgkmcnt(8)
    v_mfma_f32_16x16x32_bf16 v[24:27], a[208:211], a[8:11], v[24:27]
    buffer_load_dwordx4 v191, s[24:27], s55 offen offset:1024 sc1 lds
    v_mfma_f32_16x16x32_bf16 v[60:63], a[208:211], a[12:15], v[60:63]
    ds_read_b128 a[208:211], v243 offset:29696
    s_waitcnt lgkmcnt(8)
    v_mfma_f32_16x16x32_bf16 v[64:67], a[212:215], a[12:15], v[64:67]
    buffer_load_dwordx4 v191, s[24:27], s55 offen offset:2048 sc1 lds
    v_mfma_f32_16x16x32_bf16 v[28:31], a[212:215], a[8:11], v[28:31]
    ds_read_b128 a[212:215], v243 offset:30720
    s_waitcnt lgkmcnt(8)
    v_mfma_f32_16x16x32_bf16 v[32:35], a[216:219], a[8:11], v[32:35]
    v_lshl_add_u32 v5, v4, 3, v5
    s_mul_i32 s35, s31, 288
    s_mul_i32 s36, s68, 160
    s_add_u32 s35, s35, s36
    v_add_u32 v5, s35, v5
    s_mul_i32 s33, s31, 9
    s_mul_i32 s35, s68, 5
    s_add_u32 s33, s33, s35
    s_add_u32 s33, s33, 5184
    s_lshl_b32 s33, s33, 10
    s_add_u32 s35, s28, 0
    s_mul_i32 s36, s35, 52
    s_lshr_b32 s36, s36, 8
    s_mul_i32 s36, s36, 67
    s_add_u32 s36, s36, s35
    s_add_u32 s39, s28, 0
    v_mfma_f32_16x16x32_bf16 v[68:71], a[216:219], a[12:15], v[68:71]
    ds_read_b128 a[216:219], v243 offset:31744
    s_waitcnt lgkmcnt(8)
    v_mfma_f32_16x16x32_bf16 v[72:75], a[220:223], a[12:15], v[72:75]
    buffer_load_dwordx4 v191, s[24:27], s55 offen offset:3072 sc1 lds
    v_mfma_f32_16x16x32_bf16 v[36:39], a[220:223], a[8:11], v[36:39]
    ds_read_b128 a[220:223], v243 offset:32768
    s_waitcnt lgkmcnt(8)
    v_mfma_f32_16x16x32_bf16 v[40:43], a[224:227], a[8:11], v[40:43]
    s_cmp_eq_u32 s68, 0
    s_cselect_b32 s36, s36, s39
    s_cselect_b32 s39, 0, 0
    v_lshl_add_u32 v246, s36, 10, v191
    s_add_u32 s39, s39, s35
    s_lshl_b32 s39, s39, 10
    s_add_u32 s35, s28, 4
    s_mul_i32 s36, s35, 52
    s_lshr_b32 s36, s36, 8
    s_mul_i32 s36, s36, 67
    s_add_u32 s36, s36, s35
    s_add_u32 s40, s28, 72
    s_cmp_eq_u32 s68, 0
    s_cselect_b32 s36, s36, s40
    s_cselect_b32 s40, 0, 1
    v_lshl_add_u32 v247, s36, 10, v191
    v_mfma_f32_16x16x32_bf16 v[76:79], a[224:227], a[12:15], v[76:79]
    ds_read_b128 a[224:227], v243 offset:33792
    s_waitcnt lgkmcnt(8)
    v_mfma_f32_16x16x32_bf16 v[80:83], a[228:231], a[12:15], v[80:83]
    s_add_u32 m0, s52, 77824
    s_add_u32 s38, s55, 4096
    s_mov_b32 exec_hi, 0
    buffer_load_dwordx4 v191, s[24:27], s38 offen sc1 lds
    s_mov_b32 exec_hi, -1
    s_add_u32 s55, s55, 73728
    v_mfma_f32_16x16x32_bf16 v[44:47], a[228:231], a[8:11], v[44:47]
    ds_read_b128 a[228:231], v243 offset:34816
    s_waitcnt lgkmcnt(8)
    v_mfma_f32_16x16x32_bf16 v[48:51], a[232:235], a[8:11], v[48:51]
    s_add_u32 s40, s40, s35
    s_lshl_b32 s40, s40, 10
    s_add_u32 s35, s28, 8
    s_mul_i32 s36, s35, 52
    s_lshr_b32 s36, s36, 8
    s_mul_i32 s36, s36, 67
    s_add_u32 s36, s36, s35
    s_add_u32 s41, s28, 144
    s_cmp_eq_u32 s68, 0
    s_cselect_b32 s36, s36, s41
    s_cselect_b32 s41, 0, 2
    v_lshl_add_u32 v248, s36, 10, v191
    s_add_u32 s41, s41, s35
    s_lshl_b32 s41, s41, 10
    s_add_u32 s35, s28, 12
    s_mul_i32 s36, s35, 52
    v_mfma_f32_16x16x32_bf16 v[84:87], a[232:235], a[12:15], v[84:87]
    ds_read_b128 a[232:235], v243 offset:35840
    s_waitcnt vmcnt(31)
    s_barrier
    s_waitcnt lgkmcnt(8)
    v_mfma_f32_16x16x32_bf16 v[16:19], a[200:203], a[152:155], v[16:19]
    buffer_load_dwordx4 a[40:43], v191, s[20:23], s53 offen offset:0 sc1
    v_mfma_f32_16x16x32_bf16 v[52:55], a[200:203], a[156:159], v[52:55]
    ds_read_b128 a[200:203], v243 offset:36864
    s_waitcnt lgkmcnt(8)
    v_mfma_f32_16x16x32_bf16 v[56:59], a[204:207], a[156:159], v[56:59]
    buffer_load_dwordx4 a[44:47], v191, s[20:23], s53 offen offset:1024 sc1
    s_add_u32 s53, s53, 8192
    v_mfma_f32_16x16x32_bf16 v[20:23], a[204:207], a[152:155], v[20:23]
    ds_read_b128 a[204:207], v243 offset:37888
    s_waitcnt lgkmcnt(8)
    v_mfma_f32_16x16x32_bf16 v[24:27], a[208:211], a[152:155], v[24:27]
    buffer_load_dwordx4 a[184:187], v191, s[20:23], s54 offen offset:0 sc1
    v_mfma_f32_16x16x32_bf16 v[60:63], a[208:211], a[156:159], v[60:63]
    ds_read_b128 a[208:211], v243 offset:38912
    s_waitcnt lgkmcnt(8)
    v_mfma_f32_16x16x32_bf16 v[64:67], a[212:215], a[156:159], v[64:67]
    buffer_load_dwordx4 a[188:191], v191, s[20:23], s54 offen offset:1024 sc1
    s_add_u32 s54, s54, 8192
    v_mfma_f32_16x16x32_bf16 v[28:31], a[212:215], a[152:155], v[28:31]
    ds_read_b128 a[212:215], v243 offset:39936
    s_waitcnt lgkmcnt(8)
    v_mfma_f32_16x16x32_bf16 v[32:35], a[216:219], a[152:155], v[32:35]
    s_add_u32 m0, s52, 92160
    s_nop 0
    buffer_load_dwordx4 v191, s[24:27], s55 offen sc1 lds
    v_mfma_f32_16x16x32_bf16 v[68:71], a[216:219], a[156:159], v[68:71]
    ds_read_b128 a[216:219], v243 offset:40960
    s_waitcnt lgkmcnt(8)
    v_mfma_f32_16x16x32_bf16 v[72:75], a[220:223], a[156:159], v[72:75]
    s_lshr_b32 s36, s36, 8
    s_mul_i32 s36, s36, 67
    s_add_u32 s36, s36, s35
    s_add_u32 s56, s28, 216
    s_cmp_eq_u32 s68, 0
    s_cselect_b32 s36, s36, s56
    s_cselect_b32 s56, 0, 3
    v_lshl_add_u32 v249, s36, 10, v191
    s_add_u32 s56, s56, s35
    s_min_u32 s56, s56, 17
    s_lshl_b32 s56, s56, 10
    s_add_u32 s72, s70, 0x03400000
    s_addc_u32 s73, s71, 0
    s_and_b32 s73, s73, 0xffff
    s_mov_b32 s74, 0x005b2000
    s_mov_b32 s75, 0x00020000
    v_mfma_f32_16x16x32_bf16 v[36:39], a[220:223], a[152:155], v[36:39]
    ds_read_b128 a[220:223], v243 offset:41984
    s_waitcnt lgkmcnt(8)
    v_mfma_f32_16x16x32_bf16 v[40:43], a[224:227], a[152:155], v[40:43]
    buffer_load_dwordx4 v191, s[24:27], s55 offen offset:1024 sc1 lds
    v_mfma_f32_16x16x32_bf16 v[76:79], a[224:227], a[156:159], v[76:79]
    ds_read_b128 a[224:227], v243 offset:43008
    s_waitcnt lgkmcnt(8)
    v_mfma_f32_16x16x32_bf16 v[80:83], a[228:231], a[156:159], v[80:83]
    s_lshl_b32 s35, s68, 2
    s_add_u32 s35, s35, s28
    s_cmp_lt_u32 s35, 3
    s_cselect_b32 s74, s74, 0
    s_and_b32 s35, s28, 2
    s_lshl_b32 s43, s42, 2
    s_add_u32 s43, s43, s29
    s_lshl_b32 s43, s43, 2
    s_add_u32 s43, s43, s35
    s_mul_i32 s43, s43, 18432
    s_cmp_eq_u32 s35, s29
    s_cselect_b32 s18, 0, s18
    s_add_u32 s35, s35, 1
    s_cmp_eq_u32 s35, s29
    s_cselect_b32 s69, 0, 0x01200000
    s_mul_i32 s35, s32, 7680
    v_mfma_f32_16x16x32_bf16 v[44:47], a[228:231], a[152:155], v[44:47]
    ds_read_b128 a[228:231], v243 offset:44032
    s_waitcnt lgkmcnt(8)
    v_mfma_f32_16x16x32_bf16 v[48:51], a[232:235], a[152:155], v[48:51]
    buffer_load_dwordx4 v191, s[24:27], s55 offen offset:2048 sc1 lds
    v_mfma_f32_16x16x32_bf16 v[84:87], a[232:235], a[156:159], v[84:87]
    ds_read_b128 a[232:235], v243 offset:45056
    s_waitcnt vmcnt(34)
    s_waitcnt lgkmcnt(8)
    v_mfma_f32_16x16x32_bf16 v[16:19], a[200:203], a[16:19], v[16:19]
    buffer_load_dwordx4 v191, s[24:27], s55 offen offset:3072 sc1 lds
    v_mfma_f32_16x16x32_bf16 v[52:55], a[200:203], a[20:23], v[52:55]
    ds_read_b128 a[200:203], v243 offset:46080
    s_waitcnt lgkmcnt(8)
    v_mfma_f32_16x16x32_bf16 v[56:59], a[204:207], a[20:23], v[56:59]
    s_add_u32 m0, s52, 96256
    s_add_u32 s38, s55, 4096
    s_mov_b32 exec_hi, 0
    buffer_load_dwordx4 v191, s[24:27], s38 offen sc1 lds
    s_mov_b32 exec_hi, -1
    s_add_u32 s55, s55, 73728
    v_mfma_f32_16x16x32_bf16 v[20:23], a[204:207], a[16:19], v[20:23]
    ds_read_b128 a[204:207], v243 offset:47104
    s_waitcnt lgkmcnt(8)
    v_mfma_f32_16x16x32_bf16 v[24:27], a[208:211], a[16:19], v[24:27]
    buffer_load_dwordx4 a[48:51], v191, s[20:23], s53 offen offset:0 sc1
    v_mfma_f32_16x16x32_bf16 v[60:63], a[208:211], a[20:23], v[60:63]
    ds_read_b128 a[208:211], v243 offset:48128
    s_waitcnt lgkmcnt(8)
    v_mfma_f32_16x16x32_bf16 v[64:67], a[212:215], a[20:23], v[64:67]
    buffer_load_dwordx4 a[52:55], v191, s[20:23], s53 offen offset:1024 sc1
    s_add_u32 s53, s53, 8192
    v_mfma_f32_16x16x32_bf16 v[28:31], a[212:215], a[16:19], v[28:31]
    ds_read_b128 a[212:215], v243 offset:49152
    s_waitcnt lgkmcnt(8)
    v_mfma_f32_16x16x32_bf16 v[32:35], a[216:219], a[16:19], v[32:35]
    s_add_u32 s43, s43, s35
    v_mul_u32_u24 v190, 12, v0
    v_add_u32 v238, 3840, v190
    s_mov_b32 s76, 0x07060501
    s_mov_b32 s77, 0x07060502
    s_mov_b32 s78, 0x07060503
    s_mov_b32 s79, 0x04000c0c
    s_mov_b32 s0, 0x07060001
    s_mul_i32 s35, s32, 10240
    s_add_u32 s35, s35, 129024
    v_add_u32 v1, s35, v191
    s_mul_i32 s35, s28, 3840
    s_add_u32 s36, s29, 1
    s_and_b32 s36, s36, 3
    s_lshl_b32 s4, s42, 2
    s_add_u32 s4, s4, s36
    v_mfma_f32_16x16x32_bf16 v[68:71], a[216:219], a[20:23], v[68:71]
    ds_read_b128 a[216:219], v243 offset:50176
    s_waitcnt lgkmcnt(8)
    v_mfma_f32_16x16x32_bf16 v[72:75], a[220:223], a[20:23], v[72:75]
    buffer_load_dwordx4 a[192:195], v191, s[20:23], s54 offen offset:0 sc1
    v_mfma_f32_16x16x32_bf16 v[36:39], a[220:223], a[16:19], v[36:39]
    ds_read_b128 a[220:223], v243 offset:51200
    s_waitcnt lgkmcnt(8)
    v_mfma_f32_16x16x32_bf16 v[40:43], a[224:227], a[16:19], v[40:43]
    s_lshl_b32 s4, s4, 2
    s_add_u32 s4, s4, s29
    s_mul_i32 s4, s4, 18432
    s_add_u32 s4, s4, s35
    s_add_u32 s36, s29, 2
    s_and_b32 s36, s36, 3
    s_lshl_b32 s5, s42, 2
    s_add_u32 s5, s5, s36
    s_lshl_b32 s5, s5, 2
    s_add_u32 s5, s5, s29
    s_mul_i32 s5, s5, 18432
    s_add_u32 s5, s5, s35
    s_add_u32 s36, s29, 3
    s_and_b32 s36, s36, 3
    s_lshl_b32 s6, s42, 2
    s_add_u32 s6, s6, s36
    v_mfma_f32_16x16x32_bf16 v[76:79], a[224:227], a[20:23], v[76:79]
    ds_read_b128 a[224:227], v243 offset:52224
    s_waitcnt lgkmcnt(8)
    v_mfma_f32_16x16x32_bf16 v[80:83], a[228:231], a[20:23], v[80:83]
    buffer_load_dwordx4 a[196:199], v191, s[20:23], s54 offen offset:1024 sc1
    s_add_u32 s54, s54, 8192
    v_mfma_f32_16x16x32_bf16 v[44:47], a[228:231], a[16:19], v[44:47]
    ds_read_b128 a[228:231], v243 offset:53248
    s_waitcnt lgkmcnt(8)
    v_mfma_f32_16x16x32_bf16 v[48:51], a[232:235], a[16:19], v[48:51]
    s_lshl_b32 s6, s6, 2
    s_add_u32 s6, s6, s29
    s_mul_i32 s6, s6, 18432
    s_add_u32 s6, s6, s35
    s_lshl_b32 s7, s42, 11
    s_lshl_b32 s37, s29, 2
    s_add_u32 s37, s37, s28
    s_lshl_b32 s37, s37, 7
    s_add_u32 s37, s37, s7
    s_and_b32 s36, s29, 2
    s_lshr_b32 s35, s28, 1
    s_add_u32 s36, s36, s35
    s_lshl_b32 s36, s36, 7
    s_add_u32 s7, s7, s36
    s_xor_b32 s36, s68, 1
    s_lshl_b32 s36, s36, 17
    v_mfma_f32_16x16x32_bf16 v[84:87], a[232:235], a[20:23], v[84:87]
    ds_read_b128 a[232:235], v243 offset:54272
    s_waitcnt vmcnt(31)
    s_barrier
    s_waitcnt lgkmcnt(8)
    v_mfma_f32_16x16x32_bf16 v[16:19], a[200:203], a[160:163], v[16:19]
    s_add_u32 m0, s52, 0
    s_nop 0
    buffer_load_dwordx4 v191, s[24:27], s55 offen sc1 lds
    v_mfma_f32_16x16x32_bf16 v[52:55], a[200:203], a[164:167], v[52:55]
    ds_read_b128 a[200:203], v244 offset:0
    s_waitcnt lgkmcnt(8)
    v_mfma_f32_16x16x32_bf16 v[56:59], a[204:207], a[164:167], v[56:59]
    buffer_load_dwordx4 v191, s[24:27], s55 offen offset:1024 sc1 lds
    v_mfma_f32_16x16x32_bf16 v[20:23], a[204:207], a[160:163], v[20:23]
    ds_read_b128 a[204:207], v244 offset:1024
    s_waitcnt lgkmcnt(8)
    v_mfma_f32_16x16x32_bf16 v[24:27], a[208:211], a[160:163], v[24:27]
    buffer_load_dwordx4 v191, s[24:27], s55 offen offset:2048 sc1 lds
    v_mfma_f32_16x16x32_bf16 v[60:63], a[208:211], a[164:167], v[60:63]
    ds_read_b128 a[208:211], v244 offset:2048
    s_waitcnt lgkmcnt(8)
    v_mfma_f32_16x16x32_bf16 v[64:67], a[212:215], a[164:167], v[64:67]
    buffer_load_dwordx4 v191, s[24:27], s55 offen offset:3072 sc1 lds
    v_mfma_f32_16x16x32_bf16 v[28:31], a[212:215], a[160:163], v[28:31]
    ds_read_b128 a[212:215], v244 offset:3072
    s_waitcnt lgkmcnt(8)
    v_mfma_f32_16x16x32_bf16 v[32:35], a[216:219], a[160:163], v[32:35]
    s_add_u32 m0, s52, 4096
    s_add_u32 s38, s55, 4096
    s_mov_b32 exec_hi, 0
    buffer_load_dwordx4 v191, s[24:27], s38 offen sc1 lds
    s_mov_b32 exec_hi, -1
    s_add_u32 s55, s55, 73728
    v_mfma_f32_16x16x32_bf16 v[68:71], a[216:219], a[164:167], v[68:71]
    ds_read_b128 a[216:219], v244 offset:4096
    s_waitcnt lgkmcnt(8)
    v_mfma_f32_16x16x32_bf16 v[72:75], a[220:223], a[164:167], v[72:75]
    s_add_u32 s7, s7, s36
    v_lshlrev_b32 v179, 3, v0
    v_add_u32 v7, 0x20000, v179
    v_and_b32 v8, 3, v0
    v_lshlrev_b32 v8, 9, v8
    s_mul_i32 s35, s28, 5120
    v_add_u32 v3, s35, v191
    v_add_u32 v2, 129024, v3
    s_xor_b32 s35, s28, 1
    s_mul_i32 s35, s35, 5120
    v_add_u32 v4, s35, v191
    s_mov_b32 s58, 0xbfb8aa3b
    s_mov_b32 s59, s58
    s_xor_b32 s57, s28, s29
    s_and_b32 s83, s2, 7
    s_lshl_b32 s83, s83, 5
    v_mfma_f32_16x16x32_bf16 v[36:39], a[220:223], a[160:163], v[36:39]
    ds_read_b128 a[220:223], v244 offset:5120
    s_waitcnt lgkmcnt(8)
    v_mfma_f32_16x16x32_bf16 v[40:43], a[224:227], a[160:163], v[40:43]
    buffer_load_dwordx4 a[0:3], v191, s[20:23], s53 offen offset:0 sc1
    v_mfma_f32_16x16x32_bf16 v[76:79], a[224:227], a[164:167], v[76:79]
    ds_read_b128 a[224:227], v244 offset:6144
    s_waitcnt lgkmcnt(8)
    v_mfma_f32_16x16x32_bf16 v[80:83], a[228:231], a[164:167], v[80:83]
    s_lshr_b32 s3, s2, 3
    s_add_u32 s83, s83, s3
    s_lshl_b32 s3, s83, 2
    s_add_u32 s3, s3, s86
    s_lshl_b32 s3, s3, 7
    s_add_u32 s3, s3, 458752
    v_lshlrev_b32 v251, 3, v0
    v_add_u32 v251, s3, v251
    v_mov_b32 v92, s66
    v_mov_b32 v93, s67
    s_lshr_b32 s84, s83, 1
    s_and_b32 s85, s83, 1
    s_lshl_b32 s3, s84, 4
    s_add_u32 s3, s3, s85
    v_and_b32 v9, 7, v0
    v_lshl_add_u32 v6, v9, 1, s3
    v_mfma_f32_16x16x32_bf16 v[44:47], a[228:231], a[160:163], v[44:47]
    ds_read_b128 a[228:231], v244 offset:7168
    s_waitcnt lgkmcnt(8)
    v_mfma_f32_16x16x32_bf16 v[48:51], a[232:235], a[160:163], v[48:51]
    buffer_load_dwordx4 a[4:7], v191, s[20:23], s53 offen offset:1024 sc1
    s_add_u32 s53, s53, 8192
    v_mfma_f32_16x16x32_bf16 v[84:87], a[232:235], a[164:167], v[84:87]
    ds_read_b128 a[232:235], v244 offset:8192
    s_waitcnt vmcnt(34)
    s_waitcnt lgkmcnt(8)
    v_mfma_f32_16x16x32_bf16 v[16:19], a[200:203], a[24:27], v[16:19]
    buffer_load_dwordx4 a[144:147], v191, s[20:23], s54 offen offset:0 sc1
    v_mfma_f32_16x16x32_bf16 v[52:55], a[200:203], a[28:31], v[52:55]
    ds_read_b128 a[200:203], v244 offset:9216
    s_waitcnt lgkmcnt(8)
    v_mfma_f32_16x16x32_bf16 v[56:59], a[204:207], a[28:31], v[56:59]
    buffer_load_dwordx4 a[148:151], v191, s[20:23], s54 offen offset:1024 sc1
    s_add_u32 s54, s54, 8192
    v_mfma_f32_16x16x32_bf16 v[20:23], a[204:207], a[24:27], v[20:23]
    ds_read_b128 a[204:207], v244 offset:10240
    s_waitcnt lgkmcnt(8)
    v_mfma_f32_16x16x32_bf16 v[24:27], a[208:211], a[24:27], v[24:27]
    s_add_u32 m0, s52, 18432
    s_nop 0
    buffer_load_dwordx4 v191, s[24:27], s55 offen sc1 lds
    v_mfma_f32_16x16x32_bf16 v[60:63], a[208:211], a[28:31], v[60:63]
    ds_read_b128 a[208:211], v244 offset:11264
    s_waitcnt lgkmcnt(8)
    v_mfma_f32_16x16x32_bf16 v[64:67], a[212:215], a[28:31], v[64:67]
    buffer_load_dwordx4 v191, s[24:27], s55 offen offset:1024 sc1 lds
    v_mfma_f32_16x16x32_bf16 v[28:31], a[212:215], a[24:27], v[28:31]
    ds_read_b128 a[212:215], v244 offset:12288
    s_waitcnt lgkmcnt(8)
    v_mfma_f32_16x16x32_bf16 v[32:35], a[216:219], a[24:27], v[32:35]
    v_lshlrev_b32 v9, 4, v9
    s_lshl_b32 s84, s84, 7
    s_lshl_b32 s85, s85, 14
    s_add_u32 s84, s84, s85
    s_mul_i32 s81, s86, 589824
    s_add_u32 s81, s81, s84
    s_add_u32 s80, s81, 2359168
    s_mul_i32 s82, s86, 7168
    s_add_u32 s82, s82, 129024
    s_add_u32 s8, s70, 0x00240000
    s_addc_u32 s9, s71, 0
    s_and_b32 s9, s9, 0xffff
    s_mov_b32 s10, 0x006c0000
    s_mov_b32 s11, 0x00020000
    s_add_u32 s12, s70, 0x00900000
    s_addc_u32 s13, s71, 0
    v_mfma_f32_16x16x32_bf16 v[68:71], a[216:219], a[28:31], v[68:71]
    ds_read_b128 a[216:219], v244 offset:13312
    s_waitcnt lgkmcnt(8)
    v_mfma_f32_16x16x32_bf16 v[72:75], a[220:223], a[28:31], v[72:75]
    buffer_load_dwordx4 v191, s[24:27], s55 offen offset:2048 sc1 lds
    v_mfma_f32_16x16x32_bf16 v[36:39], a[220:223], a[24:27], v[36:39]
    ds_read_b128 a[220:223], v244 offset:14336
    s_waitcnt lgkmcnt(8)
    v_mfma_f32_16x16x32_bf16 v[40:43], a[224:227], a[24:27], v[40:43]
    s_and_b32 s13, s13, 0xffff
    s_mov_b32 s14, 0x01440000
    s_mov_b32 s15, 0x00020000
    v_lshrrev_b32 v10, 4, v0
    v_and_b32 v11, 15, v0
    v_lshlrev_b32 v11, 4, v11
    v_lshl_add_u32 v230, v10, 15, v11
    v_lshrrev_b32 v12, 3, v0
    v_lshl_add_u32 v232, v12, 15, v9
    v_add_u32 v13, 2883456, v230
    v_subrev_u32 v14, 131072, v232
    v_cmp_gt_u32 vcc, 32, v0
    s_nop 1
    v_cndmask_b32 v231, v14, v13, vcc
    v_and_b32 v12, 1, v12
    v_lshl_add_u32 v12, v12, 2, v10
    v_mfma_f32_16x16x32_bf16 v[76:79], a[224:227], a[28:31], v[76:79]
    ds_read_b128 a[224:227], v244 offset:15360
    s_waitcnt lgkmcnt(8)
    v_mfma_f32_16x16x32_bf16 v[80:83], a[228:231], a[28:31], v[80:83]
    buffer_load_dwordx4 v191, s[24:27], s55 offen offset:3072 sc1 lds
    v_mfma_f32_16x16x32_bf16 v[44:47], a[228:231], a[24:27], v[44:47]
    ds_read_b128 a[228:231], v244 offset:16384
    s_waitcnt lgkmcnt(8)
    v_mfma_f32_16x16x32_bf16 v[48:51], a[232:235], a[24:27], v[48:51]
    v_and_b32 v10, 1, v10
    v_mul_u32_u24 v12, 36, v12
    v_lshl_add_u32 v11, v10, 2, v12
    v_lshlrev_b32 v10, 5, v10
    v_sub_u32 v12, v12, v10
    v_add_u32 v9, s82, v9
    s_mov_b32 s84, 0xc8c84040
    v_add_u32 v13, 0, v11
    v_bfe_u32 v14, s84, v13, 4
    v_add_u32 v14, v14, v9
    v_lshrrev_b32 v15, 5, v13
    v_bfe_u32 v13, v13, 3, 1
    v_lshl_add_u32 v13, v15, 1, v13
    v_lshl_add_u32 v170, v13, 8, v14
    v_lshl_add_u32 v192, v13, 7, v14
    v_add_u32 v13, 8, v11
    v_mfma_f32_16x16x32_bf16 v[84:87], a[232:235], a[28:31], v[84:87]
    ds_read_b128 a[232:235], v244 offset:17408
    s_waitcnt vmcnt(35)
    s_barrier
    s_waitcnt lgkmcnt(8)
    v_mfma_f32_16x16x32_bf16 v[16:19], a[200:203], a[168:171], v[16:19]
    s_add_u32 m0, s52, 22528
    s_add_u32 s38, s55, 4096
    s_mov_b32 exec_hi, 0
    buffer_load_dwordx4 v191, s[24:27], s38 offen sc1 lds
    s_mov_b32 exec_hi, -1
    s_add_u32 s55, s55, 73728
    v_mfma_f32_16x16x32_bf16 v[52:55], a[200:203], a[172:175], v[52:55]
    ds_read_b128 a[200:203], v245 offset:0
    s_waitcnt lgkmcnt(8)
    v_mfma_f32_16x16x32_bf16 v[56:59], a[204:207], a[172:175], v[56:59]
    buffer_load_dwordx4 a[8:11], v191, s[20:23], s53 offen offset:0 sc1
    v_mfma_f32_16x16x32_bf16 v[20:23], a[204:207], a[168:171], v[20:23]
    ds_read_b128 a[204:207], v245 offset:1024
    s_waitcnt lgkmcnt(8)
    v_mfma_f32_16x16x32_bf16 v[24:27], a[208:211], a[168:171], v[24:27]
    buffer_load_dwordx4 a[12:15], v191, s[20:23], s53 offen offset:1024 sc1
    s_add_u32 s53, s53, 8192
    v_mfma_f32_16x16x32_bf16 v[60:63], a[208:211], a[172:175], v[60:63]
    ds_read_b128 a[208:211], v245 offset:2048
    s_waitcnt lgkmcnt(8)
    v_mfma_f32_16x16x32_bf16 v[64:67], a[212:215], a[172:175], v[64:67]
    buffer_load_dwordx4 a[152:155], v191, s[20:23], s54 offen offset:0 sc1
    v_mfma_f32_16x16x32_bf16 v[28:31], a[212:215], a[168:171], v[28:31]
    ds_read_b128 a[212:215], v245 offset:3072
    s_waitcnt lgkmcnt(8)
    v_mfma_f32_16x16x32_bf16 v[32:35], a[216:219], a[168:171], v[32:35]
    buffer_load_dwordx4 a[156:159], v191, s[20:23], s54 offen offset:1024 sc1
    s_add_u32 s54, s54, 8192
    v_mfma_f32_16x16x32_bf16 v[68:71], a[216:219], a[172:175], v[68:71]
    ds_read_b128 a[216:219], v245 offset:4096
    s_waitcnt lgkmcnt(8)
    v_mfma_f32_16x16x32_bf16 v[72:75], a[220:223], a[172:175], v[72:75]
    v_bfe_u32 v14, s84, v13, 4
    v_add_u32 v14, v14, v9
    v_lshrrev_b32 v15, 5, v13
    v_bfe_u32 v13, v13, 3, 1
    v_lshl_add_u32 v13, v15, 1, v13
    v_lshl_add_u32 v171, v13, 8, v14
    v_lshl_add_u32 v193, v13, 7, v14
    v_add_u32 v13, 16, v11
    v_bfe_u32 v14, s84, v13, 4
    v_add_u32 v14, v14, v9
    v_lshrrev_b32 v15, 5, v13
    v_bfe_u32 v13, v13, 3, 1
    v_lshl_add_u32 v13, v15, 1, v13
    v_lshl_add_u32 v172, v13, 8, v14
    v_lshl_add_u32 v194, v13, 7, v14
    v_add_u32 v13, 24, v11
    v_mfma_f32_16x16x32_bf16 v[36:39], a[220:223], a[168:171], v[36:39]
    ds_read_b128 a[220:223], v245 offset:5120
    s_waitcnt lgkmcnt(8)
    v_mfma_f32_16x16x32_bf16 v[40:43], a[224:227], a[168:171], v[40:43]
    s_add_u32 m0, s52, 36864
    s_nop 0
    buffer_load_dwordx4 v191, s[24:27], s55 offen sc1 lds
    v_mfma_f32_16x16x32_bf16 v[76:79], a[224:227], a[172:175], v[76:79]
    ds_read_b128 a[224:227], v245 offset:6144
    s_waitcnt lgkmcnt(8)
    v_mfma_f32_16x16x32_bf16 v[80:83], a[228:231], a[172:175], v[80:83]
    v_bfe_u32 v14, s84, v13, 4
    v_add_u32 v14, v14, v9
    v_lshrrev_b32 v15, 5, v13
    v_bfe_u32 v13, v13, 3, 1
    v_lshl_add_u32 v13, v15, 1, v13
    v_lshl_add_u32 v173, v13, 8, v14
    v_lshl_add_u32 v195, v13, 7, v14
    v_add_u32 v13, 32, v12
    v_bfe_u32 v14, s84, v13, 4
    v_add_u32 v14, v14, v9
    v_lshrrev_b32 v15, 5, v13
    v_bfe_u32 v13, v13, 3, 1
    v_lshl_add_u32 v13, v15, 1, v13
    v_lshl_add_u32 v174, v13, 8, v14
    v_lshl_add_u32 v196, v13, 7, v14
    s_mov_b32 s70, 1.0
    v_mfma_f32_16x16x32_bf16 v[44:47], a[228:231], a[168:171], v[44:47]
    ds_read_b128 a[228:231], v245 offset:7168
    s_waitcnt lgkmcnt(8)
    v_mfma_f32_16x16x32_bf16 v[48:51], a[232:235], a[168:171], v[48:51]
    buffer_load_dwordx4 v191, s[24:27], s55 offen offset:1024 sc1 lds
    v_mfma_f32_16x16x32_bf16 v[84:87], a[232:235], a[172:175], v[84:87]
    ds_read_b128 a[232:235], v245 offset:8192
    s_waitcnt vmcnt(38)
    s_mov_b32 s65, 32768
    buffer_load_dwordx2 v[176:177], v178, s[88:91], s65 offen sc1
    s_waitcnt lgkmcnt(8)
    v_mfma_f32_16x16x32_bf16 v[16:19], a[200:203], a[32:35], v[16:19]
    buffer_load_dwordx4 v191, s[24:27], s55 offen offset:2048 sc1 lds
    v_mfma_f32_16x16x32_bf16 v[52:55], a[200:203], a[36:39], v[52:55]
    ds_read_b128 a[200:203], v245 offset:9216
    s_waitcnt lgkmcnt(8)
    v_mfma_f32_16x16x32_bf16 v[56:59], a[204:207], a[36:39], v[56:59]
    buffer_load_dwordx4 v191, s[24:27], s55 offen offset:3072 sc1 lds
    v_mfma_f32_16x16x32_bf16 v[20:23], a[204:207], a[32:35], v[20:23]
    ds_read_b128 a[204:207], v245 offset:10240
    s_waitcnt lgkmcnt(8)
    v_mfma_f32_16x16x32_bf16 v[24:27], a[208:211], a[32:35], v[24:27]
    s_add_u32 m0, s52, 40960
    s_add_u32 s38, s55, 4096
    s_mov_b32 exec_hi, 0
    buffer_load_dwordx4 v191, s[24:27], s38 offen sc1 lds
    s_mov_b32 exec_hi, -1
    s_add_u32 s55, s55, 73728
    v_mfma_f32_16x16x32_bf16 v[60:63], a[208:211], a[36:39], v[60:63]
    ds_read_b128 a[208:211], v245 offset:11264
    s_waitcnt lgkmcnt(8)
    v_mfma_f32_16x16x32_bf16 v[64:67], a[212:215], a[36:39], v[64:67]
    buffer_load_dwordx4 a[16:19], v191, s[20:23], s53 offen offset:0 sc1
    v_mfma_f32_16x16x32_bf16 v[28:31], a[212:215], a[32:35], v[28:31]
    ds_read_b128 a[212:215], v245 offset:12288
    s_waitcnt lgkmcnt(8)
    v_mfma_f32_16x16x32_bf16 v[32:35], a[216:219], a[32:35], v[32:35]
    s_mov_b32 s71, 1.0
    v_mfma_f32_16x16x32_bf16 v[68:71], a[216:219], a[36:39], v[68:71]
    ds_read_b128 a[216:219], v245 offset:13312
    s_waitcnt lgkmcnt(8)
    v_mfma_f32_16x16x32_bf16 v[72:75], a[220:223], a[36:39], v[72:75]
    buffer_load_dwordx4 a[20:23], v191, s[20:23], s53 offen offset:1024 sc1
    s_add_u32 s53, s53, 8192
    v_mfma_f32_16x16x32_bf16 v[36:39], a[220:223], a[32:35], v[36:39]
    ds_read_b128 a[220:223], v245 offset:14336
    s_waitcnt lgkmcnt(8)
    v_mfma_f32_16x16x32_bf16 v[40:43], a[224:227], a[32:35], v[40:43]
    v_mfma_f32_16x16x32_bf16 v[76:79], a[224:227], a[36:39], v[76:79]
    ds_read_b128 a[224:227], v245 offset:15360
    s_waitcnt lgkmcnt(8)
    v_mfma_f32_16x16x32_bf16 v[80:83], a[228:231], a[36:39], v[80:83]
    buffer_load_dwordx4 a[160:163], v191, s[20:23], s54 offen offset:0 sc1
    v_mfma_f32_16x16x32_bf16 v[44:47], a[228:231], a[32:35], v[44:47]
    ds_read_b128 a[228:231], v245 offset:16384
    s_waitcnt lgkmcnt(8)
    v_mfma_f32_16x16x32_bf16 v[48:51], a[232:235], a[32:35], v[48:51]
    v_mfma_f32_16x16x32_bf16 v[84:87], a[232:235], a[36:39], v[84:87]
    ds_read_b128 a[232:235], v245 offset:17408
    s_waitcnt vmcnt(40)
    s_barrier
    s_waitcnt lgkmcnt(8)
    v_mfma_f32_16x16x32_bf16 v[16:19], a[200:203], a[176:179], v[16:19]
    buffer_load_dwordx4 a[164:167], v191, s[20:23], s54 offen offset:1024 sc1
    s_add_u32 s54, s54, 8192
    v_mfma_f32_16x16x32_bf16 v[52:55], a[200:203], a[180:183], v[52:55]
    ds_read_b128 a[200:203], v244 offset:18432
    s_waitcnt lgkmcnt(8)
    v_mfma_f32_16x16x32_bf16 v[56:59], a[204:207], a[180:183], v[56:59]
    s_add_u32 m0, s52, 55296
    s_nop 0
    buffer_load_dwordx4 v191, s[24:27], s55 offen sc1 lds
    v_mfma_f32_16x16x32_bf16 v[20:23], a[204:207], a[176:179], v[20:23]
    ds_read_b128 a[204:207], v244 offset:19456
    s_waitcnt lgkmcnt(8)
    v_mfma_f32_16x16x32_bf16 v[24:27], a[208:211], a[176:179], v[24:27]
    buffer_load_dwordx4 v191, s[24:27], s55 offen offset:1024 sc1 lds
    v_mfma_f32_16x16x32_bf16 v[60:63], a[208:211], a[180:183], v[60:63]
    ds_read_b128 a[208:211], v244 offset:20480
    s_waitcnt lgkmcnt(8)
    v_mfma_f32_16x16x32_bf16 v[64:67], a[212:215], a[180:183], v[64:67]
    v_mfma_f32_16x16x32_bf16 v[28:31], a[212:215], a[176:179], v[28:31]
    ds_read_b128 a[212:215], v244 offset:21504
    s_waitcnt lgkmcnt(8)
    v_mfma_f32_16x16x32_bf16 v[32:35], a[216:219], a[176:179], v[32:35]
    buffer_load_dwordx4 v191, s[24:27], s55 offen offset:2048 sc1 lds
    v_mfma_f32_16x16x32_bf16 v[68:71], a[216:219], a[180:183], v[68:71]
    ds_read_b128 a[216:219], v244 offset:22528
    s_waitcnt lgkmcnt(8)
    v_mfma_f32_16x16x32_bf16 v[72:75], a[220:223], a[180:183], v[72:75]
    v_mfma_f32_16x16x32_bf16 v[36:39], a[220:223], a[176:179], v[36:39]
    ds_read_b128 a[220:223], v244 offset:23552
    s_waitcnt lgkmcnt(8)
    v_mfma_f32_16x16x32_bf16 v[40:43], a[224:227], a[176:179], v[40:43]
    buffer_load_dwordx4 v191, s[24:27], s55 offen offset:3072 sc1 lds
    v_mfma_f32_16x16x32_bf16 v[76:79], a[224:227], a[180:183], v[76:79]
    ds_read_b128 a[224:227], v244 offset:24576
    s_waitcnt lgkmcnt(8)
    v_mfma_f32_16x16x32_bf16 v[80:83], a[228:231], a[180:183], v[80:83]
    v_mfma_f32_16x16x32_bf16 v[44:47], a[228:231], a[176:179], v[44:47]
    ds_read_b128 a[228:231], v244 offset:25600
    s_waitcnt lgkmcnt(8)
    v_mfma_f32_16x16x32_bf16 v[48:51], a[232:235], a[176:179], v[48:51]
    s_add_u32 m0, s52, 59392
    s_add_u32 s38, s55, 4096
    s_mov_b32 exec_hi, 0
    buffer_load_dwordx4 v191, s[24:27], s38 offen sc1 lds
    s_mov_b32 exec_hi, -1
    s_add_u32 s55, s55, 73728
    v_mfma_f32_16x16x32_bf16 v[84:87], a[232:235], a[180:183], v[84:87]
    ds_read_b128 a[232:235], v244 offset:26624
    s_waitcnt vmcnt(42)
    s_waitcnt lgkmcnt(8)
    v_mfma_f32_16x16x32_bf16 v[16:19], a[200:203], a[40:43], v[16:19]
    v_mfma_f32_16x16x32_bf16 v[52:55], a[200:203], a[44:47], v[52:55]
    ds_read_b128 a[200:203], v244 offset:27648
    s_waitcnt lgkmcnt(8)
    v_mfma_f32_16x16x32_bf16 v[56:59], a[204:207], a[44:47], v[56:59]
    buffer_load_dwordx4 a[24:27], v191, s[20:23], s53 offen offset:0 sc1
    v_mfma_f32_16x16x32_bf16 v[20:23], a[204:207], a[40:43], v[20:23]
    ds_read_b128 a[204:207], v244 offset:28672
    s_waitcnt lgkmcnt(8)
    v_mfma_f32_16x16x32_bf16 v[24:27], a[208:211], a[40:43], v[24:27]
    v_mfma_f32_16x16x32_bf16 v[60:63], a[208:211], a[44:47], v[60:63]
    ds_read_b128 a[208:211], v244 offset:29696
    s_waitcnt lgkmcnt(8)
    v_mfma_f32_16x16x32_bf16 v[64:67], a[212:215], a[44:47], v[64:67]
    buffer_load_dwordx4 a[28:31], v191, s[20:23], s53 offen offset:1024 sc1
    s_add_u32 s53, s53, 8192
    v_mfma_f32_16x16x32_bf16 v[28:31], a[212:215], a[40:43], v[28:31]
    ds_read_b128 a[212:215], v244 offset:30720
    s_waitcnt lgkmcnt(8)
    v_mfma_f32_16x16x32_bf16 v[32:35], a[216:219], a[40:43], v[32:35]
    v_mfma_f32_16x16x32_bf16 v[68:71], a[216:219], a[44:47], v[68:71]
    ds_read_b128 a[216:219], v244 offset:31744
    s_waitcnt lgkmcnt(8)
    v_mfma_f32_16x16x32_bf16 v[72:75], a[220:223], a[44:47], v[72:75]
    buffer_load_dwordx4 a[168:171], v191, s[20:23], s54 offen offset:0 sc1
    v_mfma_f32_16x16x32_bf16 v[36:39], a[220:223], a[40:43], v[36:39]
    ds_read_b128 a[220:223], v244 offset:32768
    s_waitcnt lgkmcnt(8)
    v_mfma_f32_16x16x32_bf16 v[40:43], a[224:227], a[40:43], v[40:43]
    v_mfma_f32_16x16x32_bf16 v[76:79], a[224:227], a[44:47], v[76:79]
    ds_read_b128 a[224:227], v244 offset:33792
    s_waitcnt lgkmcnt(8)
    v_mfma_f32_16x16x32_bf16 v[80:83], a[228:231], a[44:47], v[80:83]
    buffer_load_dwordx4 a[172:175], v191, s[20:23], s54 offen offset:1024 sc1
    s_add_u32 s54, s54, 8192
    v_mfma_f32_16x16x32_bf16 v[44:47], a[228:231], a[40:43], v[44:47]
    ds_read_b128 a[228:231], v244 offset:34816
    s_waitcnt lgkmcnt(8)
    v_mfma_f32_16x16x32_bf16 v[48:51], a[232:235], a[40:43], v[48:51]
    v_mfma_f32_16x16x32_bf16 v[84:87], a[232:235], a[44:47], v[84:87]
    ds_read_b128 a[232:235], v244 offset:35840
    s_waitcnt vmcnt(41)
    s_waitcnt vmcnt(16)
L_spg:
    v_xor_b32 v176, s66, v176
    v_xor_b32 v177, s67, v177
    v_or_b32 v176, v176, v177
    v_cmp_ne_u32 vcc, 0, v176
    s_nop 3
    s_cmp_eq_u64 vcc, 0
    s_cbranch_scc1 L_spokg
    s_sleep 4
    buffer_load_dwordx2 v[176:177], v178, s[88:91], s65 offen sc1
    s_waitcnt vmcnt(0)
    s_branch L_spg
L_spokg:
    s_barrier
    s_add_u32 m0, s82, 0
    s_add_u32 s87, s80, 0
    buffer_load_dwordx4 v230, s[8:11], s87 offen sc1 lds
    s_add_u32 m0, s82, 1024
    s_add_u32 s87, s80, 131072
    buffer_load_dwordx4 v230, s[8:11], s87 offen sc1 lds
    s_add_u32 m0, s82, 2048
    s_add_u32 s87, s80, 262144
    buffer_load_dwordx4 v230, s[8:11], s87 offen sc1 lds
    s_add_u32 m0, s82, 3072
    s_add_u32 s87, s80, 393216
    buffer_load_dwordx4 v230, s[8:11], s87 offen sc1 lds
    s_add_u32 m0, s82, 4096
    s_add_u32 s87, s81, 0
    buffer_load_dwordx4 v231, s[8:11], s87 offen sc1 lds
    s_add_u32 m0, s82, 5120
    s_add_u32 s87, s81, 131072
    buffer_load_dwordx4 v232, s[8:11], s87 offen sc1 lds
    s_add_u32 m0, s82, 6144
    s_add_u32 s87, s81, 393216
    buffer_load_dwordx4 v232, s[8:11], s87 offen sc1 lds
    s_waitcnt lgkmcnt(8)
    v_mfma_f32_16x16x32_bf16 v[16:19], a[200:203], a[184:187], v[16:19]
    s_add_u32 m0, s52, 110592
    s_nop 0
    buffer_load_dwordx4 v191, s[24:27], s55 offen sc1 lds
    v_mfma_f32_16x16x32_bf16 v[52:55], a[200:203], a[188:191], v[52:55]
    ds_read_b128 a[200:203], v244 offset:36864
    s_waitcnt lgkmcnt(8)
    v_mfma_f32_16x16x32_bf16 v[56:59], a[204:207], a[188:191], v[56:59]
    v_mfma_f32_16x16x32_bf16 v[20:23], a[204:207], a[184:187], v[20:23]
    ds_read_b128 a[204:207], v244 offset:37888
    s_waitcnt lgkmcnt(8)
    v_mfma_f32_16x16x32_bf16 v[24:27], a[208:211], a[184:187], v[24:27]
    buffer_load_dwordx4 v191, s[24:27], s55 offen offset:1024 sc1 lds
    v_mfma_f32_16x16x32_bf16 v[60:63], a[208:211], a[188:191], v[60:63]
    ds_read_b128 a[208:211], v244 offset:38912
    s_waitcnt lgkmcnt(8)
    v_mfma_f32_16x16x32_bf16 v[64:67], a[212:215], a[188:191], v[64:67]
    v_mfma_f32_16x16x32_bf16 v[28:31], a[212:215], a[184:187], v[28:31]
    ds_read_b128 a[212:215], v244 offset:39936
    s_waitcnt lgkmcnt(8)
    v_mfma_f32_16x16x32_bf16 v[32:35], a[216:219], a[184:187], v[32:35]
    buffer_load_dwordx4 v191, s[24:27], s55 offen offset:2048 sc1 lds
    v_mfma_f32_16x16x32_bf16 v[68:71], a[216:219], a[188:191], v[68:71]
    ds_read_b128 a[216:219], v244 offset:40960
    s_waitcnt lgkmcnt(8)
    v_mfma_f32_16x16x32_bf16 v[72:75], a[220:223], a[188:191], v[72:75]
    v_mfma_f32_16x16x32_bf16 v[36:39], a[220:223], a[184:187], v[36:39]
    ds_read_b128 a[220:223], v244 offset:41984
    s_waitcnt lgkmcnt(8)
    v_mfma_f32_16x16x32_bf16 v[40:43], a[224:227], a[184:187], v[40:43]
    buffer_load_dwordx4 v191, s[24:27], s55 offen offset:3072 sc1 lds
    v_mfma_f32_16x16x32_bf16 v[76:79], a[224:227], a[188:191], v[76:79]
    ds_read_b128 a[224:227], v244 offset:43008
    s_waitcnt lgkmcnt(8)
    v_mfma_f32_16x16x32_bf16 v[80:83], a[228:231], a[188:191], v[80:83]
    v_mfma_f32_16x16x32_bf16 v[44:47], a[228:231], a[184:187], v[44:47]
    ds_read_b128 a[228:231], v244 offset:44032
    s_waitcnt lgkmcnt(8)
    v_mfma_f32_16x16x32_bf16 v[48:51], a[232:235], a[184:187], v[48:51]
    s_add_u32 m0, s52, 114688
    s_add_u32 s38, s55, 4096
    s_mov_b32 exec_hi, 0
    buffer_load_dwordx4 v191, s[24:27], s38 offen sc1 lds
    s_mov_b32 exec_hi, -1
    s_add_u32 s55, s55, 73728
    v_mfma_f32_16x16x32_bf16 v[84:87], a[232:235], a[188:191], v[84:87]
    ds_read_b128 a[232:235], v244 offset:45056
    s_waitcnt vmcnt(49)
    s_waitcnt lgkmcnt(8)
    v_mfma_f32_16x16x32_bf16 v[16:19], a[200:203], a[48:51], v[16:19]
    v_mfma_f32_16x16x32_bf16 v[52:55], a[200:203], a[52:55], v[52:55]
    ds_read_b128 a[200:203], v244 offset:46080
    s_waitcnt lgkmcnt(8)
    v_mfma_f32_16x16x32_bf16 v[56:59], a[204:207], a[52:55], v[56:59]
    buffer_load_dwordx4 a[32:35], v191, s[20:23], s53 offen offset:0 sc1
    v_mfma_f32_16x16x32_bf16 v[20:23], a[204:207], a[48:51], v[20:23]
    ds_read_b128 a[204:207], v244 offset:47104
    s_waitcnt lgkmcnt(8)
    v_mfma_f32_16x16x32_bf16 v[24:27], a[208:211], a[48:51], v[24:27]
    v_mfma_f32_16x16x32_bf16 v[60:63], a[208:211], a[52:55], v[60:63]
    ds_read_b128 a[208:211], v244 offset:48128
    s_waitcnt lgkmcnt(8)
    v_mfma_f32_16x16x32_bf16 v[64:67], a[212:215], a[52:55], v[64:67]
    buffer_load_dwordx4 a[36:39], v191, s[20:23], s53 offen offset:1024 sc1
    s_add_u32 s53, s53, 8192
    v_mfma_f32_16x16x32_bf16 v[28:31], a[212:215], a[48:51], v[28:31]
    ds_read_b128 a[212:215], v244 offset:49152
    s_waitcnt lgkmcnt(8)
    v_mfma_f32_16x16x32_bf16 v[32:35], a[216:219], a[48:51], v[32:35]
    v_mfma_f32_16x16x32_bf16 v[68:71], a[216:219], a[52:55], v[68:71]
    ds_read_b128 a[216:219], v244 offset:50176
    s_waitcnt lgkmcnt(8)
    v_mfma_f32_16x16x32_bf16 v[72:75], a[220:223], a[52:55], v[72:75]
    buffer_load_dwordx4 a[176:179], v191, s[20:23], s54 offen offset:0 sc1
    v_mfma_f32_16x16x32_bf16 v[36:39], a[220:223], a[48:51], v[36:39]
    ds_read_b128 a[220:223], v244 offset:51200
    s_waitcnt lgkmcnt(8)
    v_mfma_f32_16x16x32_bf16 v[40:43], a[224:227], a[48:51], v[40:43]
    v_mfma_f32_16x16x32_bf16 v[76:79], a[224:227], a[52:55], v[76:79]
    ds_read_b128 a[224:227], v244 offset:52224
    s_waitcnt lgkmcnt(8)
    v_mfma_f32_16x16x32_bf16 v[80:83], a[228:231], a[52:55], v[80:83]
    buffer_load_dwordx4 a[180:183], v191, s[20:23], s54 offen offset:1024 sc1
    s_add_u32 s54, s54, 8192
    v_mfma_f32_16x16x32_bf16 v[44:47], a[228:231], a[48:51], v[44:47]
    ds_read_b128 a[228:231], v244 offset:53248
    s_waitcnt lgkmcnt(8)
    v_mfma_f32_16x16x32_bf16 v[48:51], a[232:235], a[48:51], v[48:51]
    s_waitcnt vmcnt(9)
    ds_read_b64 v[208:209], v192 offset:4608
    ds_read_b64 v[210:211], v193 offset:4608
    ds_read_b64 v[212:213], v194 offset:4608
    ds_read_b64 v[214:215], v195 offset:4608
    ds_read_b32 v216, v196 offset:4608
    ds_read2_b64 v[98:101], v170 offset0:16 offset1:14
    ds_read2_b64 v[102:105], v171 offset0:16 offset1:14
    ds_read2_b64 v[106:109], v172 offset0:16 offset1:14
    ds_read2_b64 v[110:113], v173 offset0:16 offset1:14
    ds_read2_b32 v[114:115], v174 offset0:32 offset1:28
    ds_read2_b64 v[116:119], v170 offset0:12 offset1:10
    ds_read2_b64 v[120:123], v171 offset0:12 offset1:10
    ds_read2_b64 v[124:127], v172 offset0:12 offset1:10
    ds_read2_b64 v[128:131], v173 offset0:12 offset1:10
    ds_read2_b32 v[132:133], v174 offset0:24 offset1:20
    ds_read2_b64 v[134:137], v170 offset0:8 offset1:6
    v_mfma_f32_16x16x32_bf16 v[84:87], a[232:235], a[52:55], v[84:87]
    ds_read_b128 a[232:235], v244 offset:54272
    s_waitcnt vmcnt(48)
    s_barrier
    s_waitcnt lgkmcnt(8)
    v_mfma_f32_16x16x32_bf16 v[16:19], a[200:203], a[192:195], v[16:19]
    s_add_u32 m0, s52, 73728
    s_nop 0
    buffer_load_dwordx4 v191, s[24:27], s55 offen sc1 lds
    v_mfma_f32_16x16x32_bf16 v[52:55], a[200:203], a[196:199], v[52:55]
    ds_read_b128 a[200:203], v243 offset:0
    s_waitcnt lgkmcnt(8)
    v_mfma_f32_16x16x32_bf16 v[56:59], a[204:207], a[196:199], v[56:59]
    ds_read2_b64 v[138:141], v171 offset0:8 offset1:6
    ds_read2_b64 v[142:145], v172 offset0:8 offset1:6
    ds_read2_b64 v[146:149], v173 offset0:8 offset1:6
    ds_read2_b32 v[150:151], v174 offset0:16 offset1:12
    ds_read2_b64 v[152:155], v170 offset0:4 offset1:2
    ds_read2_b64 v[156:159], v171 offset0:4 offset1:2
    ds_read2_b64 v[160:163], v172 offset0:4 offset1:2
    ds_read2_b64 v[164:167], v173 offset0:4 offset1:2
    ds_read2_b32 v[168:169], v174 offset0:8 offset1:4
    s_waitcnt lgkmcnt(0)
    s_add_u32 m0, s82, 0
    s_add_u32 s87, s80, 2359296
    buffer_load_dwordx4 v230, s[8:11], s87 offen sc1 lds
    v_mfma_f32_16x16x32_bf16 v[20:23], a[204:207], a[192:195], v[20:23]
    ds_read_b128 a[204:207], v243 offset:1024
    s_waitcnt lgkmcnt(8)
    v_mfma_f32_16x16x32_bf16 v[24:27], a[208:211], a[192:195], v[24:27]
    s_add_u32 m0, s52, 73728
    s_nop 0
    buffer_load_dwordx4 v191, s[24:27], s55 offen offset:1024 sc1 lds
    v_mfma_f32_16x16x32_bf16 v[60:63], a[208:211], a[196:199], v[60:63]
    ds_read_b128 a[208:211], v243 offset:2048
    s_waitcnt lgkmcnt(8)
    v_mfma_f32_16x16x32_bf16 v[64:67], a[212:215], a[196:199], v[64:67]
    s_add_u32 m0, s82, 1024
    s_add_u32 s87, s80, 2490368
    buffer_load_dwordx4 v230, s[8:11], s87 offen sc1 lds
    s_add_u32 m0, s82, 2048
    s_add_u32 s87, s80, 2621440
    buffer_load_dwordx4 v230, s[8:11], s87 offen sc1 lds
    s_add_u32 m0, s82, 3072
    s_add_u32 s87, s80, 2752512
    buffer_load_dwordx4 v230, s[8:11], s87 offen sc1 lds
    v_mfma_f32_16x16x32_bf16 v[28:31], a[212:215], a[192:195], v[28:31]
    ds_read_b128 a[212:215], v243 offset:3072
    s_waitcnt lgkmcnt(8)
    v_mfma_f32_16x16x32_bf16 v[32:35], a[216:219], a[192:195], v[32:35]
    s_add_u32 m0, s52, 73728
    s_nop 0
    buffer_load_dwordx4 v191, s[24:27], s55 offen offset:2048 sc1 lds
    v_mfma_f32_16x16x32_bf16 v[68:71], a[216:219], a[196:199], v[68:71]
    ds_read_b128 a[216:219], v243 offset:4096
    s_waitcnt lgkmcnt(8)
    v_mfma_f32_16x16x32_bf16 v[72:75], a[220:223], a[196:199], v[72:75]
    s_add_u32 m0, s82, 4096
    s_add_u32 s87, s80, 2883584
    buffer_load_dwordx4 v230, s[8:11], s87 offen sc1 lds
    v_dot2_f32_bf16 v218, v208, v98, 0
    v_dot2_f32_bf16 v219, v208, v100, 0
    v_dot2_f32_bf16 v220, v208, v116, 0
    v_dot2_f32_bf16 v221, v208, v118, 0
    v_dot2_f32_bf16 v222, v208, v134, 0
    v_dot2_f32_bf16 v223, v208, v136, 0
    v_dot2_f32_bf16 v224, v208, v152, 0
    v_dot2_f32_bf16 v225, v208, v154, 0
    v_dot2_f32_bf16 v218, v209, v99, v218
    v_dot2_f32_bf16 v219, v209, v101, v219
    v_dot2_f32_bf16 v220, v209, v117, v220
    v_dot2_f32_bf16 v221, v209, v119, v221
    v_dot2_f32_bf16 v222, v209, v135, v222
    v_dot2_f32_bf16 v223, v209, v137, v223
    v_dot2_f32_bf16 v224, v209, v153, v224
    v_dot2_f32_bf16 v225, v209, v155, v225
    v_dot2_f32_bf16 v218, v210, v102, v218
    v_dot2_f32_bf16 v219, v210, v104, v219
    v_dot2_f32_bf16 v220, v210, v120, v220
    v_dot2_f32_bf16 v221, v210, v122, v221
    v_dot2_f32_bf16 v222, v210, v138, v222
    v_dot2_f32_bf16 v223, v210, v140, v223
    v_dot2_f32_bf16 v224, v210, v156, v224
    v_dot2_f32_bf16 v225, v210, v158, v225
    v_dot2_f32_bf16 v218, v211, v103, v218
    v_dot2_f32_bf16 v219, v211, v105, v219
    v_dot2_f32_bf16 v220, v211, v121, v220
    v_dot2_f32_bf16 v221, v211, v123, v221
    v_dot2_f32_bf16 v222, v211, v139, v222
    v_dot2_f32_bf16 v223, v211, v141, v223
    v_dot2_f32_bf16 v224, v211, v157, v224
    v_dot2_f32_bf16 v225, v211, v159, v225
    v_dot2_f32_bf16 v218, v212, v106, v218
    v_dot2_f32_bf16 v219, v212, v108, v219
    v_dot2_f32_bf16 v220, v212, v124, v220
    v_dot2_f32_bf16 v221, v212, v126, v221
    v_mfma_f32_16x16x32_bf16 v[36:39], a[220:223], a[192:195], v[36:39]
    ds_read_b128 a[220:223], v243 offset:5120
    s_waitcnt lgkmcnt(8)
    v_mfma_f32_16x16x32_bf16 v[40:43], a[224:227], a[192:195], v[40:43]
    s_add_u32 m0, s52, 73728
    s_nop 0
    buffer_load_dwordx4 v191, s[24:27], s55 offen offset:3072 sc1 lds
    v_mfma_f32_16x16x32_bf16 v[76:79], a[224:227], a[196:199], v[76:79]
    ds_read_b128 a[224:227], v243 offset:6144
    s_waitcnt lgkmcnt(8)
    v_mfma_f32_16x16x32_bf16 v[80:83], a[228:231], a[196:199], v[80:83]
    v_mfma_f32_16x16x32_bf16 v[44:47], a[228:231], a[192:195], v[44:47]
    ds_read_b128 a[228:231], v243 offset:7168
    s_waitcnt lgkmcnt(8)
    v_mfma_f32_16x16x32_bf16 v[48:51], a[232:235], a[192:195], v[48:51]
    s_add_u32 m0, s52, 77824
    s_add_u32 s38, s55, 4096
    s_mov_b32 exec_hi, 0
    buffer_load_dwordx4 v191, s[24:27], s38 offen sc1 lds
    s_mov_b32 exec_hi, -1
    s_add_u32 s55, s55, 73728
    v_mfma_f32_16x16x32_bf16 v[84:87], a[232:235], a[196:199], v[84:87]
    ds_read_b128 a[232:235], v243 offset:8192
    s_waitcnt vmcnt(54)
    s_waitcnt lgkmcnt(8)
    v_mfma_f32_16x16x32_bf16 v[16:19], a[200:203], a[0:3], v[16:19]
    v_dot2_f32_bf16 v222, v212, v142, v222
    v_dot2_f32_bf16 v223, v212, v144, v223
    v_dot2_f32_bf16 v224, v212, v160, v224
    v_dot2_f32_bf16 v225, v212, v162, v225
    v_dot2_f32_bf16 v218, v213, v107, v218
    v_dot2_f32_bf16 v219, v213, v109, v219
    v_dot2_f32_bf16 v220, v213, v125, v220
    v_dot2_f32_bf16 v221, v213, v127, v221
    v_dot2_f32_bf16 v222, v213, v143, v222
    v_dot2_f32_bf16 v223, v213, v145, v223
    v_dot2_f32_bf16 v224, v213, v161, v224
    v_dot2_f32_bf16 v225, v213, v163, v225
    v_dot2_f32_bf16 v218, v214, v110, v218
    v_dot2_f32_bf16 v219, v214, v112, v219
    v_dot2_f32_bf16 v220, v214, v128, v220
    v_dot2_f32_bf16 v221, v214, v130, v221
    v_dot2_f32_bf16 v222, v214, v146, v222
    v_dot2_f32_bf16 v223, v214, v148, v223
    v_dot2_f32_bf16 v224, v214, v164, v224
    v_dot2_f32_bf16 v225, v214, v166, v225
    v_dot2_f32_bf16 v218, v215, v111, v218
    v_dot2_f32_bf16 v219, v215, v113, v219
    v_dot2_f32_bf16 v220, v215, v129, v220
    v_dot2_f32_bf16 v221, v215, v131, v221
    v_dot2_f32_bf16 v222, v215, v147, v222
    v_dot2_f32_bf16 v223, v215, v149, v223
    v_dot2_f32_bf16 v224, v215, v165, v224
    v_dot2_f32_bf16 v225, v215, v167, v225
    v_dot2_f32_bf16 v218, v216, v114, v218
    v_dot2_f32_bf16 v219, v216, v115, v219
    v_dot2_f32_bf16 v220, v216, v132, v220
    v_dot2_f32_bf16 v221, v216, v133, v221
    v_dot2_f32_bf16 v222, v216, v150, v222
    v_dot2_f32_bf16 v223, v216, v151, v223
    v_dot2_f32_bf16 v224, v216, v168, v224
    v_dot2_f32_bf16 v225, v216, v169, v225
    v_mfma_f32_16x16x32_bf16 v[52:55], a[200:203], a[4:7], v[52:55]
    ds_read_b128 a[200:203], v243 offset:9216
    s_waitcnt lgkmcnt(8)
    v_mfma_f32_16x16x32_bf16 v[56:59], a[204:207], a[4:7], v[56:59]
    buffer_load_dwordx4 a[40:43], v191, s[20:23], s53 offen offset:0 sc1
    v_mfma_f32_16x16x32_bf16 v[20:23], a[204:207], a[0:3], v[20:23]
    ds_read_b128 a[204:207], v243 offset:10240
    s_waitcnt lgkmcnt(8)
    v_mfma_f32_16x16x32_bf16 v[24:27], a[208:211], a[0:3], v[24:27]
    v_mfma_f32_16x16x32_bf16 v[60:63], a[208:211], a[4:7], v[60:63]
    ds_read_b128 a[208:211], v243 offset:11264
    s_waitcnt lgkmcnt(8)
    v_mfma_f32_16x16x32_bf16 v[64:67], a[212:215], a[4:7], v[64:67]
    buffer_load_dwordx4 a[44:47], v191, s[20:23], s53 offen offset:1024 sc1
    s_add_u32 s53, s53, 8192
    v_mfma_f32_16x16x32_bf16 v[28:31], a[212:215], a[0:3], v[28:31]
    ds_read_b128 a[212:215], v243 offset:12288
    s_waitcnt lgkmcnt(8)
    v_mfma_f32_16x16x32_bf16 v[32:35], a[216:219], a[0:3], v[32:35]
    v_mfma_f32_16x16x32_bf16 v[68:71], a[216:219], a[4:7], v[68:71]
    ds_read_b128 a[216:219], v243 offset:13312
    s_waitcnt lgkmcnt(8)
    v_mfma_f32_16x16x32_bf16 v[72:75], a[220:223], a[4:7], v[72:75]
    buffer_load_dwordx4 a[184:187], v191, s[20:23], s54 offen offset:0 sc1
    v_mfma_f32_16x16x32_bf16 v[36:39], a[220:223], a[0:3], v[36:39]
    ds_read_b128 a[220:223], v243 offset:14336
    s_waitcnt lgkmcnt(8)
    v_mfma_f32_16x16x32_bf16 v[40:43], a[224:227], a[0:3], v[40:43]
    s_nop 3
    v_cvt_pk_bf16_f32 v218, 0, v218
    v_cvt_pk_bf16_f32 v219, 0, v219
    v_cvt_pk_bf16_f32 v220, 0, v220
    v_cvt_pk_bf16_f32 v221, 0, v221
    v_cvt_pk_bf16_f32 v222, 0, v222
    v_cvt_pk_bf16_f32 v223, 0, v223
    v_cvt_pk_bf16_f32 v224, 0, v224
    v_cvt_pk_bf16_f32 v225, 0, v225
    v_mul_f32 v218, 0x3e715bef, v218
    v_mul_f32 v219, 0x3e715bef, v219
    v_mul_f32 v220, 0x3e715bef, v220
    v_mul_f32 v221, 0x3e715bef, v221
    v_mul_f32 v222, 0x3e715bef, v222
    v_mul_f32 v223, 0x3e715bef, v223
    v_mfma_f32_16x16x32_bf16 v[76:79], a[224:227], a[4:7], v[76:79]
    ds_read_b128 a[224:227], v243 offset:15360
    s_waitcnt lgkmcnt(8)
    v_mfma_f32_16x16x32_bf16 v[80:83], a[228:231], a[4:7], v[80:83]
    buffer_load_dwordx4 a[188:191], v191, s[20:23], s54 offen offset:1024 sc1
    s_add_u32 s54, s54, 8192
    v_mfma_f32_16x16x32_bf16 v[44:47], a[228:231], a[0:3], v[44:47]
    ds_read_b128 a[228:231], v243 offset:16384
    s_waitcnt lgkmcnt(8)
    v_mfma_f32_16x16x32_bf16 v[48:51], a[232:235], a[0:3], v[48:51]
    v_mul_f32 v224, 0x3e715bef, v224
    v_mul_f32 v225, 0x3e715bef, v225
    v_cvt_pk_bf16_f32 v218, 0, v218
    v_cvt_pk_bf16_f32 v219, 0, v219
    v_cvt_pk_bf16_f32 v220, 0, v220
    v_cvt_pk_bf16_f32 v221, 0, v221
    v_cvt_pk_bf16_f32 v222, 0, v222
    v_cvt_pk_bf16_f32 v223, 0, v223
    v_cvt_pk_bf16_f32 v224, 0, v224
    v_cvt_pk_bf16_f32 v225, 0, v225
    s_cmp_ge_u32 s83, 2
    s_cbranch_scc1 L_att_nomask
    v_mov_b32 v13, 0xce6e6b28
    v_cmp_le_u32 vcc, 2, v6
    s_nop 1
    v_cndmask_b32 v219, v13, v219, vcc
    v_cmp_le_u32 vcc, 4, v6
    s_nop 1
    v_cndmask_b32 v220, v13, v220, vcc
    v_cmp_le_u32 vcc, 6, v6
    s_nop 1
    v_cndmask_b32 v221, v13, v221, vcc
    v_cmp_le_u32 vcc, 8, v6
    s_nop 1
    v_cndmask_b32 v222, v13, v222, vcc
    v_cmp_le_u32 vcc, 10, v6
    s_nop 1
    v_cndmask_b32 v223, v13, v223, vcc
    v_cmp_le_u32 vcc, 12, v6
    s_nop 1
    v_cndmask_b32 v224, v13, v224, vcc
    v_cmp_le_u32 vcc, 14, v6
    s_nop 1
    v_cndmask_b32 v225, v13, v225, vcc
L_att_nomask:
    v_max3_f32 v12, v218, v219, v220
    v_max3_f32 v12, v12, v221, v222
    v_max3_f32 v12, v12, v223, v224
    v_max_f32 v12, v12, v225
    v_mfma_f32_16x16x32_bf16 v[84:87], a[232:235], a[4:7], v[84:87]
    ds_read_b128 a[232:235], v243 offset:17408
    s_waitcnt vmcnt(53)
    s_barrier
    s_waitcnt lgkmcnt(8)
    v_mfma_f32_16x16x32_bf16 v[16:19], a[200:203], a[144:147], v[16:19]
    s_add_u32 m0, s52, 92160
    s_nop 0
    buffer_load_dwordx4 v191, s[24:27], s55 offen sc1 lds
    v_mfma_f32_16x16x32_bf16 v[52:55], a[200:203], a[148:151], v[52:55]
    ds_read_b128 a[200:203], v243 offset:18432
    s_waitcnt lgkmcnt(8)
    v_mfma_f32_16x16x32_bf16 v[56:59], a[204:207], a[148:151], v[56:59]
    v_sub_f32 v218, v218, v12
    v_mul_f32 v218, 0x3fb8aa3b, v218
    v_exp_f32 v218, v218
    v_sub_f32 v219, v219, v12
    v_mul_f32 v219, 0x3fb8aa3b, v219
    v_exp_f32 v219, v219
    v_sub_f32 v220, v220, v12
    v_mul_f32 v220, 0x3fb8aa3b, v220
    v_exp_f32 v220, v220
    v_sub_f32 v221, v221, v12
    v_mul_f32 v221, 0x3fb8aa3b, v221
    v_exp_f32 v221, v221
    v_sub_f32 v222, v222, v12
    v_mul_f32 v222, 0x3fb8aa3b, v222
    v_exp_f32 v222, v222
    v_sub_f32 v223, v223, v12
    v_mfma_f32_16x16x32_bf16 v[20:23], a[204:207], a[144:147], v[20:23]
    ds_read_b128 a[204:207], v243 offset:19456
    s_waitcnt lgkmcnt(8)
    v_mfma_f32_16x16x32_bf16 v[24:27], a[208:211], a[144:147], v[24:27]
    buffer_load_dwordx4 v191, s[24:27], s55 offen offset:1024 sc1 lds
    v_mfma_f32_16x16x32_bf16 v[60:63], a[208:211], a[148:151], v[60:63]
    ds_read_b128 a[208:211], v243 offset:20480
    s_waitcnt lgkmcnt(8)
    v_mfma_f32_16x16x32_bf16 v[64:67], a[212:215], a[148:151], v[64:67]
    v_mul_f32 v223, 0x3fb8aa3b, v223
    v_exp_f32 v223, v223
    v_sub_f32 v224, v224, v12
    v_mul_f32 v224, 0x3fb8aa3b, v224
    v_exp_f32 v224, v224
    v_sub_f32 v225, v225, v12
    v_mul_f32 v225, 0x3fb8aa3b, v225
    v_exp_f32 v225, v225
    s_nop 0
    v_add_f32 v12, v218, v219
    v_add_f32 v13, v220, v221
    v_add_f32 v14, v222, v223
    v_add_f32 v15, v224, v225
    v_add_f32 v12, v12, v13
    v_add_f32 v14, v14, v15
    v_add_f32 v12, v12, v14
    v_mfma_f32_16x16x32_bf16 v[28:31], a[212:215], a[144:147], v[28:31]
    ds_read_b128 a[212:215], v243 offset:21504
    s_waitcnt lgkmcnt(8)
    v_mfma_f32_16x16x32_bf16 v[32:35], a[216:219], a[144:147], v[32:35]
    buffer_load_dwordx4 v191, s[24:27], s55 offen offset:2048 sc1 lds
    v_mfma_f32_16x16x32_bf16 v[68:71], a[216:219], a[148:151], v[68:71]
    ds_read_b128 a[216:219], v243 offset:22528
    s_waitcnt lgkmcnt(8)
    v_mfma_f32_16x16x32_bf16 v[72:75], a[220:223], a[148:151], v[72:75]
    v_rcp_f32 v12, v12
    s_nop 0
    v_mul_f32 v218, v218, v12
    v_mul_f32 v219, v219, v12
    v_mul_f32 v220, v220, v12
    v_mul_f32 v221, v221, v12
    v_mul_f32 v222, v222, v12
    v_mul_f32 v223, v223, v12
    v_mul_f32 v224, v224, v12
    v_mul_f32 v225, v225, v12
    v_cvt_pk_bf16_f32 v226, v218, v219
    v_cvt_pk_bf16_f32 v227, v220, v221
    v_cvt_pk_bf16_f32 v228, v222, v223
    v_cvt_pk_bf16_f32 v229, v224, v225
    v_mfma_f32_16x16x32_bf16 v[36:39], a[220:223], a[144:147], v[36:39]
    ds_read_b128 a[220:223], v243 offset:23552
    s_waitcnt lgkmcnt(8)
    v_mfma_f32_16x16x32_bf16 v[40:43], a[224:227], a[144:147], v[40:43]
    buffer_load_dwordx4 v191, s[24:27], s55 offen offset:3072 sc1 lds
    v_mfma_f32_16x16x32_bf16 v[76:79], a[224:227], a[148:151], v[76:79]
    ds_read_b128 a[224:227], v243 offset:24576
    s_waitcnt lgkmcnt(8)
    v_mfma_f32_16x16x32_bf16 v[80:83], a[228:231], a[148:151], v[80:83]
    v_mfma_f32_16x16x32_bf16 v[44:47], a[228:231], a[144:147], v[44:47]
    ds_read_b128 a[228:231], v243 offset:25600
    s_waitcnt lgkmcnt(8)
    v_mfma_f32_16x16x32_bf16 v[48:51], a[232:235], a[144:147], v[48:51]
    s_add_u32 m0, s52, 96256
    s_add_u32 s38, s55, 4096
    s_mov_b32 exec_hi, 0
    buffer_load_dwordx4 v191, s[24:27], s38 offen sc1 lds
    s_mov_b32 exec_hi, -1
    s_add_u32 s55, s55, 73728
    v_mfma_f32_16x16x32_bf16 v[84:87], a[232:235], a[148:151], v[84:87]
    ds_read_b128 a[232:235], v243 offset:26624
    s_waitcnt vmcnt(54)
    s_waitcnt lgkmcnt(8)
    v_mfma_f32_16x16x32_bf16 v[16:19], a[200:203], a[8:11], v[16:19]
    v_mfma_f32_16x16x32_bf16 v[52:55], a[200:203], a[12:15], v[52:55]
    ds_read_b128 a[200:203], v243 offset:27648
    s_waitcnt lgkmcnt(8)
    v_mfma_f32_16x16x32_bf16 v[56:59], a[204:207], a[12:15], v[56:59]
    buffer_load_dwordx4 a[48:51], v191, s[20:23], s53 offen offset:0 sc1
    v_mfma_f32_16x16x32_bf16 v[20:23], a[204:207], a[8:11], v[20:23]
    ds_read_b128 a[204:207], v243 offset:28672
    s_waitcnt lgkmcnt(8)
    v_mfma_f32_16x16x32_bf16 v[24:27], a[208:211], a[8:11], v[24:27]
    s_waitcnt vmcnt(12)
    ds_read2_b64 v[98:101], v170 offset0:16 offset1:14
    ds_read2_b64 v[102:105], v171 offset0:16 offset1:14
    ds_read2_b64 v[106:109], v172 offset0:16 offset1:14
    ds_read2_b64 v[110:113], v173 offset0:16 offset1:14
    ds_read2_b32 v[114:115], v174 offset0:32 offset1:28
    ds_read2_b64 v[116:119], v170 offset0:12 offset1:10
    ds_read2_b64 v[120:123], v171 offset0:12 offset1:10
    ds_read2_b64 v[124:127], v172 offset0:12 offset1:10
    ds_read2_b64 v[128:131], v173 offset0:12 offset1:10
    ds_read2_b32 v[132:133], v174 offset0:24 offset1:20
    ds_read2_b64 v[134:137], v170 offset0:8 offset1:6
    ds_read2_b64 v[138:141], v171 offset0:8 offset1:6
    ds_read2_b64 v[142:145], v172 offset0:8 offset1:6
    ds_read2_b64 v[146:149], v173 offset0:8 offset1:6
    ds_read2_b32 v[150:151], v174 offset0:16 offset1:12
    ds_read2_b64 v[152:155], v170 offset0:4 offset1:2
    v_mfma_f32_16x16x32_bf16 v[60:63], a[208:211], a[12:15], v[60:63]
    ds_read_b128 a[208:211], v243 offset:29696
    s_waitcnt lgkmcnt(8)
    v_mfma_f32_16x16x32_bf16 v[64:67], a[212:215], a[12:15], v[64:67]
    buffer_load_dwordx4 a[52:55], v191, s[20:23], s53 offen offset:1024 sc1
    s_add_u32 s53, s53, 8192
    v_mfma_f32_16x16x32_bf16 v[28:31], a[212:215], a[8:11], v[28:31]
    ds_read_b128 a[212:215], v243 offset:30720
    s_waitcnt lgkmcnt(8)
    v_mfma_f32_16x16x32_bf16 v[32:35], a[216:219], a[8:11], v[32:35]
    ds_read2_b64 v[156:159], v171 offset0:4 offset1:2
    ds_read2_b64 v[160:163], v172 offset0:4 offset1:2
    ds_read2_b64 v[164:167], v173 offset0:4 offset1:2
    ds_read2_b32 v[168:169], v174 offset0:8 offset1:4
    s_mov_b32 s84, 0x05040100
    s_mov_b32 s85, 0x07060302
    s_waitcnt lgkmcnt(0)
    v_perm_b32 v94, v100, v98, s84
    v_perm_b32 v95, v100, v98, s85
    v_perm_b32 v96, v101, v99, s84
    v_perm_b32 v97, v101, v99, s85
    v_perm_b32 v98, v104, v102, s84
    v_perm_b32 v99, v104, v102, s85
    v_perm_b32 v100, v105, v103, s84
    v_perm_b32 v101, v105, v103, s85
    v_perm_b32 v102, v108, v106, s84
    v_mfma_f32_16x16x32_bf16 v[68:71], a[216:219], a[12:15], v[68:71]
    ds_read_b128 a[216:219], v243 offset:31744
    s_waitcnt lgkmcnt(8)
    v_mfma_f32_16x16x32_bf16 v[72:75], a[220:223], a[12:15], v[72:75]
    buffer_load_dwordx4 a[192:195], v191, s[20:23], s54 offen offset:0 sc1
    v_mfma_f32_16x16x32_bf16 v[36:39], a[220:223], a[8:11], v[36:39]
    ds_read_b128 a[220:223], v243 offset:32768
    s_waitcnt lgkmcnt(8)
    v_mfma_f32_16x16x32_bf16 v[40:43], a[224:227], a[8:11], v[40:43]
    v_perm_b32 v103, v108, v106, s85
    v_perm_b32 v104, v109, v107, s84
    v_perm_b32 v105, v109, v107, s85
    v_perm_b32 v106, v112, v110, s84
    v_perm_b32 v107, v112, v110, s85
    v_perm_b32 v108, v113, v111, s84
    v_perm_b32 v109, v113, v111, s85
    v_perm_b32 v110, v115, v114, s84
    v_perm_b32 v111, v115, v114, s85
    v_perm_b32 v112, v118, v116, s84
    v_perm_b32 v113, v118, v116, s85
    v_perm_b32 v114, v119, v117, s84
    v_perm_b32 v115, v119, v117, s85
    v_perm_b32 v116, v122, v120, s84
    v_perm_b32 v117, v122, v120, s85
    v_perm_b32 v118, v123, v121, s84
    v_mfma_f32_16x16x32_bf16 v[76:79], a[224:227], a[12:15], v[76:79]
    ds_read_b128 a[224:227], v243 offset:33792
    s_waitcnt lgkmcnt(8)
    v_mfma_f32_16x16x32_bf16 v[80:83], a[228:231], a[12:15], v[80:83]
    buffer_load_dwordx4 a[196:199], v191, s[20:23], s54 offen offset:1024 sc1
    s_add_u32 s54, s54, 8192
    v_mfma_f32_16x16x32_bf16 v[44:47], a[228:231], a[8:11], v[44:47]
    ds_read_b128 a[228:231], v243 offset:34816
    s_waitcnt lgkmcnt(8)
    v_mfma_f32_16x16x32_bf16 v[48:51], a[232:235], a[8:11], v[48:51]
    v_perm_b32 v119, v123, v121, s85
    v_perm_b32 v120, v126, v124, s84
    v_perm_b32 v121, v126, v124, s85
    v_perm_b32 v122, v127, v125, s84
    v_perm_b32 v123, v127, v125, s85
    v_perm_b32 v124, v130, v128, s84
    v_perm_b32 v125, v130, v128, s85
    v_perm_b32 v126, v131, v129, s84
    v_perm_b32 v127, v131, v129, s85
    v_perm_b32 v128, v133, v132, s84
    v_perm_b32 v129, v133, v132, s85
    v_perm_b32 v130, v136, v134, s84
    v_perm_b32 v131, v136, v134, s85
    v_perm_b32 v132, v137, v135, s84
    v_perm_b32 v133, v137, v135, s85
    v_perm_b32 v134, v140, v138, s84
    v_mfma_f32_16x16x32_bf16 v[84:87], a[232:235], a[12:15], v[84:87]
    ds_read_b128 a[232:235], v243 offset:35840
    s_waitcnt vmcnt(52)
    s_barrier
    s_waitcnt lgkmcnt(8)
    v_mfma_f32_16x16x32_bf16 v[16:19], a[200:203], a[152:155], v[16:19]
    s_add_u32 m0, s52, 0
    s_nop 0
    buffer_load_dwordx4 v191, s[24:27], s55 offen sc1 lds
    v_mfma_f32_16x16x32_bf16 v[52:55], a[200:203], a[156:159], v[52:55]
    ds_read_b128 a[200:203], v243 offset:36864
    s_waitcnt lgkmcnt(8)
    v_mfma_f32_16x16x32_bf16 v[56:59], a[204:207], a[156:159], v[56:59]
    v_perm_b32 v135, v140, v138, s85
    v_perm_b32 v136, v141, v139, s84
    v_perm_b32 v137, v141, v139, s85
    v_perm_b32 v138, v144, v142, s84
    v_perm_b32 v139, v144, v142, s85
    v_perm_b32 v140, v145, v143, s84
    v_perm_b32 v141, v145, v143, s85
    v_perm_b32 v142, v148, v146, s84
    v_perm_b32 v143, v148, v146, s85
    v_perm_b32 v144, v149, v147, s84
    v_perm_b32 v145, v149, v147, s85
    v_perm_b32 v146, v151, v150, s84
    v_perm_b32 v147, v151, v150, s85
    v_perm_b32 v148, v154, v152, s84
    v_perm_b32 v149, v154, v152, s85
    v_perm_b32 v150, v155, v153, s84
    v_mfma_f32_16x16x32_bf16 v[20:23], a[204:207], a[152:155], v[20:23]
    ds_read_b128 a[204:207], v243 offset:37888
    s_waitcnt lgkmcnt(8)
    v_mfma_f32_16x16x32_bf16 v[24:27], a[208:211], a[152:155], v[24:27]
    buffer_load_dwordx4 v191, s[24:27], s55 offen offset:1024 sc1 lds
    v_mfma_f32_16x16x32_bf16 v[60:63], a[208:211], a[156:159], v[60:63]
    ds_read_b128 a[208:211], v243 offset:38912
    s_waitcnt lgkmcnt(8)
    v_mfma_f32_16x16x32_bf16 v[64:67], a[212:215], a[156:159], v[64:67]
    v_perm_b32 v151, v155, v153, s85
    v_perm_b32 v152, v158, v156, s84
    v_perm_b32 v153, v158, v156, s85
    v_perm_b32 v154, v159, v157, s84
    v_perm_b32 v155, v159, v157, s85
    v_perm_b32 v156, v162, v160, s84
    v_perm_b32 v157, v162, v160, s85
    v_perm_b32 v158, v163, v161, s84
    v_perm_b32 v159, v163, v161, s85
    v_perm_b32 v160, v166, v164, s84
    v_perm_b32 v161, v166, v164, s85
    v_perm_b32 v162, v167, v165, s84
    v_perm_b32 v163, v167, v165, s85
    v_perm_b32 v164, v169, v168, s84
    v_perm_b32 v165, v169, v168, s85
    v_dot2_f32_bf16 v208, v94, v226, 0
    v_dot2_f32_bf16 v209, v95, v226, 0
    v_dot2_f32_bf16 v210, v96, v226, 0
    v_dot2_f32_bf16 v211, v97, v226, 0
    v_dot2_f32_bf16 v212, v98, v226, 0
    v_dot2_f32_bf16 v213, v99, v226, 0
    v_dot2_f32_bf16 v214, v100, v226, 0
    v_dot2_f32_bf16 v215, v101, v226, 0
    v_dot2_f32_bf16 v216, v102, v226, 0
    v_dot2_f32_bf16 v217, v103, v226, 0
    v_dot2_f32_bf16 v230, v104, v226, 0
    v_dot2_f32_bf16 v231, v105, v226, 0
    v_dot2_f32_bf16 v232, v106, v226, 0
    v_dot2_f32_bf16 v233, v107, v226, 0
    v_dot2_f32_bf16 v234, v108, v226, 0
    v_dot2_f32_bf16 v235, v109, v226, 0
    v_dot2_f32_bf16 v236, v110, v226, 0
    v_dot2_f32_bf16 v237, v111, v226, 0
    v_dot2_f32_bf16 v208, v112, v227, v208
    v_dot2_f32_bf16 v209, v113, v227, v209
    v_dot2_f32_bf16 v210, v114, v227, v210
    v_dot2_f32_bf16 v211, v115, v227, v211
    v_dot2_f32_bf16 v212, v116, v227, v212
    v_dot2_f32_bf16 v213, v117, v227, v213
    v_dot2_f32_bf16 v214, v118, v227, v214
    v_dot2_f32_bf16 v215, v119, v227, v215
    v_dot2_f32_bf16 v216, v120, v227, v216
    v_dot2_f32_bf16 v217, v121, v227, v217
    v_dot2_f32_bf16 v230, v122, v227, v230
    v_dot2_f32_bf16 v231, v123, v227, v231
    v_dot2_f32_bf16 v232, v124, v227, v232
    v_dot2_f32_bf16 v233, v125, v227, v233
    v_dot2_f32_bf16 v234, v126, v227, v234
    v_dot2_f32_bf16 v235, v127, v227, v235
    v_dot2_f32_bf16 v236, v128, v227, v236
    v_dot2_f32_bf16 v237, v129, v227, v237
    v_mfma_f32_16x16x32_bf16 v[28:31], a[212:215], a[152:155], v[28:31]
    ds_read_b128 a[212:215], v243 offset:39936
    s_waitcnt lgkmcnt(8)
    v_mfma_f32_16x16x32_bf16 v[32:35], a[216:219], a[152:155], v[32:35]
    buffer_load_dwordx4 v191, s[24:27], s55 offen offset:2048 sc1 lds
    v_mfma_f32_16x16x32_bf16 v[68:71], a[216:219], a[156:159], v[68:71]
    ds_read_b128 a[216:219], v243 offset:40960
    s_waitcnt lgkmcnt(8)
    v_mfma_f32_16x16x32_bf16 v[72:75], a[220:223], a[156:159], v[72:75]
    v_mfma_f32_16x16x32_bf16 v[36:39], a[220:223], a[152:155], v[36:39]
    ds_read_b128 a[220:223], v243 offset:41984
    s_waitcnt lgkmcnt(8)
    v_mfma_f32_16x16x32_bf16 v[40:43], a[224:227], a[152:155], v[40:43]
    buffer_load_dwordx4 v191, s[24:27], s55 offen offset:3072 sc1 lds
    v_mfma_f32_16x16x32_bf16 v[76:79], a[224:227], a[156:159], v[76:79]
    ds_read_b128 a[224:227], v243 offset:43008
    s_waitcnt lgkmcnt(8)
    v_mfma_f32_16x16x32_bf16 v[80:83], a[228:231], a[156:159], v[80:83]
    v_mfma_f32_16x16x32_bf16 v[44:47], a[228:231], a[152:155], v[44:47]
    ds_read_b128 a[228:231], v243 offset:44032
    s_waitcnt lgkmcnt(8)
    v_mfma_f32_16x16x32_bf16 v[48:51], a[232:235], a[152:155], v[48:51]
    s_add_u32 m0, s52, 4096
    s_add_u32 s38, s55, 4096
    s_mov_b32 exec_hi, 0
    buffer_load_dwordx4 v191, s[24:27], s38 offen sc1 lds
    s_mov_b32 exec_hi, -1
    s_add_u32 s55, s55, 73728
    v_mfma_f32_16x16x32_bf16 v[84:87], a[232:235], a[156:159], v[84:87]
    ds_read_b128 a[232:235], v243 offset:45056
    s_waitcnt vmcnt(53)
    s_waitcnt lgkmcnt(8)
    v_mfma_f32_16x16x32_bf16 v[16:19], a[200:203], a[16:19], v[16:19]
    v_dot2_f32_bf16 v208, v130, v228, v208
    v_dot2_f32_bf16 v209, v131, v228, v209
    v_dot2_f32_bf16 v210, v132, v228, v210
    v_dot2_f32_bf16 v211, v133, v228, v211
    v_dot2_f32_bf16 v212, v134, v228, v212
    v_dot2_f32_bf16 v213, v135, v228, v213
    v_dot2_f32_bf16 v214, v136, v228, v214
    v_dot2_f32_bf16 v215, v137, v228, v215
    v_dot2_f32_bf16 v216, v138, v228, v216
    v_dot2_f32_bf16 v217, v139, v228, v217
    v_dot2_f32_bf16 v230, v140, v228, v230
    v_dot2_f32_bf16 v231, v141, v228, v231
    v_dot2_f32_bf16 v232, v142, v228, v232
    v_dot2_f32_bf16 v233, v143, v228, v233
    v_dot2_f32_bf16 v234, v144, v228, v234
    v_dot2_f32_bf16 v235, v145, v228, v235
    v_dot2_f32_bf16 v236, v146, v228, v236
    v_dot2_f32_bf16 v237, v147, v228, v237
    v_dot2_f32_bf16 v208, v148, v229, v208
    v_dot2_f32_bf16 v209, v149, v229, v209
    v_dot2_f32_bf16 v210, v150, v229, v210
    v_dot2_f32_bf16 v211, v151, v229, v211
    v_dot2_f32_bf16 v212, v152, v229, v212
    v_dot2_f32_bf16 v213, v153, v229, v213
    v_dot2_f32_bf16 v214, v154, v229, v214
    v_dot2_f32_bf16 v215, v155, v229, v215
    v_dot2_f32_bf16 v216, v156, v229, v216
    v_dot2_f32_bf16 v217, v157, v229, v217
    v_dot2_f32_bf16 v230, v158, v229, v230
    v_dot2_f32_bf16 v231, v159, v229, v231
    v_dot2_f32_bf16 v232, v160, v229, v232
    v_dot2_f32_bf16 v233, v161, v229, v233
    v_dot2_f32_bf16 v234, v162, v229, v234
    v_dot2_f32_bf16 v235, v163, v229, v235
    v_dot2_f32_bf16 v236, v164, v229, v236
    v_dot2_f32_bf16 v237, v165, v229, v237
    v_mfma_f32_16x16x32_bf16 v[52:55], a[200:203], a[20:23], v[52:55]
    ds_read_b128 a[200:203], v243 offset:46080
    s_waitcnt lgkmcnt(8)
    v_mfma_f32_16x16x32_bf16 v[56:59], a[204:207], a[20:23], v[56:59]
    buffer_load_dwordx4 a[0:3], v191, s[20:23], s53 offen offset:0 sc1
    v_mfma_f32_16x16x32_bf16 v[20:23], a[204:207], a[16:19], v[20:23]
    ds_read_b128 a[204:207], v243 offset:47104
    s_waitcnt lgkmcnt(8)
    v_mfma_f32_16x16x32_bf16 v[24:27], a[208:211], a[16:19], v[24:27]
    v_mfma_f32_16x16x32_bf16 v[60:63], a[208:211], a[20:23], v[60:63]
    ds_read_b128 a[208:211], v243 offset:48128
    s_waitcnt lgkmcnt(8)
    v_mfma_f32_16x16x32_bf16 v[64:67], a[212:215], a[20:23], v[64:67]
    buffer_load_dwordx4 a[4:7], v191, s[20:23], s53 offen offset:1024 sc1
    s_add_u32 s53, s53, 8192
    v_mfma_f32_16x16x32_bf16 v[28:31], a[212:215], a[16:19], v[28:31]
    ds_read_b128 a[212:215], v243 offset:49152
    s_waitcnt lgkmcnt(8)
    v_mfma_f32_16x16x32_bf16 v[32:35], a[216:219], a[16:19], v[32:35]
    s_nop 3
    v_cvt_pk_bf16_f32 v208, v208, v209
    v_cvt_pk_bf16_f32 v209, v210, v211
    ds_write_b64 v192, v[208:209]
    v_cvt_pk_bf16_f32 v212, v212, v213
    v_cvt_pk_bf16_f32 v213, v214, v215
    ds_write_b64 v193, v[212:213]
    v_cvt_pk_bf16_f32 v216, v216, v217
    v_cvt_pk_bf16_f32 v217, v230, v231
    v_mfma_f32_16x16x32_bf16 v[68:71], a[216:219], a[20:23], v[68:71]
    ds_read_b128 a[216:219], v243 offset:50176
    s_waitcnt lgkmcnt(8)
    v_mfma_f32_16x16x32_bf16 v[72:75], a[220:223], a[20:23], v[72:75]
    buffer_load_dwordx4 a[144:147], v191, s[20:23], s54 offen offset:0 sc1
    v_mfma_f32_16x16x32_bf16 v[36:39], a[220:223], a[16:19], v[36:39]
    ds_read_b128 a[220:223], v243 offset:51200
    s_waitcnt lgkmcnt(8)
    v_mfma_f32_16x16x32_bf16 v[40:43], a[224:227], a[16:19], v[40:43]
    ds_write_b64 v194, v[216:217]
    v_cvt_pk_bf16_f32 v232, v232, v233
    v_cvt_pk_bf16_f32 v233, v234, v235
    ds_write_b64 v195, v[232:233]
    v_cvt_pk_bf16_f32 v236, v236, v237
    ds_write_b32 v196, v236
    s_lshr_b32 s84, s83, 3
    s_mul_i32 s84, s84, 162
    s_add_u32 s84, s84, 144
    s_lshl_b32 s84, s84, 12
    s_bfe_u32 s85, s83, 0x20001
    s_lshl_b32 s85, s85, 10
    s_add_u32 s84, s84, s85
    s_and_b32 s85, s83, 1
    s_lshl_b32 s85, s85, 7
    s_add_u32 s84, s84, s85
    v_mfma_f32_16x16x32_bf16 v[76:79], a[224:227], a[20:23], v[76:79]
    ds_read_b128 a[224:227], v243 offset:52224
    s_waitcnt lgkmcnt(8)
    v_mfma_f32_16x16x32_bf16 v[80:83], a[228:231], a[20:23], v[80:83]
    buffer_load_dwordx4 a[148:151], v191, s[20:23], s54 offen offset:1024 sc1
    s_add_u32 s54, s54, 8192
    v_mfma_f32_16x16x32_bf16 v[44:47], a[228:231], a[16:19], v[44:47]
    ds_read_b128 a[228:231], v243 offset:53248
    s_waitcnt lgkmcnt(8)
    v_mfma_f32_16x16x32_bf16 v[48:51], a[232:235], a[16:19], v[48:51]
    s_mul_i32 s85, s86, 18
    v_and_b32 v12, 63, v255
    v_lshlrev_b32 v230, 4, v12
    v_add_u32 v230, s82, v230
    v_lshrrev_b32 v13, 3, v12
    v_add_u32 v13, s85, v13
    v_and_b32 v12, 7, v12
    v_lshlrev_b32 v12, 4, v12
    v_and_b32 v14, 3, v13
    v_lshl_add_u32 v12, v14, 8, v12
    v_lshrrev_b32 v13, 2, v13
    v_lshl_add_u32 v233, v13, 12, v12
    s_waitcnt lgkmcnt(0)
    ds_read_b128 v[208:211], v230 offset:0
    ds_read_b128 v[212:215], v230 offset:1024
    ds_read_b128 v[216:219], v230 offset:2048
    v_mfma_f32_16x16x32_bf16 v[84:87], a[232:235], a[20:23], v[84:87]
    ds_read_b128 a[232:235], v243 offset:54272
    s_waitcnt vmcnt(52)
    s_barrier
    s_waitcnt lgkmcnt(8)
    v_mfma_f32_16x16x32_bf16 v[16:19], a[200:203], a[160:163], v[16:19]
    s_add_u32 m0, s52, 18432
    s_nop 0
    buffer_load_dwordx4 v191, s[24:27], s55 offen sc1 lds
    v_mfma_f32_16x16x32_bf16 v[52:55], a[200:203], a[164:167], v[52:55]
    ds_read_b128 a[200:203], v244 offset:0
    s_waitcnt lgkmcnt(8)
    v_mfma_f32_16x16x32_bf16 v[56:59], a[204:207], a[164:167], v[56:59]
    s_add_u32 s85, s84, 8192
    s_add_u32 s87, s84, 16384
    s_waitcnt lgkmcnt(0)
    s_mov_b64 exec, 0xffff
    buffer_store_dwordx4 v[216:219], v233, s[12:15], s87 offen sc1
    s_mov_b64 exec, -1
    buffer_store_dwordx4 v[208:211], v233, s[12:15], s84 offen sc1
    buffer_store_dwordx4 v[212:215], v233, s[12:15], s85 offen sc1
    v_mfma_f32_16x16x32_bf16 v[20:23], a[204:207], a[160:163], v[20:23]
    ds_read_b128 a[204:207], v244 offset:1024
    s_waitcnt lgkmcnt(8)
    v_mfma_f32_16x16x32_bf16 v[24:27], a[208:211], a[160:163], v[24:27]
    buffer_load_dwordx4 v191, s[24:27], s55 offen offset:1024 sc1 lds
    v_mfma_f32_16x16x32_bf16 v[60:63], a[208:211], a[164:167], v[60:63]
    ds_read_b128 a[208:211], v244 offset:2048
    s_waitcnt lgkmcnt(8)
    v_mfma_f32_16x16x32_bf16 v[64:67], a[212:215], a[164:167], v[64:67]
    v_mfma_f32_16x16x32_bf16 v[28:31], a[212:215], a[160:163], v[28:31]
    ds_read_b128 a[212:215], v244 offset:3072
    s_waitcnt lgkmcnt(8)
    v_mfma_f32_16x16x32_bf16 v[32:35], a[216:219], a[160:163], v[32:35]
    buffer_load_dwordx4 v191, s[24:27], s55 offen offset:2048 sc1 lds
    v_mfma_f32_16x16x32_bf16 v[68:71], a[216:219], a[164:167], v[68:71]
    ds_read_b128 a[216:219], v244 offset:4096
    s_waitcnt lgkmcnt(8)
    v_mfma_f32_16x16x32_bf16 v[72:75], a[220:223], a[164:167], v[72:75]
    v_mfma_f32_16x16x32_bf16 v[36:39], a[220:223], a[160:163], v[36:39]
    ds_read_b128 a[220:223], v244 offset:5120
    s_waitcnt lgkmcnt(8)
    v_mfma_f32_16x16x32_bf16 v[40:43], a[224:227], a[160:163], v[40:43]
    buffer_load_dwordx4 v191, s[24:27], s55 offen offset:3072 sc1 lds
    v_mfma_f32_16x16x32_bf16 v[76:79], a[224:227], a[164:167], v[76:79]
    ds_read_b128 a[224:227], v244 offset:6144
    s_waitcnt lgkmcnt(8)
    v_mfma_f32_16x16x32_bf16 v[80:83], a[228:231], a[164:167], v[80:83]
    v_mfma_f32_16x16x32_bf16 v[44:47], a[228:231], a[160:163], v[44:47]
    ds_read_b128 a[228:231], v244 offset:7168
    s_waitcnt lgkmcnt(8)
    v_mfma_f32_16x16x32_bf16 v[48:51], a[232:235], a[160:163], v[48:51]
    s_add_u32 m0, s52, 22528
    s_add_u32 s38, s55, 4096
    s_mov_b32 exec_hi, 0
    buffer_load_dwordx4 v191, s[24:27], s38 offen sc1 lds
    s_mov_b32 exec_hi, -1
    s_add_u32 s55, s55, 73728
    v_mfma_f32_16x16x32_bf16 v[84:87], a[232:235], a[164:167], v[84:87]
    ds_read_b128 a[232:235], v244 offset:8192
    s_waitcnt vmcnt(56)
    s_waitcnt lgkmcnt(8)
    v_mfma_f32_16x16x32_bf16 v[16:19], a[200:203], a[24:27], v[16:19]
    v_mfma_f32_16x16x32_bf16 v[52:55], a[200:203], a[28:31], v[52:55]
    ds_read_b128 a[200:203], v244 offset:9216
    s_waitcnt lgkmcnt(8)
    v_mfma_f32_16x16x32_bf16 v[56:59], a[204:207], a[28:31], v[56:59]
    buffer_load_dwordx4 a[8:11], v191, s[20:23], s53 offen offset:0 sc1
    v_mfma_f32_16x16x32_bf16 v[20:23], a[204:207], a[24:27], v[20:23]
    ds_read_b128 a[204:207], v244 offset:10240
    s_waitcnt lgkmcnt(8)
    v_mfma_f32_16x16x32_bf16 v[24:27], a[208:211], a[24:27], v[24:27]
    v_mfma_f32_16x16x32_bf16 v[60:63], a[208:211], a[28:31], v[60:63]
    ds_read_b128 a[208:211], v244 offset:11264
    s_waitcnt lgkmcnt(8)
    v_mfma_f32_16x16x32_bf16 v[64:67], a[212:215], a[28:31], v[64:67]
    buffer_load_dwordx4 a[12:15], v191, s[20:23], s53 offen offset:1024 sc1
    s_add_u32 s53, s53, 8192
    v_mfma_f32_16x16x32_bf16 v[28:31], a[212:215], a[24:27], v[28:31]
    ds_read_b128 a[212:215], v244 offset:12288
    s_waitcnt lgkmcnt(8)
    v_mfma_f32_16x16x32_bf16 v[32:35], a[216:219], a[24:27], v[32:35]
    s_waitcnt vmcnt(6)
    s_mov_b64 exec, 0xffff
    buffer_store_dwordx2 v[92:93], v251, s[88:91], 0 offen sc0 sc1
    s_mov_b64 exec, -1
    v_mfma_f32_16x16x32_bf16 v[68:71], a[216:219], a[28:31], v[68:71]
    ds_read_b128 a[216:219], v244 offset:13312
    s_waitcnt lgkmcnt(8)
    v_mfma_f32_16x16x32_bf16 v[72:75], a[220:223], a[28:31], v[72:75]
    buffer_load_dwordx4 a[152:155], v191, s[20:23], s54 offen offset:0 sc1
    v_mfma_f32_16x16x32_bf16 v[36:39], a[220:223], a[24:27], v[36:39]
    ds_read_b128 a[220:223], v244 offset:14336
    s_waitcnt lgkmcnt(8)
    v_mfma_f32_16x16x32_bf16 v[40:43], a[224:227], a[24:27], v[40:43]
    v_mfma_f32_16x16x32_bf16 v[76:79], a[224:227], a[28:31], v[76:79]
    ds_read_b128 a[224:227], v244 offset:15360
    s_waitcnt lgkmcnt(8)
    v_mfma_f32_16x16x32_bf16 v[80:83], a[228:231], a[28:31], v[80:83]
    buffer_load_dwordx4 a[156:159], v191, s[20:23], s54 offen offset:1024 sc1
    s_add_u32 s54, s54, 8192
    v_mfma_f32_16x16x32_bf16 v[44:47], a[228:231], a[24:27], v[44:47]
    ds_read_b128 a[228:231], v244 offset:16384
    s_waitcnt lgkmcnt(8)
    v_mfma_f32_16x16x32_bf16 v[48:51], a[232:235], a[24:27], v[48:51]
    v_mfma_f32_16x16x32_bf16 v[84:87], a[232:235], a[28:31], v[84:87]
    ds_read_b128 a[232:235], v244 offset:17408
    s_waitcnt vmcnt(49)
    s_barrier
    s_waitcnt lgkmcnt(8)
    v_mfma_f32_16x16x32_bf16 v[16:19], a[200:203], a[168:171], v[16:19]
    s_add_u32 m0, s52, 36864
    s_nop 0
    buffer_load_dwordx4 v191, s[24:27], s55 offen sc1 lds
    v_mfma_f32_16x16x32_bf16 v[52:55], a[200:203], a[172:175], v[52:55]
    ds_read_b128 a[200:203], v245 offset:0
    s_waitcnt lgkmcnt(8)
    v_mfma_f32_16x16x32_bf16 v[56:59], a[204:207], a[172:175], v[56:59]
    v_mfma_f32_16x16x32_bf16 v[20:23], a[204:207], a[168:171], v[20:23]
    ds_read_b128 a[204:207], v245 offset:1024
    s_waitcnt lgkmcnt(8)
    v_mfma_f32_16x16x32_bf16 v[24:27], a[208:211], a[168:171], v[24:27]
    buffer_load_dwordx4 v191, s[24:27], s55 offen offset:1024 sc1 lds
    v_mfma_f32_16x16x32_bf16 v[60:63], a[208:211], a[172:175], v[60:63]
    ds_read_b128 a[208:211], v245 offset:2048
    s_waitcnt lgkmcnt(8)
    v_mfma_f32_16x16x32_bf16 v[64:67], a[212:215], a[172:175], v[64:67]
    v_mfma_f32_16x16x32_bf16 v[28:31], a[212:215], a[168:171], v[28:31]
    ds_read_b128 a[212:215], v245 offset:3072
    s_waitcnt lgkmcnt(8)
    v_mfma_f32_16x16x32_bf16 v[32:35], a[216:219], a[168:171], v[32:35]
    buffer_load_dwordx4 v191, s[24:27], s55 offen offset:2048 sc1 lds
    v_mfma_f32_16x16x32_bf16 v[68:71], a[216:219], a[172:175], v[68:71]
    ds_read_b128 a[216:219], v245 offset:4096
    s_waitcnt lgkmcnt(8)
    v_mfma_f32_16x16x32_bf16 v[72:75], a[220:223], a[172:175], v[72:75]
    v_mfma_f32_16x16x32_bf16 v[36:39], a[220:223], a[168:171], v[36:39]
    ds_read_b128 a[220:223], v245 offset:5120
    s_waitcnt lgkmcnt(8)
    v_mfma_f32_16x16x32_bf16 v[40:43], a[224:227], a[168:171], v[40:43]
    buffer_load_dwordx4 v191, s[24:27], s55 offen offset:3072 sc1 lds
    v_mfma_f32_16x16x32_bf16 v[76:79], a[224:227], a[172:175], v[76:79]
    ds_read_b128 a[224:227], v245 offset:6144
    s_waitcnt lgkmcnt(8)
    v_mfma_f32_16x16x32_bf16 v[80:83], a[228:231], a[172:175], v[80:83]
    v_mfma_f32_16x16x32_bf16 v[44:47], a[228:231], a[168:171], v[44:47]
    ds_read_b128 a[228:231], v245 offset:7168
    s_waitcnt lgkmcnt(8)
    v_mfma_f32_16x16x32_bf16 v[48:51], a[232:235], a[168:171], v[48:51]
    s_add_u32 m0, s52, 40960
    s_add_u32 s38, s55, 4096
    s_mov_b32 exec_hi, 0
    buffer_load_dwordx4 v191, s[24:27], s38 offen sc1 lds
    s_mov_b32 exec_hi, -1
    s_add_u32 s55, s55, 73728
    v_mfma_f32_16x16x32_bf16 v[84:87], a[232:235], a[172:175], v[84:87]
    ds_read_b128 a[232:235], v245 offset:8192
    s_waitcnt vmcnt(50)
    s_waitcnt lgkmcnt(8)
    v_mfma_f32_16x16x32_bf16 v[16:19], a[200:203], a[32:35], v[16:19]
    v_mfma_f32_16x16x32_bf16 v[52:55], a[200:203], a[36:39], v[52:55]
    ds_read_b128 a[200:203], v245 offset:9216
    s_waitcnt lgkmcnt(8)
    v_mfma_f32_16x16x32_bf16 v[56:59], a[204:207], a[36:39], v[56:59]
    buffer_load_dwordx4 a[16:19], v191, s[20:23], s53 offen offset:0 sc1
    v_mfma_f32_16x16x32_bf16 v[20:23], a[204:207], a[32:35], v[20:23]
    ds_read_b128 a[204:207], v245 offset:10240
    s_waitcnt lgkmcnt(8)
    v_mfma_f32_16x16x32_bf16 v[24:27], a[208:211], a[32:35], v[24:27]
    v_mfma_f32_16x16x32_bf16 v[60:63], a[208:211], a[36:39], v[60:63]
    ds_read_b128 a[208:211], v245 offset:11264
    s_waitcnt lgkmcnt(8)
    v_mfma_f32_16x16x32_bf16 v[64:67], a[212:215], a[36:39], v[64:67]
    buffer_load_dwordx4 a[20:23], v191, s[20:23], s53 offen offset:1024 sc1
    s_add_u32 s53, s53, 8192
    v_mfma_f32_16x16x32_bf16 v[28:31], a[212:215], a[32:35], v[28:31]
    ds_read_b128 a[212:215], v245 offset:12288
    s_waitcnt lgkmcnt(8)
    v_mfma_f32_16x16x32_bf16 v[32:35], a[216:219], a[32:35], v[32:35]
    v_mfma_f32_16x16x32_bf16 v[68:71], a[216:219], a[36:39], v[68:71]
    ds_read_b128 a[216:219], v245 offset:13312
    s_waitcnt lgkmcnt(8)
    v_mfma_f32_16x16x32_bf16 v[72:75], a[220:223], a[36:39], v[72:75]
    buffer_load_dwordx4 a[160:163], v191, s[20:23], s54 offen offset:0 sc1
    v_mfma_f32_16x16x32_bf16 v[36:39], a[220:223], a[32:35], v[36:39]
    ds_read_b128 a[220:223], v245 offset:14336
    s_waitcnt lgkmcnt(8)
    v_mfma_f32_16x16x32_bf16 v[40:43], a[224:227], a[32:35], v[40:43]
    v_mfma_f32_16x16x32_bf16 v[76:79], a[224:227], a[36:39], v[76:79]
    ds_read_b128 a[224:227], v245 offset:15360
    s_waitcnt lgkmcnt(8)
    v_mfma_f32_16x16x32_bf16 v[80:83], a[228:231], a[36:39], v[80:83]
    buffer_load_dwordx4 a[164:167], v191, s[20:23], s54 offen offset:1024 sc1
    s_add_u32 s54, s54, 8192
    v_mfma_f32_16x16x32_bf16 v[44:47], a[228:231], a[32:35], v[44:47]
    ds_read_b128 a[228:231], v245 offset:16384
    s_waitcnt lgkmcnt(8)
    v_mfma_f32_16x16x32_bf16 v[48:51], a[232:235], a[32:35], v[48:51]
    v_mfma_f32_16x16x32_bf16 v[84:87], a[232:235], a[36:39], v[84:87]
    ds_read_b128 a[232:235], v245 offset:17408
    s_waitcnt vmcnt(44)
    s_barrier
    s_waitcnt lgkmcnt(8)
    v_mfma_f32_16x16x32_bf16 v[16:19], a[200:203], a[176:179], v[16:19]
    s_add_u32 m0, s52, 55296
    s_nop 0
    buffer_load_dwordx4 v191, s[24:27], s55 offen sc1 lds
    v_mfma_f32_16x16x32_bf16 v[52:55], a[200:203], a[180:183], v[52:55]
    ds_read_b128 a[200:203], v244 offset:18432
    s_waitcnt lgkmcnt(8)
    v_mfma_f32_16x16x32_bf16 v[56:59], a[204:207], a[180:183], v[56:59]
    v_mfma_f32_16x16x32_bf16 v[20:23], a[204:207], a[176:179], v[20:23]
    ds_read_b128 a[204:207], v244 offset:19456
    s_waitcnt lgkmcnt(8)
    v_mfma_f32_16x16x32_bf16 v[24:27], a[208:211], a[176:179], v[24:27]
    buffer_load_dwordx4 v191, s[24:27], s55 offen offset:1024 sc1 lds
    v_mfma_f32_16x16x32_bf16 v[60:63], a[208:211], a[180:183], v[60:63]
    ds_read_b128 a[208:211], v244 offset:20480
    s_waitcnt lgkmcnt(8)
    v_mfma_f32_16x16x32_bf16 v[64:67], a[212:215], a[180:183], v[64:67]
    v_mfma_f32_16x16x32_bf16 v[28:31], a[212:215], a[176:179], v[28:31]
    ds_read_b128 a[212:215], v244 offset:21504
    s_waitcnt lgkmcnt(8)
    v_mfma_f32_16x16x32_bf16 v[32:35], a[216:219], a[176:179], v[32:35]
    buffer_load_dwordx4 v191, s[24:27], s55 offen offset:2048 sc1 lds
    v_mfma_f32_16x16x32_bf16 v[68:71], a[216:219], a[180:183], v[68:71]
    ds_read_b128 a[216:219], v244 offset:22528
    s_waitcnt lgkmcnt(8)
    v_mfma_f32_16x16x32_bf16 v[72:75], a[220:223], a[180:183], v[72:75]
    v_mfma_f32_16x16x32_bf16 v[36:39], a[220:223], a[176:179], v[36:39]
    ds_read_b128 a[220:223], v244 offset:23552
    s_waitcnt lgkmcnt(8)
    v_mfma_f32_16x16x32_bf16 v[40:43], a[224:227], a[176:179], v[40:43]
    buffer_load_dwordx4 v191, s[24:27], s55 offen offset:3072 sc1 lds
    v_mfma_f32_16x16x32_bf16 v[76:79], a[224:227], a[180:183], v[76:79]
    ds_read_b128 a[224:227], v244 offset:24576
    s_waitcnt lgkmcnt(8)
    v_mfma_f32_16x16x32_bf16 v[80:83], a[228:231], a[180:183], v[80:83]
    v_mfma_f32_16x16x32_bf16 v[44:47], a[228:231], a[176:179], v[44:47]
    ds_read_b128 a[228:231], v244 offset:25600
    s_waitcnt lgkmcnt(8)
    v_mfma_f32_16x16x32_bf16 v[48:51], a[232:235], a[176:179], v[48:51]
    s_add_u32 m0, s52, 59392
    s_add_u32 s38, s55, 4096
    s_mov_b32 exec_hi, 0
    buffer_load_dwordx4 v191, s[24:27], s38 offen sc1 lds
    s_mov_b32 exec_hi, -1
    s_add_u32 s55, s55, 73728
    v_mfma_f32_16x16x32_bf16 v[84:87], a[232:235], a[180:183], v[84:87]
    ds_read_b128 a[232:235], v244 offset:26624
    s_waitcnt vmcnt(45)
    s_waitcnt lgkmcnt(8)
    v_mfma_f32_16x16x32_bf16 v[16:19], a[200:203], a[40:43], v[16:19]
    v_mfma_f32_16x16x32_bf16 v[52:55], a[200:203], a[44:47], v[52:55]
    ds_read_b128 a[200:203], v244 offset:27648
    s_waitcnt lgkmcnt(8)
    v_mfma_f32_16x16x32_bf16 v[56:59], a[204:207], a[44:47], v[56:59]
    buffer_load_dwordx4 a[24:27], v191, s[20:23], s53 offen offset:0 sc1
    v_mfma_f32_16x16x32_bf16 v[20:23], a[204:207], a[40:43], v[20:23]
    ds_read_b128 a[204:207], v244 offset:28672
    s_waitcnt lgkmcnt(8)
    v_mfma_f32_16x16x32_bf16 v[24:27], a[208:211], a[40:43], v[24:27]
    v_mfma_f32_16x16x32_bf16 v[60:63], a[208:211], a[44:47], v[60:63]
    ds_read_b128 a[208:211], v244 offset:29696
    s_waitcnt lgkmcnt(8)
    v_mfma_f32_16x16x32_bf16 v[64:67], a[212:215], a[44:47], v[64:67]
    buffer_load_dwordx4 a[28:31], v191, s[20:23], s53 offen offset:1024 sc1
    s_add_u32 s53, s53, 8192
    v_mfma_f32_16x16x32_bf16 v[28:31], a[212:215], a[40:43], v[28:31]
    ds_read_b128 a[212:215], v244 offset:30720
    s_waitcnt lgkmcnt(8)
    v_mfma_f32_16x16x32_bf16 v[32:35], a[216:219], a[40:43], v[32:35]
    v_mfma_f32_16x16x32_bf16 v[68:71], a[216:219], a[44:47], v[68:71]
    ds_read_b128 a[216:219], v244 offset:31744
    s_waitcnt lgkmcnt(8)
    v_mfma_f32_16x16x32_bf16 v[72:75], a[220:223], a[44:47], v[72:75]
    buffer_load_dwordx4 a[168:171], v191, s[20:23], s54 offen offset:0 sc1
    v_mfma_f32_16x16x32_bf16 v[36:39], a[220:223], a[40:43], v[36:39]
    ds_read_b128 a[220:223], v244 offset:32768
    s_waitcnt lgkmcnt(8)
    v_mfma_f32_16x16x32_bf16 v[40:43], a[224:227], a[40:43], v[40:43]
    v_mfma_f32_16x16x32_bf16 v[76:79], a[224:227], a[44:47], v[76:79]
    ds_read_b128 a[224:227], v244 offset:33792
    s_waitcnt lgkmcnt(8)
    v_mfma_f32_16x16x32_bf16 v[80:83], a[228:231], a[44:47], v[80:83]
    buffer_load_dwordx4 a[172:175], v191, s[20:23], s54 offen offset:1024 sc1
    s_add_u32 s54, s54, 8192
    v_mfma_f32_16x16x32_bf16 v[44:47], a[228:231], a[40:43], v[44:47]
    ds_read_b128 a[228:231], v244 offset:34816
    s_waitcnt lgkmcnt(8)
    v_mfma_f32_16x16x32_bf16 v[48:51], a[232:235], a[40:43], v[48:51]
    v_mfma_f32_16x16x32_bf16 v[84:87], a[232:235], a[44:47], v[84:87]
    ds_read_b128 a[232:235], v244 offset:35840
    s_waitcnt vmcnt(44)
    s_barrier
    s_waitcnt lgkmcnt(8)
    v_mfma_f32_16x16x32_bf16 v[16:19], a[200:203], a[184:187], v[16:19]
    s_add_u32 m0, s39, 110592
    s_nop 0
    buffer_load_dwordx4 v246, s[24:27], s33 offen sc1 lds
    v_mfma_f32_16x16x32_bf16 v[52:55], a[200:203], a[188:191], v[52:55]
    ds_read_b128 a[200:203], v244 offset:36864
    s_waitcnt lgkmcnt(8)
    v_mfma_f32_16x16x32_bf16 v[56:59], a[204:207], a[188:191], v[56:59]
    v_mfma_f32_16x16x32_bf16 v[20:23], a[204:207], a[184:187], v[20:23]
    ds_read_b128 a[204:207], v244 offset:37888
    s_waitcnt lgkmcnt(8)
    v_mfma_f32_16x16x32_bf16 v[24:27], a[208:211], a[184:187], v[24:27]
    s_add_u32 m0, s40, 110592
    s_nop 0
    buffer_load_dwordx4 v247, s[24:27], s33 offen sc1 lds
    v_mfma_f32_16x16x32_bf16 v[60:63], a[208:211], a[188:191], v[60:63]
    ds_read_b128 a[208:211], v244 offset:38912
    s_waitcnt lgkmcnt(8)
    v_mfma_f32_16x16x32_bf16 v[64:67], a[212:215], a[188:191], v[64:67]
    v_mfma_f32_16x16x32_bf16 v[28:31], a[212:215], a[184:187], v[28:31]
    ds_read_b128 a[212:215], v244 offset:39936
    s_waitcnt lgkmcnt(8)
    v_mfma_f32_16x16x32_bf16 v[32:35], a[216:219], a[184:187], v[32:35]
    s_add_u32 m0, s41, 110592
    s_nop 0
    buffer_load_dwordx4 v248, s[24:27], s33 offen sc1 lds
    v_mfma_f32_16x16x32_bf16 v[68:71], a[216:219], a[188:191], v[68:71]
    ds_read_b128 a[216:219], v244 offset:40960
    s_waitcnt lgkmcnt(8)
    v_mfma_f32_16x16x32_bf16 v[72:75], a[220:223], a[188:191], v[72:75]
    v_mfma_f32_16x16x32_bf16 v[36:39], a[220:223], a[184:187], v[36:39]
    ds_read_b128 a[220:223], v244 offset:41984
    s_waitcnt lgkmcnt(8)
    v_mfma_f32_16x16x32_bf16 v[40:43], a[224:227], a[184:187], v[40:43]
    s_add_u32 m0, s56, 110592
    s_nop 0
    buffer_load_dwordx4 v249, s[72:75], s33 offen sc1 lds
    s_add_u32 s33, s33, 36864
    v_mfma_f32_16x16x32_bf16 v[76:79], a[224:227], a[188:191], v[76:79]
    ds_read_b128 a[224:227], v244 offset:43008
    s_waitcnt lgkmcnt(8)
    v_mfma_f32_16x16x32_bf16 v[80:83], a[228:231], a[188:191], v[80:83]
    v_mfma_f32_16x16x32_bf16 v[44:47], a[228:231], a[184:187], v[44:47]
    ds_read_b128 a[228:231], v244 offset:44032
    s_waitcnt lgkmcnt(8)
    v_mfma_f32_16x16x32_bf16 v[48:51], a[232:235], a[184:187], v[48:51]
    v_mfma_f32_16x16x32_bf16 v[84:87], a[232:235], a[188:191], v[84:87]
    ds_read_b128 a[232:235], v244 offset:45056
    s_waitcnt vmcnt(44)
    s_waitcnt lgkmcnt(8)
    v_mfma_f32_16x16x32_bf16 v[16:19], a[200:203], a[48:51], v[16:19]
    v_mfma_f32_16x16x32_bf16 v[52:55], a[200:203], a[52:55], v[52:55]
    ds_read_b128 a[200:203], v244 offset:46080
    s_waitcnt lgkmcnt(8)
    v_mfma_f32_16x16x32_bf16 v[56:59], a[204:207], a[52:55], v[56:59]
    v_mfma_f32_16x16x32_bf16 v[20:23], a[204:207], a[48:51], v[20:23]
    ds_read_b128 a[204:207], v244 offset:47104
    s_waitcnt lgkmcnt(8)
    v_mfma_f32_16x16x32_bf16 v[24:27], a[208:211], a[48:51], v[24:27]
    v_mfma_f32_16x16x32_bf16 v[60:63], a[208:211], a[52:55], v[60:63]
    ds_read_b128 a[208:211], v244 offset:48128
    s_waitcnt lgkmcnt(8)
    v_mfma_f32_16x16x32_bf16 v[64:67], a[212:215], a[52:55], v[64:67]
    v_mfma_f32_16x16x32_bf16 v[28:31], a[212:215], a[48:51], v[28:31]
    ds_read_b128 a[212:215], v244 offset:49152
    s_waitcnt lgkmcnt(8)
    v_mfma_f32_16x16x32_bf16 v[32:35], a[216:219], a[48:51], v[32:35]
    v_mfma_f32_16x16x32_bf16 v[68:71], a[216:219], a[52:55], v[68:71]
    ds_read_b128 a[216:219], v244 offset:50176
    s_waitcnt lgkmcnt(8)
    v_mfma_f32_16x16x32_bf16 v[72:75], a[220:223], a[52:55], v[72:75]
    v_mfma_f32_16x16x32_bf16 v[36:39], a[220:223], a[48:51], v[36:39]
    ds_read_b128 a[220:223], v244 offset:51200
    s_waitcnt lgkmcnt(8)
    v_mfma_f32_16x16x32_bf16 v[40:43], a[224:227], a[48:51], v[40:43]
    v_mfma_f32_16x16x32_bf16 v[76:79], a[224:227], a[52:55], v[76:79]
    ds_read_b128 a[224:227], v244 offset:52224
    s_waitcnt lgkmcnt(8)
    v_mfma_f32_16x16x32_bf16 v[80:83], a[228:231], a[52:55], v[80:83]
    v_mfma_f32_16x16x32_bf16 v[44:47], a[228:231], a[48:51], v[44:47]
    ds_read_b128 a[228:231], v244 offset:53248
    s_waitcnt lgkmcnt(8)
    v_mfma_f32_16x16x32_bf16 v[48:51], a[232:235], a[48:51], v[48:51]
    v_mfma_f32_16x16x32_bf16 v[84:87], a[232:235], a[52:55], v[84:87]
    ds_read_b128 a[232:235], v244 offset:54272
    s_waitcnt vmcnt(39)
    s_barrier
    s_waitcnt lgkmcnt(8)
    v_mfma_f32_16x16x32_bf16 v[16:19], a[200:203], a[192:195], v[16:19]
    s_add_u32 m0, s39, 73728
    s_nop 0
    buffer_load_dwordx4 v246, s[24:27], s33 offen sc1 lds
    v_mfma_f32_16x16x32_bf16 v[52:55], a[200:203], a[196:199], v[52:55]
    ds_read_b128 a[200:203], v243 offset:0
    s_waitcnt lgkmcnt(8)
    v_mfma_f32_16x16x32_bf16 v[56:59], a[204:207], a[196:199], v[56:59]
    v_mfma_f32_16x16x32_bf16 v[20:23], a[204:207], a[192:195], v[20:23]
    ds_read_b128 a[204:207], v243 offset:1024
    s_waitcnt lgkmcnt(8)
    v_mfma_f32_16x16x32_bf16 v[24:27], a[208:211], a[192:195], v[24:27]
    s_add_u32 m0, s40, 73728
    s_nop 0
    buffer_load_dwordx4 v247, s[24:27], s33 offen sc1 lds
    v_mfma_f32_16x16x32_bf16 v[60:63], a[208:211], a[196:199], v[60:63]
    ds_read_b128 a[208:211], v243 offset:2048
    s_waitcnt lgkmcnt(8)
    v_mfma_f32_16x16x32_bf16 v[64:67], a[212:215], a[196:199], v[64:67]
    v_mfma_f32_16x16x32_bf16 v[28:31], a[212:215], a[192:195], v[28:31]
    ds_read_b128 a[212:215], v243 offset:3072
    s_waitcnt lgkmcnt(8)
    v_mfma_f32_16x16x32_bf16 v[32:35], a[216:219], a[192:195], v[32:35]
    s_add_u32 m0, s41, 73728
    s_nop 0
    buffer_load_dwordx4 v248, s[24:27], s33 offen sc1 lds
    v_mfma_f32_16x16x32_bf16 v[68:71], a[216:219], a[196:199], v[68:71]
    ds_read_b128 a[216:219], v243 offset:4096
    s_waitcnt lgkmcnt(8)
    v_mfma_f32_16x16x32_bf16 v[72:75], a[220:223], a[196:199], v[72:75]
    v_mfma_f32_16x16x32_bf16 v[36:39], a[220:223], a[192:195], v[36:39]
    ds_read_b128 a[220:223], v243 offset:5120
    s_waitcnt lgkmcnt(8)
    v_mfma_f32_16x16x32_bf16 v[40:43], a[224:227], a[192:195], v[40:43]
    s_add_u32 m0, s56, 73728
    s_nop 0
    buffer_load_dwordx4 v249, s[72:75], s33 offen sc1 lds
    s_add_u32 s33, s33, 184320
    v_mfma_f32_16x16x32_bf16 v[76:79], a[224:227], a[196:199], v[76:79]
    ds_read_b128 a[224:227], v243 offset:6144
    s_waitcnt lgkmcnt(8)
    v_mfma_f32_16x16x32_bf16 v[80:83], a[228:231], a[196:199], v[80:83]
    v_mfma_f32_16x16x32_bf16 v[44:47], a[228:231], a[192:195], v[44:47]
    ds_read_b128 a[228:231], v243 offset:7168
    s_waitcnt lgkmcnt(8)
    v_mfma_f32_16x16x32_bf16 v[48:51], a[232:235], a[192:195], v[48:51]
    v_mfma_f32_16x16x32_bf16 v[84:87], a[232:235], a[196:199], v[84:87]
    ds_read_b128 a[232:235], v243 offset:8192
    buffer_load_dwordx2 v[176:177], v91, s[88:91], s1 offen sc1
    s_waitcnt vmcnt(40)
    s_waitcnt lgkmcnt(8)
    v_mfma_f32_16x16x32_bf16 v[16:19], a[200:203], a[0:3], v[16:19]
    v_mfma_f32_16x16x32_bf16 v[52:55], a[200:203], a[4:7], v[52:55]
    ds_read_b128 a[200:203], v243 offset:9216
    s_waitcnt lgkmcnt(8)
    v_mfma_f32_16x16x32_bf16 v[56:59], a[204:207], a[4:7], v[56:59]
    v_mfma_f32_16x16x32_bf16 v[20:23], a[204:207], a[0:3], v[20:23]
    ds_read_b128 a[204:207], v243 offset:10240
    s_waitcnt lgkmcnt(8)
    v_mfma_f32_16x16x32_bf16 v[24:27], a[208:211], a[0:3], v[24:27]
    v_mfma_f32_16x16x32_bf16 v[60:63], a[208:211], a[4:7], v[60:63]
    ds_read_b128 a[208:211], v243 offset:11264
    s_waitcnt lgkmcnt(8)
    v_mfma_f32_16x16x32_bf16 v[64:67], a[212:215], a[4:7], v[64:67]
    v_mfma_f32_16x16x32_bf16 v[28:31], a[212:215], a[0:3], v[28:31]
    ds_read_b128 a[212:215], v243 offset:12288
    s_waitcnt lgkmcnt(8)
    v_mfma_f32_16x16x32_bf16 v[32:35], a[216:219], a[0:3], v[32:35]
    v_mfma_f32_16x16x32_bf16 v[68:71], a[216:219], a[4:7], v[68:71]
    ds_read_b128 a[216:219], v243 offset:13312
    s_waitcnt lgkmcnt(8)
    v_mfma_f32_16x16x32_bf16 v[72:75], a[220:223], a[4:7], v[72:75]
    v_mfma_f32_16x16x32_bf16 v[36:39], a[220:223], a[0:3], v[36:39]
    ds_read_b128 a[220:223], v243 offset:14336
    s_waitcnt lgkmcnt(8)
    v_mfma_f32_16x16x32_bf16 v[40:43], a[224:227], a[0:3], v[40:43]
    v_mfma_f32_16x16x32_bf16 v[76:79], a[224:227], a[4:7], v[76:79]
    ds_read_b128 a[224:227], v243 offset:15360
    s_waitcnt lgkmcnt(8)
    v_mfma_f32_16x16x32_bf16 v[80:83], a[228:231], a[4:7], v[80:83]
    v_mfma_f32_16x16x32_bf16 v[44:47], a[228:231], a[0:3], v[44:47]
    ds_read_b128 a[228:231], v243 offset:16384
    s_waitcnt lgkmcnt(8)
    v_mfma_f32_16x16x32_bf16 v[48:51], a[232:235], a[0:3], v[48:51]
    v_mfma_f32_16x16x32_bf16 v[84:87], a[232:235], a[4:7], v[84:87]
    ds_read_b128 a[232:235], v243 offset:17408
    s_waitcnt vmcnt(13)
    s_barrier
    s_waitcnt lgkmcnt(8)
    v_mfma_f32_16x16x32_bf16 v[16:19], a[200:203], a[144:147], v[16:19]
    s_add_u32 m0, s39, 92160
    s_nop 0
    buffer_load_dwordx4 v246, s[24:27], s33 offen sc1 lds
    v_mfma_f32_16x16x32_bf16 v[52:55], a[200:203], a[148:151], v[52:55]
    ds_read_b128 a[200:203], v243 offset:18432
    s_waitcnt lgkmcnt(8)
    v_mfma_f32_16x16x32_bf16 v[56:59], a[204:207], a[148:151], v[56:59]
    s_add_u32 m0, s40, 92160
    s_nop 0
    buffer_load_dwordx4 v247, s[24:27], s33 offen sc1 lds
    v_mfma_f32_16x16x32_bf16 v[20:23], a[204:207], a[144:147], v[20:23]
    ds_read_b128 a[204:207], v243 offset:27648
    s_waitcnt lgkmcnt(8)
    v_mfma_f32_16x16x32_bf16 v[24:27], a[208:211], a[144:147], v[24:27]
    s_add_u32 m0, s41, 92160
    s_nop 0
    buffer_load_dwordx4 v248, s[24:27], s33 offen sc1 lds
    v_mfma_f32_16x16x32_bf16 v[60:63], a[208:211], a[148:151], v[60:63]
    ds_read_b128 a[208:211], v243 offset:36864
    s_waitcnt lgkmcnt(8)
    v_mfma_f32_16x16x32_bf16 v[64:67], a[212:215], a[148:151], v[64:67]
    s_add_u32 m0, s56, 92160
    s_nop 0
    buffer_load_dwordx4 v249, s[72:75], s33 offen sc1 lds
    s_add_u32 s33, s33, 36864
    v_mfma_f32_16x16x32_bf16 v[28:31], a[212:215], a[144:147], v[28:31]
    ds_read_b128 a[212:215], v243 offset:46080
    s_waitcnt lgkmcnt(8)
    v_mfma_f32_16x16x32_bf16 v[32:35], a[216:219], a[144:147], v[32:35]
    v_mfma_f32_16x16x32_bf16 v[68:71], a[216:219], a[148:151], v[68:71]
    ds_read_b128 a[216:219], v244 offset:0
    s_waitcnt lgkmcnt(8)
    v_mfma_f32_16x16x32_bf16 v[72:75], a[220:223], a[148:151], v[72:75]
    v_mfma_f32_16x16x32_bf16 v[36:39], a[220:223], a[144:147], v[36:39]
    ds_read_b128 a[220:223], v244 offset:9216
    s_waitcnt lgkmcnt(8)
    v_mfma_f32_16x16x32_bf16 v[40:43], a[224:227], a[144:147], v[40:43]
    v_mfma_f32_16x16x32_bf16 v[76:79], a[224:227], a[148:151], v[76:79]
    ds_read_b128 a[224:227], v243 offset:19456
    s_waitcnt lgkmcnt(8)
    v_mfma_f32_16x16x32_bf16 v[80:83], a[228:231], a[148:151], v[80:83]
    v_mfma_f32_16x16x32_bf16 v[44:47], a[228:231], a[144:147], v[44:47]
    ds_read_b128 a[228:231], v243 offset:28672
    s_waitcnt lgkmcnt(8)
    v_mfma_f32_16x16x32_bf16 v[48:51], a[232:235], a[144:147], v[48:51]
    v_mfma_f32_16x16x32_bf16 v[84:87], a[232:235], a[148:151], v[84:87]
    ds_read_b128 a[232:235], v243 offset:37888
    s_waitcnt vmcnt(13)
    s_waitcnt lgkmcnt(8)
    v_mfma_f32_16x16x32_bf16 v[16:19], a[200:203], a[8:11], v[16:19]
    v_mfma_f32_16x16x32_bf16 v[52:55], a[200:203], a[12:15], v[52:55]
    ds_read_b128 a[200:203], v243 offset:47104
    s_waitcnt lgkmcnt(8)
    v_mfma_f32_16x16x32_bf16 v[16:19], a[204:207], a[152:155], v[16:19]
    v_mfma_f32_16x16x32_bf16 v[52:55], a[204:207], a[156:159], v[52:55]
    ds_read_b128 a[204:207], v244 offset:1024
    s_waitcnt vmcnt(5)
    s_barrier
    s_waitcnt lgkmcnt(8)
    v_mfma_f32_16x16x32_bf16 v[16:19], a[208:211], a[16:19], v[16:19]
    s_add_u32 m0, s39, 0
    s_nop 0
    buffer_load_dwordx4 v246, s[24:27], s33 offen sc1 lds
    v_mfma_f32_16x16x32_bf16 v[52:55], a[208:211], a[20:23], v[52:55]
    ds_read_b128 a[208:211], v244 offset:10240
    s_waitcnt lgkmcnt(8)
    v_mfma_f32_16x16x32_bf16 v[16:19], a[212:215], a[160:163], v[16:19]
    s_add_u32 m0, s40, 0
    s_nop 0
    buffer_load_dwordx4 v247, s[24:27], s33 offen sc1 lds
    v_mfma_f32_16x16x32_bf16 v[52:55], a[212:215], a[164:167], v[52:55]
    ds_read_b128 a[212:215], v243 offset:20480
    s_waitcnt lgkmcnt(8)
    v_mfma_f32_16x16x32_bf16 v[16:19], a[216:219], a[24:27], v[16:19]
    s_add_u32 m0, s41, 0
    s_nop 0
    buffer_load_dwordx4 v248, s[24:27], s33 offen sc1 lds
    v_mfma_f32_16x16x32_bf16 v[52:55], a[216:219], a[28:31], v[52:55]
    ds_read_b128 a[216:219], v243 offset:29696
    s_waitcnt lgkmcnt(8)
    v_mfma_f32_16x16x32_bf16 v[16:19], a[220:223], a[168:171], v[16:19]
    s_add_u32 m0, s56, 0
    s_nop 0
    buffer_load_dwordx4 v249, s[72:75], s33 offen sc1 lds
    s_add_u32 s33, s33, 184320
    v_mfma_f32_16x16x32_bf16 v[52:55], a[220:223], a[172:175], v[52:55]
    ds_read_b128 a[220:223], v243 offset:38912
    s_waitcnt vmcnt(8)
L_spo:
    v_xor_b32 v176, s66, v176
    v_xor_b32 v177, s67, v177
    v_or_b32 v176, v176, v177
    v_cmp_ne_u32 vcc, 0, v176
    s_nop 3
    s_cmp_eq_u64 vcc, 0
    s_cbranch_scc1 L_spoko
    s_sleep 2
    buffer_load_dwordx2 v[176:177], v91, s[88:91], s1 offen sc1
    s_waitcnt vmcnt(0)
    s_branch L_spo
L_spoko:
    s_waitcnt lgkmcnt(8)
    v_mfma_f32_16x16x32_bf16 v[20:23], a[224:227], a[8:11], v[20:23]
    v_mfma_f32_16x16x32_bf16 v[56:59], a[224:227], a[12:15], v[56:59]
    buffer_load_dwordx4 a[56:59], v239, s[20:23], s34 offen sc1
    ds_read_b128 a[224:227], v243 offset:48128
    s_waitcnt lgkmcnt(8)
    v_mfma_f32_16x16x32_bf16 v[20:23], a[228:231], a[152:155], v[20:23]
    v_perm_b32 v160, v16, v19, s76
    v_perm_b32 v161, v17, v19, s77
    v_perm_b32 v162, v18, v19, s78
    buffer_store_dwordx3 v[160:162], v190, s[16:19], s43 offen offset:0 sc1
    v_mfma_f32_16x16x32_bf16 v[56:59], a[228:231], a[156:159], v[56:59]
    ds_read_b128 a[228:231], v244 offset:2048
    s_waitcnt lgkmcnt(8)
    v_mfma_f32_16x16x32_bf16 v[20:23], a[232:235], a[16:19], v[20:23]
    v_perm_b32 v164, v52, v55, s76
    v_perm_b32 v165, v53, v55, s77
    v_perm_b32 v166, v54, v55, s78
    buffer_store_dwordx3 v[164:166], v238, s[16:19], s43 offen offset:0 sc1
    v_mfma_f32_16x16x32_bf16 v[56:59], a[232:235], a[20:23], v[56:59]
    buffer_load_dwordx4 a[60:63], v250, s[20:23], s34 offen sc1
    s_add_u32 s34, s34, 8192
    ds_read_b128 a[232:235], v244 offset:11264
    s_waitcnt lgkmcnt(8)
    v_mfma_f32_16x16x32_bf16 v[20:23], a[200:203], a[160:163], v[20:23]
    v_mfma_f32_16x16x32_bf16 v[56:59], a[200:203], a[164:167], v[56:59]
    ds_read_b128 a[200:203], v243 offset:21504
    s_waitcnt lgkmcnt(8)
    v_mfma_f32_16x16x32_bf16 v[20:23], a[204:207], a[24:27], v[20:23]
    v_mfma_f32_16x16x32_bf16 v[56:59], a[204:207], a[28:31], v[56:59]
    buffer_load_dwordx4 a[64:67], v239, s[20:23], s34 offen sc1
    ds_read_b128 a[204:207], v243 offset:30720
    s_waitcnt lgkmcnt(8)
    v_mfma_f32_16x16x32_bf16 v[20:23], a[208:211], a[168:171], v[20:23]
    v_mfma_f32_16x16x32_bf16 v[56:59], a[208:211], a[172:175], v[56:59]
    ds_read_b128 a[208:211], v243 offset:39936
    s_waitcnt lgkmcnt(8)
    v_mfma_f32_16x16x32_bf16 v[24:27], a[212:215], a[8:11], v[24:27]
    v_mfma_f32_16x16x32_bf16 v[60:63], a[212:215], a[12:15], v[60:63]
    buffer_load_dwordx4 a[68:71], v250, s[20:23], s34 offen sc1
    s_add_u32 s34, s34, 8192
    ds_read_b128 a[212:215], v243 offset:49152
    s_waitcnt lgkmcnt(8)
    v_mfma_f32_16x16x32_bf16 v[24:27], a[216:219], a[152:155], v[24:27]
    v_perm_b32 v168, v20, v23, s76
    v_perm_b32 v169, v21, v23, s77
    v_perm_b32 v170, v22, v23, s78
    buffer_store_dwordx3 v[168:170], v190, s[16:19], s43 offen offset:768 sc1
    v_mfma_f32_16x16x32_bf16 v[60:63], a[216:219], a[156:159], v[60:63]
    ds_read_b128 a[216:219], v244 offset:3072
    s_waitcnt lgkmcnt(8)
    v_mfma_f32_16x16x32_bf16 v[24:27], a[220:223], a[16:19], v[24:27]
    v_perm_b32 v172, v56, v59, s76
    v_perm_b32 v173, v57, v59, s77
    v_perm_b32 v174, v58, v59, s78
    buffer_store_dwordx3 v[172:174], v238, s[16:19], s43 offen offset:768 sc1
    v_mfma_f32_16x16x32_bf16 v[60:63], a[220:223], a[20:23], v[60:63]
    buffer_load_dwordx4 a[72:75], v239, s[20:23], s34 offen sc1
    ds_read_b128 a[220:223], v244 offset:12288
    s_waitcnt lgkmcnt(8)
    v_mfma_f32_16x16x32_bf16 v[24:27], a[224:227], a[160:163], v[24:27]
    v_mfma_f32_16x16x32_bf16 v[60:63], a[224:227], a[164:167], v[60:63]
    ds_read_b128 a[224:227], v243 offset:22528
    s_waitcnt lgkmcnt(8)
    v_mfma_f32_16x16x32_bf16 v[24:27], a[228:231], a[24:27], v[24:27]
    v_mfma_f32_16x16x32_bf16 v[60:63], a[228:231], a[28:31], v[60:63]
    buffer_load_dwordx4 a[76:79], v250, s[20:23], s34 offen sc1
    s_add_u32 s34, s34, 8192
    ds_read_b128 a[228:231], v243 offset:31744
    s_waitcnt lgkmcnt(8)
    v_mfma_f32_16x16x32_bf16 v[24:27], a[232:235], a[168:171], v[24:27]
    v_mfma_f32_16x16x32_bf16 v[60:63], a[232:235], a[172:175], v[60:63]
    ds_read_b128 a[232:235], v243 offset:40960
    s_waitcnt lgkmcnt(8)
    v_mfma_f32_16x16x32_bf16 v[28:31], a[200:203], a[8:11], v[28:31]
    v_mfma_f32_16x16x32_bf16 v[64:67], a[200:203], a[12:15], v[64:67]
    buffer_load_dwordx4 a[80:83], v239, s[20:23], s34 offen sc1
    ds_read_b128 a[200:203], v243 offset:50176
    s_waitcnt lgkmcnt(8)
    v_mfma_f32_16x16x32_bf16 v[28:31], a[204:207], a[152:155], v[28:31]
    v_perm_b32 v160, v24, v27, s76
    v_perm_b32 v161, v25, v27, s77
    v_perm_b32 v162, v26, v27, s78
    buffer_store_dwordx3 v[160:162], v190, s[16:19], s43 offen offset:1536 sc1
    v_mfma_f32_16x16x32_bf16 v[64:67], a[204:207], a[156:159], v[64:67]
    ds_read_b128 a[204:207], v244 offset:4096
    s_waitcnt lgkmcnt(8)
    v_mfma_f32_16x16x32_bf16 v[28:31], a[208:211], a[16:19], v[28:31]
    v_perm_b32 v164, v60, v63, s76
    v_perm_b32 v165, v61, v63, s77
    v_perm_b32 v166, v62, v63, s78
    buffer_store_dwordx3 v[164:166], v238, s[16:19], s43 offen offset:1536 sc1
    v_mfma_f32_16x16x32_bf16 v[64:67], a[208:211], a[20:23], v[64:67]
    buffer_load_dwordx4 a[84:87], v250, s[20:23], s34 offen sc1
    s_add_u32 s34, s34, 8192
    ds_read_b128 a[208:211], v244 offset:13312
    s_waitcnt lgkmcnt(8)
    v_mfma_f32_16x16x32_bf16 v[28:31], a[212:215], a[160:163], v[28:31]
    v_mfma_f32_16x16x32_bf16 v[64:67], a[212:215], a[164:167], v[64:67]
    ds_read_b128 a[212:215], v243 offset:23552
    s_waitcnt lgkmcnt(8)
    v_mfma_f32_16x16x32_bf16 v[28:31], a[216:219], a[24:27], v[28:31]
    v_mfma_f32_16x16x32_bf16 v[64:67], a[216:219], a[28:31], v[64:67]
    buffer_load_dwordx4 a[88:91], v239, s[20:23], s34 offen sc1
    ds_read_b128 a[216:219], v243 offset:32768
    s_waitcnt lgkmcnt(8)
    v_mfma_f32_16x16x32_bf16 v[28:31], a[220:223], a[168:171], v[28:31]
    v_mfma_f32_16x16x32_bf16 v[64:67], a[220:223], a[172:175], v[64:67]
    ds_read_b128 a[220:223], v243 offset:41984
    s_waitcnt lgkmcnt(8)
    v_mfma_f32_16x16x32_bf16 v[32:35], a[224:227], a[8:11], v[32:35]
    v_mfma_f32_16x16x32_bf16 v[68:71], a[224:227], a[12:15], v[68:71]
    buffer_load_dwordx4 a[92:95], v250, s[20:23], s34 offen sc1
    s_add_u32 s34, s34, 8192
    ds_read_b128 a[224:227], v243 offset:51200
    s_waitcnt lgkmcnt(8)
    v_mfma_f32_16x16x32_bf16 v[32:35], a[228:231], a[152:155], v[32:35]
    v_perm_b32 v168, v28, v31, s76
    v_perm_b32 v169, v29, v31, s77
    v_perm_b32 v170, v30, v31, s78
    buffer_store_dwordx3 v[168:170], v190, s[16:19], s43 offen offset:2304 sc1
    v_mfma_f32_16x16x32_bf16 v[68:71], a[228:231], a[156:159], v[68:71]
    ds_read_b128 a[228:231], v244 offset:5120
    s_waitcnt lgkmcnt(8)
    v_mfma_f32_16x16x32_bf16 v[32:35], a[232:235], a[16:19], v[32:35]
    v_perm_b32 v172, v64, v67, s76
    v_perm_b32 v173, v65, v67, s77
    v_perm_b32 v174, v66, v67, s78
    buffer_store_dwordx3 v[172:174], v238, s[16:19], s43 offen offset:2304 sc1
    v_mfma_f32_16x16x32_bf16 v[68:71], a[232:235], a[20:23], v[68:71]
    buffer_load_dwordx4 a[96:99], v239, s[20:23], s34 offen sc1
    ds_read_b128 a[232:235], v244 offset:14336
    s_waitcnt lgkmcnt(8)
    v_mfma_f32_16x16x32_bf16 v[32:35], a[200:203], a[160:163], v[32:35]
    v_mfma_f32_16x16x32_bf16 v[68:71], a[200:203], a[164:167], v[68:71]
    ds_read_b128 a[200:203], v243 offset:24576
    s_waitcnt lgkmcnt(8)
    v_mfma_f32_16x16x32_bf16 v[32:35], a[204:207], a[24:27], v[32:35]
    v_mfma_f32_16x16x32_bf16 v[68:71], a[204:207], a[28:31], v[68:71]
    buffer_load_dwordx4 a[100:103], v250, s[20:23], s34 offen sc1
    s_add_u32 s34, s34, 8192
    ds_read_b128 a[204:207], v243 offset:33792
    s_waitcnt lgkmcnt(8)
    v_mfma_f32_16x16x32_bf16 v[32:35], a[208:211], a[168:171], v[32:35]
    v_mfma_f32_16x16x32_bf16 v[68:71], a[208:211], a[172:175], v[68:71]
    ds_read_b128 a[208:211], v243 offset:43008
    s_waitcnt lgkmcnt(8)
    v_mfma_f32_16x16x32_bf16 v[36:39], a[212:215], a[8:11], v[36:39]
    v_mfma_f32_16x16x32_bf16 v[72:75], a[212:215], a[12:15], v[72:75]
    buffer_load_dwordx4 a[104:107], v239, s[20:23], s34 offen sc1
    ds_read_b128 a[212:215], v243 offset:52224
    s_waitcnt lgkmcnt(8)
    v_mfma_f32_16x16x32_bf16 v[36:39], a[216:219], a[152:155], v[36:39]
    v_perm_b32 v160, v32, v35, s76
    v_perm_b32 v161, v33, v35, s77
    v_perm_b32 v162, v34, v35, s78
    buffer_store_dwordx3 v[160:162], v190, s[16:19], s43 offen offset:3072 sc1
    v_mfma_f32_16x16x32_bf16 v[72:75], a[216:219], a[156:159], v[72:75]
    ds_read_b128 a[216:219], v244 offset:6144
    s_waitcnt lgkmcnt(8)
    v_mfma_f32_16x16x32_bf16 v[36:39], a[220:223], a[16:19], v[36:39]
    v_perm_b32 v164, v68, v71, s76
    v_perm_b32 v165, v69, v71, s77
    v_perm_b32 v166, v70, v71, s78
    buffer_store_dwordx3 v[164:166], v238, s[16:19], s43 offen offset:3072 sc1
    v_mfma_f32_16x16x32_bf16 v[72:75], a[220:223], a[20:23], v[72:75]
    buffer_load_dwordx4 a[108:111], v250, s[20:23], s34 offen sc1
    s_add_u32 s34, s34, 8192
    ds_read_b128 a[220:223], v244 offset:15360
    s_waitcnt lgkmcnt(8)
    v_mfma_f32_16x16x32_bf16 v[36:39], a[224:227], a[160:163], v[36:39]
    v_mfma_f32_16x16x32_bf16 v[72:75], a[224:227], a[164:167], v[72:75]
    ds_read_b128 a[224:227], v243 offset:25600
    s_waitcnt lgkmcnt(8)
    v_mfma_f32_16x16x32_bf16 v[36:39], a[228:231], a[24:27], v[36:39]
    v_mfma_f32_16x16x32_bf16 v[72:75], a[228:231], a[28:31], v[72:75]
    buffer_load_dwordx4 a[112:115], v239, s[20:23], s34 offen sc1
    ds_read_b128 a[228:231], v243 offset:34816
    s_waitcnt lgkmcnt(8)
    v_mfma_f32_16x16x32_bf16 v[36:39], a[232:235], a[168:171], v[36:39]
    v_mfma_f32_16x16x32_bf16 v[72:75], a[232:235], a[172:175], v[72:75]
    ds_read_b128 a[232:235], v243 offset:44032
    s_waitcnt lgkmcnt(8)
    v_mfma_f32_16x16x32_bf16 v[40:43], a[200:203], a[8:11], v[40:43]
    v_mfma_f32_16x16x32_bf16 v[76:79], a[200:203], a[12:15], v[76:79]
    buffer_load_dwordx4 a[116:119], v250, s[20:23], s34 offen sc1
    s_add_u32 s34, s34, 8192
    ds_read_b128 a[200:203], v243 offset:53248
    s_waitcnt lgkmcnt(8)
    v_mfma_f32_16x16x32_bf16 v[40:43], a[204:207], a[152:155], v[40:43]
    v_perm_b32 v168, v36, v39, s76
    v_perm_b32 v169, v37, v39, s77
    v_perm_b32 v170, v38, v39, s78
    s_mov_b32 s18, s69
    s_add_u32 s43, s43, 18432
    buffer_store_dwordx3 v[168:170], v190, s[16:19], s43 offen offset:0 sc1
    v_mfma_f32_16x16x32_bf16 v[76:79], a[204:207], a[156:159], v[76:79]
    ds_read_b128 a[204:207], v244 offset:7168
    s_waitcnt lgkmcnt(8)
    v_mfma_f32_16x16x32_bf16 v[40:43], a[208:211], a[16:19], v[40:43]
    v_perm_b32 v172, v72, v75, s76
    v_perm_b32 v173, v73, v75, s77
    v_perm_b32 v174, v74, v75, s78
    buffer_store_dwordx3 v[172:174], v238, s[16:19], s43 offen offset:0 sc1
    v_mfma_f32_16x16x32_bf16 v[76:79], a[208:211], a[20:23], v[76:79]
    buffer_load_dwordx4 a[120:123], v239, s[20:23], s34 offen sc1
    ds_read_b128 a[208:211], v244 offset:16384
    s_waitcnt lgkmcnt(8)
    v_mfma_f32_16x16x32_bf16 v[40:43], a[212:215], a[160:163], v[40:43]
    v_mfma_f32_16x16x32_bf16 v[76:79], a[212:215], a[164:167], v[76:79]
    ds_read_b128 a[212:215], v243 offset:26624
    s_waitcnt lgkmcnt(8)
    v_mfma_f32_16x16x32_bf16 v[40:43], a[216:219], a[24:27], v[40:43]
    v_mfma_f32_16x16x32_bf16 v[76:79], a[216:219], a[28:31], v[76:79]
    buffer_load_dwordx4 a[124:127], v250, s[20:23], s34 offen sc1
    s_add_u32 s34, s34, 8192
    ds_read_b128 a[216:219], v243 offset:35840
    s_waitcnt lgkmcnt(8)
    v_mfma_f32_16x16x32_bf16 v[40:43], a[220:223], a[168:171], v[40:43]
    v_mfma_f32_16x16x32_bf16 v[76:79], a[220:223], a[172:175], v[76:79]
    ds_read_b128 a[220:223], v243 offset:45056
    s_waitcnt lgkmcnt(8)
    v_mfma_f32_16x16x32_bf16 v[44:47], a[224:227], a[8:11], v[44:47]
    v_mfma_f32_16x16x32_bf16 v[80:83], a[224:227], a[12:15], v[80:83]
    ds_read_b128 a[224:227], v243 offset:54272
    s_waitcnt lgkmcnt(8)
    v_mfma_f32_16x16x32_bf16 v[44:47], a[228:231], a[152:155], v[44:47]
    v_perm_b32 v160, v40, v43, s76
    v_perm_b32 v161, v41, v43, s77
    v_perm_b32 v162, v42, v43, s78
    buffer_store_dwordx3 v[160:162], v190, s[16:19], s43 offen offset:768 sc1
    v_mfma_f32_16x16x32_bf16 v[80:83], a[228:231], a[156:159], v[80:83]
    ds_read_b128 a[228:231], v244 offset:8192
    s_waitcnt lgkmcnt(8)
    v_mfma_f32_16x16x32_bf16 v[44:47], a[232:235], a[16:19], v[44:47]
    v_perm_b32 v164, v76, v79, s76
    v_perm_b32 v165, v77, v79, s77
    v_perm_b32 v166, v78, v79, s78
    buffer_store_dwordx3 v[164:166], v238, s[16:19], s43 offen offset:768 sc1
    v_mfma_f32_16x16x32_bf16 v[80:83], a[232:235], a[20:23], v[80:83]
    ds_read_b128 a[232:235], v244 offset:17408
    s_waitcnt lgkmcnt(8)
    v_mfma_f32_16x16x32_bf16 v[44:47], a[200:203], a[160:163], v[44:47]
    v_mfma_f32_16x16x32_bf16 v[80:83], a[200:203], a[164:167], v[80:83]
    ds_read_b128 a[200:203], v88 offset:0
    s_waitcnt lgkmcnt(8)
    v_mfma_f32_16x16x32_bf16 v[44:47], a[204:207], a[24:27], v[44:47]
    v_mfma_f32_16x16x32_bf16 v[80:83], a[204:207], a[28:31], v[80:83]
    ds_read_b128 a[204:207], v88 offset:1024
    s_waitcnt lgkmcnt(8)
    v_mfma_f32_16x16x32_bf16 v[44:47], a[208:211], a[168:171], v[44:47]
    v_mfma_f32_16x16x32_bf16 v[80:83], a[208:211], a[172:175], v[80:83]
    ds_read_b128 a[208:211], v88 offset:2048
    s_waitcnt lgkmcnt(8)
    v_mfma_f32_16x16x32_bf16 v[48:51], a[212:215], a[8:11], v[48:51]
    v_mfma_f32_16x16x32_bf16 v[84:87], a[212:215], a[12:15], v[84:87]
    ds_read_b128 a[212:215], v88 offset:3072
    s_waitcnt lgkmcnt(8)
    v_mfma_f32_16x16x32_bf16 v[48:51], a[216:219], a[152:155], v[48:51]
    v_perm_b32 v168, v44, v47, s76
    v_perm_b32 v169, v45, v47, s77
    v_perm_b32 v170, v46, v47, s78
    buffer_store_dwordx3 v[168:170], v190, s[16:19], s43 offen offset:1536 sc1
    v_mfma_f32_16x16x32_bf16 v[84:87], a[216:219], a[156:159], v[84:87]
    ds_read_b128 a[216:219], v88 offset:4096
    s_waitcnt lgkmcnt(8)
    v_mfma_f32_16x16x32_bf16 v[48:51], a[220:223], a[16:19], v[48:51]
    v_perm_b32 v172, v80, v83, s76
    v_perm_b32 v173, v81, v83, s77
    v_perm_b32 v174, v82, v83, s78
    buffer_store_dwordx3 v[172:174], v238, s[16:19], s43 offen offset:1536 sc1
    v_mfma_f32_16x16x32_bf16 v[84:87], a[220:223], a[20:23], v[84:87]
    ds_read_b128 a[220:223], v88 offset:5120
    s_waitcnt lgkmcnt(8)
    v_mfma_f32_16x16x32_bf16 v[48:51], a[224:227], a[160:163], v[48:51]
    v_mfma_f32_16x16x32_bf16 v[84:87], a[224:227], a[164:167], v[84:87]
    ds_read_b128 a[224:227], v88 offset:6144
    s_waitcnt lgkmcnt(8)
    v_mfma_f32_16x16x32_bf16 v[48:51], a[228:231], a[24:27], v[48:51]
    v_mfma_f32_16x16x32_bf16 v[84:87], a[228:231], a[28:31], v[84:87]
    ds_read_b128 a[228:231], v88 offset:7168
    s_waitcnt lgkmcnt(8)
    v_mfma_f32_16x16x32_bf16 v[48:51], a[232:235], a[168:171], v[48:51]
    v_mfma_f32_16x16x32_bf16 v[84:87], a[232:235], a[172:175], v[84:87]
    ds_read_b128 a[232:235], v88 offset:8192
    s_nop 7
    v_perm_b32 v160, v48, v51, s76
    v_perm_b32 v161, v49, v51, s77
    v_perm_b32 v162, v50, v51, s78
    buffer_store_dwordx3 v[160:162], v190, s[16:19], s43 offen offset:2304 sc1
    v_perm_b32 v164, v84, v87, s76
    v_perm_b32 v165, v85, v87, s77
    v_perm_b32 v166, v86, v87, s78
    buffer_store_dwordx3 v[164:166], v238, s[16:19], s43 offen offset:2304 sc1
    s_mov_b32 s18, 0x01200000
    s_cmp_ge_u32 s57, 2
    s_cbranch_scc1 L_k3_sent
    s_cmp_lg_u32 s68, 0
    s_cbranch_scc1 L_k3_own1
    ds_write_b128 v1, v[16:19] offset:0
    ds_write_b128 v1, v[52:55] offset:5120
    ds_write_b128 v1, v[20:23] offset:1024
    ds_write_b128 v1, v[56:59] offset:6144
    ds_write_b128 v1, v[24:27] offset:2048
    ds_write_b128 v1, v[60:63] offset:7168
    ds_write_b128 v1, v[28:31] offset:3072
    ds_write_b128 v1, v[64:67] offset:8192
    ds_write_b128 v1, v[32:35] offset:4096
    ds_write_b128 v1, v[68:71] offset:9216
    s_branch L_k3_sent
L_k3_own1:
    ds_write_b128 v1, v[36:39] offset:0
    ds_write_b128 v1, v[72:75] offset:5120
    ds_write_b128 v1, v[40:43] offset:1024
    ds_write_b128 v1, v[76:79] offset:6144
    ds_write_b128 v1, v[44:47] offset:2048
    ds_write_b128 v1, v[80:83] offset:7168
    ds_write_b128 v1, v[48:51] offset:3072
    ds_write_b128 v1, v[84:87] offset:8192
L_k3_sent:
    s_waitcnt vmcnt(36)
    s_barrier
    s_waitcnt vmcnt(32)
    s_waitcnt lgkmcnt(8)
    v_mfma_f32_16x16x32_bf16 v[212:215], a[200:203], a[56:59], 0
    s_add_u32 m0, s39, 18432
    s_nop 0
    buffer_load_dwordx4 v246, s[24:27], s33 offen sc1 lds
    v_mfma_f32_16x16x32_bf16 a[0:3], a[200:203], a[60:63], 0
    s_add_u32 m0, s40, 18432
    s_nop 0
    buffer_load_dwordx4 v247, s[24:27], s33 offen sc1 lds
    ds_read_b128 a[200:203], v88 offset:9216
    s_waitcnt lgkmcnt(8)
    v_mfma_f32_16x16x32_bf16 v[216:219], a[204:207], a[56:59], 0
    s_add_u32 m0, s41, 18432
    s_nop 0
    buffer_load_dwordx4 v248, s[24:27], s33 offen sc1 lds
    v_mfma_f32_16x16x32_bf16 a[4:7], a[204:207], a[60:63], 0
    s_add_u32 m0, s56, 18432
    s_nop 0
    buffer_load_dwordx4 v249, s[72:75], s33 offen sc1 lds
    s_add_u32 s33, s33, 36864
    ds_read_b128 a[204:207], v88 offset:10240
    s_waitcnt lgkmcnt(8)
    v_mfma_f32_16x16x32_bf16 v[220:223], a[208:211], a[56:59], 0
    s_add_u32 m0, s39, 36864
    s_nop 0
    buffer_load_dwordx4 v246, s[24:27], s33 offen sc1 lds
    v_mfma_f32_16x16x32_bf16 a[8:11], a[208:211], a[60:63], 0
    s_add_u32 m0, s40, 36864
    s_nop 0
    buffer_load_dwordx4 v247, s[24:27], s33 offen sc1 lds
    ds_read_b128 a[208:211], v88 offset:11264
    s_waitcnt lgkmcnt(8)
    v_mfma_f32_16x16x32_bf16 v[224:227], a[212:215], a[56:59], 0
    s_add_u32 m0, s41, 36864
    s_nop 0
    buffer_load_dwordx4 v248, s[24:27], s33 offen sc1 lds
    v_mfma_f32_16x16x32_bf16 a[12:15], a[212:215], a[60:63], 0
    s_add_u32 m0, s56, 36864
    s_nop 0
    buffer_load_dwordx4 v249, s[72:75], s33 offen sc1 lds
    s_add_u32 s33, s33, 184320
    ds_read_b128 a[212:215], v88 offset:12288
    s_waitcnt lgkmcnt(8)
    v_mfma_f32_16x16x32_bf16 v[228:231], a[216:219], a[56:59], 0
    buffer_load_dwordx2 v[180:181], v5, s[44:47], 0 offen offset:0
    v_mfma_f32_16x16x32_bf16 a[16:19], a[216:219], a[60:63], 0
    buffer_load_dwordx2 v[182:183], v5, s[44:47], 0 offen offset:32
    ds_read_b128 a[216:219], v88 offset:13312
    s_waitcnt vmcnt(40)
    s_waitcnt lgkmcnt(8)
    v_mfma_f32_16x16x32_bf16 v[212:215], a[220:223], a[64:67], v[212:215]
    buffer_load_dwordx2 v[184:185], v5, s[44:47], 0 offen offset:64
    v_mfma_f32_16x16x32_bf16 a[0:3], a[220:223], a[68:71], a[0:3]
    buffer_load_dwordx2 v[186:187], v5, s[44:47], 0 offen offset:96
    ds_read_b128 a[220:223], v88 offset:14336
    s_waitcnt vmcnt(25)
    s_mov_b64 exec, 0xffff
    buffer_store_dwordx2 v[92:93], v7, s[60:63], s37 offen sc0 sc1
    s_mov_b64 exec, -1
    s_waitcnt lgkmcnt(8)
    v_mfma_f32_16x16x32_bf16 v[216:219], a[224:227], a[64:67], v[216:219]
    buffer_load_dwordx2 v[188:189], v5, s[44:47], 0 offen offset:128
    v_mfma_f32_16x16x32_bf16 a[4:7], a[224:227], a[68:71], a[4:7]
    ds_read_b128 a[224:227], v89 offset:0
    s_waitcnt lgkmcnt(8)
    v_mfma_f32_16x16x32_bf16 v[220:223], a[228:231], a[64:67], v[220:223]
    v_mfma_f32_16x16x32_bf16 a[8:11], a[228:231], a[68:71], a[8:11]
    ds_read_b128 a[228:231], v89 offset:1024
    s_waitcnt lgkmcnt(8)
    v_mfma_f32_16x16x32_bf16 v[224:227], a[232:235], a[64:67], v[224:227]
    v_mfma_f32_16x16x32_bf16 a[12:15], a[232:235], a[68:71], a[12:15]
    ds_read_b128 a[232:235], v89 offset:2048
    s_waitcnt lgkmcnt(8)
    v_mfma_f32_16x16x32_bf16 v[228:231], a[200:203], a[64:67], v[228:231]
    v_mfma_f32_16x16x32_bf16 a[16:19], a[200:203], a[68:71], a[16:19]
    ds_read_b128 a[200:203], v89 offset:3072
    s_waitcnt vmcnt(40)
    s_waitcnt lgkmcnt(8)
    v_mfma_f32_16x16x32_bf16 v[212:215], a[204:207], a[72:75], v[212:215]
    v_mfma_f32_16x16x32_bf16 a[0:3], a[204:207], a[76:79], a[0:3]
    ds_read_b128 a[204:207], v89 offset:4096
    s_waitcnt lgkmcnt(8)
    v_mfma_f32_16x16x32_bf16 v[216:219], a[208:211], a[72:75], v[216:219]
    v_mfma_f32_16x16x32_bf16 a[4:7], a[208:211], a[76:79], a[4:7]
    ds_read_b128 a[208:211], v89 offset:5120
    s_waitcnt lgkmcnt(8)
    v_mfma_f32_16x16x32_bf16 v[220:223], a[212:215], a[72:75], v[220:223]
    v_mfma_f32_16x16x32_bf16 a[8:11], a[212:215], a[76:79], a[8:11]
    ds_read_b128 a[212:215], v89 offset:6144
    s_waitcnt lgkmcnt(8)
    v_mfma_f32_16x16x32_bf16 v[224:227], a[216:219], a[72:75], v[224:227]
    v_mfma_f32_16x16x32_bf16 a[12:15], a[216:219], a[76:79], a[12:15]
    ds_read_b128 a[216:219], v89 offset:7168
    s_waitcnt lgkmcnt(8)
    v_mfma_f32_16x16x32_bf16 v[228:231], a[220:223], a[72:75], v[228:231]
    v_mfma_f32_16x16x32_bf16 a[16:19], a[220:223], a[76:79], a[16:19]
    ds_read_b128 a[220:223], v89 offset:8192
    s_waitcnt vmcnt(36)
    s_waitcnt lgkmcnt(8)
    v_mfma_f32_16x16x32_bf16 v[212:215], a[224:227], a[80:83], v[212:215]
    v_mfma_f32_16x16x32_bf16 a[0:3], a[224:227], a[84:87], a[0:3]
    ds_read_b128 a[224:227], v89 offset:9216
    s_waitcnt lgkmcnt(8)
    v_mfma_f32_16x16x32_bf16 v[216:219], a[228:231], a[80:83], v[216:219]
    v_mfma_f32_16x16x32_bf16 a[4:7], a[228:231], a[84:87], a[4:7]
    ds_read_b128 a[228:231], v89 offset:10240
    s_waitcnt lgkmcnt(8)
    v_mfma_f32_16x16x32_bf16 v[220:223], a[232:235], a[80:83], v[220:223]
    v_mfma_f32_16x16x32_bf16 a[8:11], a[232:235], a[84:87], a[8:11]
    ds_read_b128 a[232:235], v89 offset:11264
    s_waitcnt lgkmcnt(8)
    v_mfma_f32_16x16x32_bf16 v[224:227], a[200:203], a[80:83], v[224:227]
    v_mfma_f32_16x16x32_bf16 a[12:15], a[200:203], a[84:87], a[12:15]
    ds_read_b128 a[200:203], v89 offset:12288
    s_waitcnt lgkmcnt(8)
    v_mfma_f32_16x16x32_bf16 v[228:231], a[204:207], a[80:83], v[228:231]
    v_mfma_f32_16x16x32_bf16 a[16:19], a[204:207], a[84:87], a[16:19]
    ds_read_b128 a[204:207], v89 offset:13312
    s_waitcnt vmcnt(34)
    s_waitcnt lgkmcnt(8)
    v_mfma_f32_16x16x32_bf16 v[212:215], a[208:211], a[88:91], v[212:215]
    v_mfma_f32_16x16x32_bf16 a[0:3], a[208:211], a[92:95], a[0:3]
    ds_read_b128 a[208:211], v89 offset:14336
    s_waitcnt vmcnt(6)
    s_mov_b64 exec, 0xffff
    buffer_store_dwordx2 v[92:93], v179, s[60:63], s37 offen sc0 sc1
    s_mov_b64 exec, -1
    s_barrier
    s_waitcnt lgkmcnt(8)
    v_mfma_f32_16x16x32_bf16 v[216:219], a[212:215], a[88:91], v[216:219]
    v_mfma_f32_16x16x32_bf16 a[4:7], a[212:215], a[92:95], a[4:7]
    ds_read_b128 a[212:215], v90 offset:0
    s_waitcnt lgkmcnt(8)
    v_mfma_f32_16x16x32_bf16 v[220:223], a[216:219], a[88:91], v[220:223]
    v_mfma_f32_16x16x32_bf16 a[8:11], a[216:219], a[92:95], a[8:11]
    ds_read_b128 a[216:219], v90 offset:1024
    s_waitcnt lgkmcnt(8)
    v_mfma_f32_16x16x32_bf16 v[224:227], a[220:223], a[88:91], v[224:227]
    v_mfma_f32_16x16x32_bf16 a[12:15], a[220:223], a[92:95], a[12:15]
    ds_read_b128 a[220:223], v90 offset:2048
    s_waitcnt lgkmcnt(8)
    v_mfma_f32_16x16x32_bf16 v[228:231], a[224:227], a[88:91], v[228:231]
    v_mfma_f32_16x16x32_bf16 a[16:19], a[224:227], a[92:95], a[16:19]
    ds_read_b128 a[224:227], v90 offset:3072
    s_waitcnt vmcnt(31)
    s_waitcnt lgkmcnt(8)
    v_mfma_f32_16x16x32_bf16 v[212:215], a[228:231], a[96:99], v[212:215]
    v_mfma_f32_16x16x32_bf16 a[0:3], a[228:231], a[100:103], a[0:3]
    ds_read_b128 a[228:231], v90 offset:4096
    s_waitcnt lgkmcnt(8)
    v_mfma_f32_16x16x32_bf16 v[216:219], a[232:235], a[96:99], v[216:219]
    v_mfma_f32_16x16x32_bf16 a[4:7], a[232:235], a[100:103], a[4:7]
    ds_read_b128 a[232:235], v90 offset:5120
    s_waitcnt lgkmcnt(8)
    v_mfma_f32_16x16x32_bf16 v[220:223], a[200:203], a[96:99], v[220:223]
    v_mfma_f32_16x16x32_bf16 a[8:11], a[200:203], a[100:103], a[8:11]
    ds_read_b128 a[200:203], v90 offset:6144
    buffer_load_dwordx2 v[176:177], v8, s[60:63], s7 offen sc1
    s_waitcnt lgkmcnt(8)
    v_mfma_f32_16x16x32_bf16 v[224:227], a[204:207], a[96:99], v[224:227]
    v_mfma_f32_16x16x32_bf16 a[12:15], a[204:207], a[100:103], a[12:15]
    ds_read_b128 a[204:207], v90 offset:7168
    s_waitcnt lgkmcnt(8)
    v_mfma_f32_16x16x32_bf16 v[228:231], a[208:211], a[96:99], v[228:231]
    v_mfma_f32_16x16x32_bf16 a[16:19], a[208:211], a[100:103], a[16:19]
    ds_read_b128 a[208:211], v90 offset:8192
    s_waitcnt vmcnt(28)
    s_waitcnt lgkmcnt(8)
    v_mfma_f32_16x16x32_bf16 v[212:215], a[212:215], a[104:107], v[212:215]
    v_mfma_f32_16x16x32_bf16 a[0:3], a[212:215], a[108:111], a[0:3]
    ds_read_b128 a[212:215], v90 offset:9216
    s_waitcnt lgkmcnt(8)
    v_mfma_f32_16x16x32_bf16 v[216:219], a[216:219], a[104:107], v[216:219]
    v_mfma_f32_16x16x32_bf16 a[4:7], a[216:219], a[108:111], a[4:7]
    ds_read_b128 a[216:219], v90 offset:10240
    s_waitcnt lgkmcnt(8)
    v_mfma_f32_16x16x32_bf16 v[220:223], a[220:223], a[104:107], v[220:223]
    v_mfma_f32_16x16x32_bf16 a[8:11], a[220:223], a[108:111], a[8:11]
    ds_read_b128 a[220:223], v90 offset:11264
    s_waitcnt lgkmcnt(8)
    v_mfma_f32_16x16x32_bf16 v[224:227], a[224:227], a[104:107], v[224:227]
    v_mfma_f32_16x16x32_bf16 a[12:15], a[224:227], a[108:111], a[12:15]
    ds_read_b128 a[224:227], v90 offset:12288
    s_waitcnt lgkmcnt(8)
    v_mfma_f32_16x16x32_bf16 v[228:231], a[228:231], a[104:107], v[228:231]
    v_mfma_f32_16x16x32_bf16 a[16:19], a[228:231], a[108:111], a[16:19]
    ds_read_b128 a[228:231], v90 offset:13312
    s_waitcnt vmcnt(26)
    s_waitcnt lgkmcnt(8)
    v_mfma_f32_16x16x32_bf16 v[212:215], a[232:235], a[112:115], v[212:215]
    v_mfma_f32_16x16x32_bf16 a[0:3], a[232:235], a[116:119], a[0:3]
    ds_read_b128 a[232:235], v90 offset:14336
    s_cmp_lg_u32 s68, 0
    s_cbranch_scc1 L_k3_nf0
    s_waitcnt vmcnt(0)
L_spf0:
    v_xor_b32 v176, s66, v176
    v_xor_b32 v177, s67, v177
    v_or_b32 v176, v176, v177
    v_cmp_ne_u32 vcc, 0, v176
    s_nop 3
    s_cmp_eq_u64 vcc, 0
    s_cbranch_scc1 L_spokf0
    s_sleep 1
    buffer_load_dwordx2 v[176:177], v8, s[60:63], s7 offen sc1
    s_waitcnt vmcnt(0)
    s_branch L_spf0
L_spokf0:
    buffer_load_dwordx3 v[96:98], v190, s[16:19], s4 offen offset:0 sc1
    buffer_load_dwordx3 v[100:102], v190, s[16:19], s5 offen offset:0 sc1
    buffer_load_dwordx3 v[104:106], v190, s[16:19], s6 offen offset:0 sc1
    buffer_load_dwordx3 v[108:110], v190, s[16:19], s4 offen offset:768 sc1
    buffer_load_dwordx3 v[112:114], v190, s[16:19], s5 offen offset:768 sc1
    buffer_load_dwordx3 v[116:118], v190, s[16:19], s6 offen offset:768 sc1
    buffer_load_dwordx3 v[120:122], v190, s[16:19], s4 offen offset:1536 sc1
    buffer_load_dwordx3 v[124:126], v190, s[16:19], s5 offen offset:1536 sc1
    buffer_load_dwordx3 v[128:130], v190, s[16:19], s6 offen offset:1536 sc1
    buffer_load_dwordx3 v[132:134], v190, s[16:19], s4 offen offset:2304 sc1
    buffer_load_dwordx3 v[136:138], v190, s[16:19], s5 offen offset:2304 sc1
    buffer_load_dwordx3 v[140:142], v190, s[16:19], s6 offen offset:2304 sc1
    buffer_load_dwordx3 v[144:146], v190, s[16:19], s4 offen offset:3072 sc1
    buffer_load_dwordx3 v[148:150], v190, s[16:19], s5 offen offset:3072 sc1
    buffer_load_dwordx3 v[152:154], v190, s[16:19], s6 offen offset:3072 sc1
L_k3_nf0:
    s_waitcnt lgkmcnt(8)
    v_mfma_f32_16x16x32_bf16 v[216:219], a[200:203], a[112:115], v[216:219]
    v_mfma_f32_16x16x32_bf16 a[4:7], a[200:203], a[116:119], a[4:7]
    s_waitcnt lgkmcnt(7)
    v_mfma_f32_16x16x32_bf16 v[220:223], a[204:207], a[112:115], v[220:223]
    v_mfma_f32_16x16x32_bf16 a[8:11], a[204:207], a[116:119], a[8:11]
    s_waitcnt lgkmcnt(6)
    v_mfma_f32_16x16x32_bf16 v[224:227], a[208:211], a[112:115], v[224:227]
    v_mfma_f32_16x16x32_bf16 a[12:15], a[208:211], a[116:119], a[12:15]
    s_waitcnt lgkmcnt(5)
    v_mfma_f32_16x16x32_bf16 v[228:231], a[212:215], a[112:115], v[228:231]
    v_mfma_f32_16x16x32_bf16 a[16:19], a[212:215], a[116:119], a[16:19]
    s_waitcnt vmcnt(22)
    buffer_load_dwordx2 v[176:177], v8, s[60:63], s7 offen sc1
    s_waitcnt lgkmcnt(4)
    v_mfma_f32_16x16x32_bf16 v[212:215], a[216:219], a[120:123], v[212:215]
    v_mfma_f32_16x16x32_bf16 a[0:3], a[216:219], a[124:127], a[0:3]
    s_waitcnt lgkmcnt(3)
    v_mfma_f32_16x16x32_bf16 v[216:219], a[220:223], a[120:123], v[216:219]
    v_mfma_f32_16x16x32_bf16 a[4:7], a[220:223], a[124:127], a[4:7]
    s_waitcnt lgkmcnt(2)
    v_mfma_f32_16x16x32_bf16 v[220:223], a[224:227], a[120:123], v[220:223]
    v_mfma_f32_16x16x32_bf16 a[8:11], a[224:227], a[124:127], a[8:11]
    s_waitcnt lgkmcnt(1)
    v_mfma_f32_16x16x32_bf16 v[224:227], a[228:231], a[120:123], v[224:227]
    v_mfma_f32_16x16x32_bf16 a[12:15], a[228:231], a[124:127], a[12:15]
    s_waitcnt lgkmcnt(0)
    v_mfma_f32_16x16x32_bf16 v[228:231], a[232:235], a[120:123], v[228:231]
    v_mfma_f32_16x16x32_bf16 a[16:19], a[232:235], a[124:127], a[16:19]
    s_nop 7
    ds_write_b128 v4, a[0:3] offset:55296
    ds_write_b128 v4, a[4:7] offset:56320
    ds_write_b128 v4, a[8:11] offset:57344
    ds_write_b128 v4, a[12:15] offset:58368
    ds_write_b128 v4, a[16:19] offset:59392
    s_waitcnt lgkmcnt(0)
    s_barrier
    ds_read_b128 v[16:19], v3 offset:55296
    ds_read_b128 v[20:23], v3 offset:56320
    ds_read_b128 v[24:27], v3 offset:57344
    ds_read_b128 v[28:31], v3 offset:58368
    ds_read_b128 v[32:35], v3 offset:59392
    ds_read_b128 v[156:159], v2 offset:0
    ds_read_b128 v[160:163], v2 offset:1024
    ds_read_b128 v[164:167], v2 offset:2048
    ds_read_b128 v[168:171], v2 offset:3072
    ds_read_b128 v[172:175], v2 offset:4096
    s_cmp_lg_u32 s68, 1
    s_cbranch_scc1 L_k3_nf1
    s_waitcnt vmcnt(0)
L_spf1:
    v_xor_b32 v176, s66, v176
    v_xor_b32 v177, s67, v177
    v_or_b32 v176, v176, v177
    v_cmp_ne_u32 vcc, 0, v176
    s_nop 3
    s_cmp_eq_u64 vcc, 0
    s_cbranch_scc1 L_spokf1
    s_sleep 1
    buffer_load_dwordx2 v[176:177], v8, s[60:63], s7 offen sc1
    s_waitcnt vmcnt(0)
    s_branch L_spf1
L_spokf1:
    buffer_load_dwordx3 v[96:98], v190, s[16:19], s4 offen offset:0 sc1
    buffer_load_dwordx3 v[100:102], v190, s[16:19], s5 offen offset:0 sc1
    buffer_load_dwordx3 v[104:106], v190, s[16:19], s6 offen offset:0 sc1
    buffer_load_dwordx3 v[108:110], v190, s[16:19], s4 offen offset:768 sc1
    buffer_load_dwordx3 v[112:114], v190, s[16:19], s5 offen offset:768 sc1
    buffer_load_dwordx3 v[116:118], v190, s[16:19], s6 offen offset:768 sc1
    buffer_load_dwordx3 v[120:122], v190, s[16:19], s4 offen offset:1536 sc1
    buffer_load_dwordx3 v[124:126], v190, s[16:19], s5 offen offset:1536 sc1
    buffer_load_dwordx3 v[128:130], v190, s[16:19], s6 offen offset:1536 sc1
    buffer_load_dwordx3 v[132:134], v190, s[16:19], s4 offen offset:2304 sc1
    buffer_load_dwordx3 v[136:138], v190, s[16:19], s5 offen offset:2304 sc1
    buffer_load_dwordx3 v[140:142], v190, s[16:19], s6 offen offset:2304 sc1
L_k3_nf1:
    s_waitcnt vmcnt(12)
    v_lshlrev_b32 v40, 16, v180
    v_and_b32 v41, 0xffff0000, v180
    v_lshlrev_b32 v42, 16, v181
    v_and_b32 v43, 0xffff0000, v181
    v_lshlrev_b32 v44, 16, v182
    v_and_b32 v45, 0xffff0000, v182
    v_lshlrev_b32 v46, 16, v183
    v_and_b32 v47, 0xffff0000, v183
    v_lshlrev_b32 v48, 16, v184
    v_and_b32 v49, 0xffff0000, v184
    v_lshlrev_b32 v50, 16, v185
    v_and_b32 v51, 0xffff0000, v185
    v_lshlrev_b32 v52, 16, v186
    v_and_b32 v53, 0xffff0000, v186
    v_lshlrev_b32 v54, 16, v187
    v_and_b32 v55, 0xffff0000, v187
    v_lshlrev_b32 v56, 16, v188
    v_and_b32 v57, 0xffff0000, v188
    v_lshlrev_b32 v58, 16, v189
    v_and_b32 v59, 0xffff0000, v189
    s_waitcnt lgkmcnt(5)
    v_pk_add_f32 v[16:17], v[16:17], v[212:213]
    v_pk_add_f32 v[18:19], v[18:19], v[214:215]
    v_pk_add_f32 v[20:21], v[20:21], v[216:217]
    v_pk_add_f32 v[22:23], v[22:23], v[218:219]
    v_pk_add_f32 v[24:25], v[24:25], v[220:221]
    v_pk_add_f32 v[26:27], v[26:27], v[222:223]
    v_pk_add_f32 v[28:29], v[28:29], v[224:225]
    v_pk_add_f32 v[30:31], v[30:31], v[226:227]
    v_pk_add_f32 v[32:33], v[32:33], v[228:229]
    v_pk_add_f32 v[34:35], v[34:35], v[230:231]
    v_cvt_pk_bf16_f32 v16, 0, v16
    v_cvt_pk_bf16_f32 v17, 0, v17
    v_cvt_pk_bf16_f32 v18, 0, v18
    v_cvt_pk_bf16_f32 v19, 0, v19
    v_cvt_pk_bf16_f32 v20, 0, v20
    v_cvt_pk_bf16_f32 v21, 0, v21
    v_cvt_pk_bf16_f32 v22, 0, v22
    v_cvt_pk_bf16_f32 v23, 0, v23
    v_cvt_pk_bf16_f32 v24, 0, v24
    v_cvt_pk_bf16_f32 v25, 0, v25
    v_cvt_pk_bf16_f32 v26, 0, v26
    v_cvt_pk_bf16_f32 v27, 0, v27
    v_cvt_pk_bf16_f32 v28, 0, v28
    v_cvt_pk_bf16_f32 v29, 0, v29
    v_cvt_pk_bf16_f32 v30, 0, v30
    v_cvt_pk_bf16_f32 v31, 0, v31
    v_cvt_pk_bf16_f32 v32, 0, v32
    v_cvt_pk_bf16_f32 v33, 0, v33
    v_cvt_pk_bf16_f32 v34, 0, v34
    v_cvt_pk_bf16_f32 v35, 0, v35
    s_waitcnt lgkmcnt(0)
    s_waitcnt vmcnt(9)
    v_perm_b32 v99, v98, v97, s79
    v_perm_b32 v103, v102, v101, s79
    v_perm_b32 v107, v106, v105, s79
    v_perm_b32 v99, v99, v96, s0
    v_perm_b32 v103, v103, v100, s0
    v_perm_b32 v107, v107, v104, s0
    v_pk_add_f32 v[96:97], v[96:97], v[100:101]
    v_pk_add_f32 v[98:99], v[98:99], v[102:103]
    v_pk_add_f32 v[104:105], v[104:105], v[156:157]
    v_pk_add_f32 v[106:107], v[106:107], v[158:159]
    v_pk_add_f32 v[96:97], v[96:97], v[104:105]
    v_pk_add_f32 v[98:99], v[98:99], v[106:107]
    v_cvt_pk_bf16_f32 v194, 0, v96
    v_cvt_pk_bf16_f32 v202, 0, v98
    v_cvt_pk_bf16_f32 v195, 0, v97
    v_cvt_pk_bf16_f32 v203, 0, v99
    v_pk_mul_f32 v[196:197], v[194:195], s[58:59]
    v_pk_mul_f32 v[204:205], v[202:203], s[58:59]
    v_exp_f32 v196, v196
    v_exp_f32 v204, v204
    v_exp_f32 v197, v197
    v_exp_f32 v205, v205
    v_pk_add_f32 v[196:197], v[196:197], s[70:71]
    v_pk_add_f32 v[204:205], v[204:205], s[70:71]
    v_rcp_f32 v196, v196
    v_rcp_f32 v204, v204
    v_rcp_f32 v197, v197
    v_rcp_f32 v205, v205
    v_pk_mul_f32 v[196:197], v[196:197], v[194:195]
    v_pk_mul_f32 v[204:205], v[204:205], v[202:203]
    v_cvt_pk_bf16_f32 v196, 0, v196
    v_cvt_pk_bf16_f32 v204, 0, v204
    v_cvt_pk_bf16_f32 v197, 0, v197
    v_cvt_pk_bf16_f32 v205, 0, v205
    v_pk_mul_f32 v[196:197], v[196:197], v[16:17]
    v_pk_mul_f32 v[204:205], v[204:205], v[18:19]
    v_cvt_pk_bf16_f32 v196, 0, v196
    v_cvt_pk_bf16_f32 v204, 0, v204
    v_cvt_pk_bf16_f32 v197, 0, v197
    v_cvt_pk_bf16_f32 v205, 0, v205
    v_pk_add_f32 v[196:197], v[196:197], v[40:41]
    v_pk_add_f32 v[204:205], v[204:205], v[42:43]
    v_cvt_pk_bf16_f32 v180, v196, v197
    v_cvt_pk_bf16_f32 v181, v204, v205
    buffer_store_dwordx2 v[180:181], v5, s[48:51], 0 offen offset:0
    s_waitcnt vmcnt(7)
    v_perm_b32 v111, v110, v109, s79
    v_perm_b32 v115, v114, v113, s79
    v_perm_b32 v119, v118, v117, s79
    v_perm_b32 v111, v111, v108, s0
    v_perm_b32 v115, v115, v112, s0
    v_perm_b32 v119, v119, v116, s0
    v_pk_add_f32 v[108:109], v[108:109], v[112:113]
    v_pk_add_f32 v[110:111], v[110:111], v[114:115]
    v_pk_add_f32 v[116:117], v[116:117], v[160:161]
    v_pk_add_f32 v[118:119], v[118:119], v[162:163]
    v_pk_add_f32 v[108:109], v[108:109], v[116:117]
    v_pk_add_f32 v[110:111], v[110:111], v[118:119]
    v_cvt_pk_bf16_f32 v194, 0, v108
    v_cvt_pk_bf16_f32 v202, 0, v110
    v_cvt_pk_bf16_f32 v195, 0, v109
    v_cvt_pk_bf16_f32 v203, 0, v111
    v_pk_mul_f32 v[196:197], v[194:195], s[58:59]
    v_pk_mul_f32 v[204:205], v[202:203], s[58:59]
    v_exp_f32 v196, v196
    v_exp_f32 v204, v204
    v_exp_f32 v197, v197
    v_exp_f32 v205, v205
    v_pk_add_f32 v[196:197], v[196:197], s[70:71]
    v_pk_add_f32 v[204:205], v[204:205], s[70:71]
    v_rcp_f32 v196, v196
    v_rcp_f32 v204, v204
    v_rcp_f32 v197, v197
    v_rcp_f32 v205, v205
    v_pk_mul_f32 v[196:197], v[196:197], v[194:195]
    v_pk_mul_f32 v[204:205], v[204:205], v[202:203]
    v_cvt_pk_bf16_f32 v196, 0, v196
    v_cvt_pk_bf16_f32 v204, 0, v204
    v_cvt_pk_bf16_f32 v197, 0, v197
    v_cvt_pk_bf16_f32 v205, 0, v205
    v_pk_mul_f32 v[196:197], v[196:197], v[20:21]
    v_pk_mul_f32 v[204:205], v[204:205], v[22:23]
    v_cvt_pk_bf16_f32 v196, 0, v196
    v_cvt_pk_bf16_f32 v204, 0, v204
    v_cvt_pk_bf16_f32 v197, 0, v197
    v_cvt_pk_bf16_f32 v205, 0, v205
    v_pk_add_f32 v[196:197], v[196:197], v[44:45]
    v_pk_add_f32 v[204:205], v[204:205], v[46:47]
    v_cvt_pk_bf16_f32 v182, v196, v197
    v_cvt_pk_bf16_f32 v183, v204, v205
    buffer_store_dwordx2 v[182:183], v5, s[48:51], 0 offen offset:32
    s_waitcnt vmcnt(5)
    v_perm_b32 v123, v122, v121, s79
    v_perm_b32 v127, v126, v125, s79
    v_perm_b32 v131, v130, v129, s79
    v_perm_b32 v123, v123, v120, s0
    v_perm_b32 v127, v127, v124, s0
    v_perm_b32 v131, v131, v128, s0
    v_pk_add_f32 v[120:121], v[120:121], v[124:125]
    v_pk_add_f32 v[122:123], v[122:123], v[126:127]
    v_pk_add_f32 v[128:129], v[128:129], v[164:165]
    v_pk_add_f32 v[130:131], v[130:131], v[166:167]
    v_pk_add_f32 v[120:121], v[120:121], v[128:129]
    v_pk_add_f32 v[122:123], v[122:123], v[130:131]
    v_cvt_pk_bf16_f32 v194, 0, v120
    v_cvt_pk_bf16_f32 v202, 0, v122
    v_cvt_pk_bf16_f32 v195, 0, v121
    v_cvt_pk_bf16_f32 v203, 0, v123
    v_pk_mul_f32 v[196:197], v[194:195], s[58:59]
    v_pk_mul_f32 v[204:205], v[202:203], s[58:59]
    v_exp_f32 v196, v196
    v_exp_f32 v204, v204
    v_exp_f32 v197, v197
    v_exp_f32 v205, v205
    v_pk_add_f32 v[196:197], v[196:197], s[70:71]
    v_pk_add_f32 v[204:205], v[204:205], s[70:71]
    v_rcp_f32 v196, v196
    v_rcp_f32 v204, v204
    v_rcp_f32 v197, v197
    v_rcp_f32 v205, v205
    v_pk_mul_f32 v[196:197], v[196:197], v[194:195]
    v_pk_mul_f32 v[204:205], v[204:205], v[202:203]
    v_cvt_pk_bf16_f32 v196, 0, v196
    v_cvt_pk_bf16_f32 v204, 0, v204
    v_cvt_pk_bf16_f32 v197, 0, v197
    v_cvt_pk_bf16_f32 v205, 0, v205
    v_pk_mul_f32 v[196:197], v[196:197], v[24:25]
    v_pk_mul_f32 v[204:205], v[204:205], v[26:27]
    v_cvt_pk_bf16_f32 v196, 0, v196
    v_cvt_pk_bf16_f32 v204, 0, v204
    v_cvt_pk_bf16_f32 v197, 0, v197
    v_cvt_pk_bf16_f32 v205, 0, v205
    v_pk_add_f32 v[196:197], v[196:197], v[48:49]
    v_pk_add_f32 v[204:205], v[204:205], v[50:51]
    v_cvt_pk_bf16_f32 v184, v196, v197
    v_cvt_pk_bf16_f32 v185, v204, v205
    buffer_store_dwordx2 v[184:185], v5, s[48:51], 0 offen offset:64
    s_waitcnt vmcnt(3)
    v_perm_b32 v135, v134, v133, s79
    v_perm_b32 v139, v138, v137, s79
    v_perm_b32 v143, v142, v141, s79
    v_perm_b32 v135, v135, v132, s0
    v_perm_b32 v139, v139, v136, s0
    v_perm_b32 v143, v143, v140, s0
    v_pk_add_f32 v[132:133], v[132:133], v[136:137]
    v_pk_add_f32 v[134:135], v[134:135], v[138:139]
    v_pk_add_f32 v[140:141], v[140:141], v[168:169]
    v_pk_add_f32 v[142:143], v[142:143], v[170:171]
    v_pk_add_f32 v[132:133], v[132:133], v[140:141]
    v_pk_add_f32 v[134:135], v[134:135], v[142:143]
    v_cvt_pk_bf16_f32 v194, 0, v132
    v_cvt_pk_bf16_f32 v202, 0, v134
    v_cvt_pk_bf16_f32 v195, 0, v133
    v_cvt_pk_bf16_f32 v203, 0, v135
    v_pk_mul_f32 v[196:197], v[194:195], s[58:59]
    v_pk_mul_f32 v[204:205], v[202:203], s[58:59]
    v_exp_f32 v196, v196
    v_exp_f32 v204, v204
    v_exp_f32 v197, v197
    v_exp_f32 v205, v205
    v_pk_add_f32 v[196:197], v[196:197], s[70:71]
    v_pk_add_f32 v[204:205], v[204:205], s[70:71]
    v_rcp_f32 v196, v196
    v_rcp_f32 v204, v204
    v_rcp_f32 v197, v197
    v_rcp_f32 v205, v205
    v_pk_mul_f32 v[196:197], v[196:197], v[194:195]
    v_pk_mul_f32 v[204:205], v[204:205], v[202:203]
    v_cvt_pk_bf16_f32 v196, 0, v196
    v_cvt_pk_bf16_f32 v204, 0, v204
    v_cvt_pk_bf16_f32 v197, 0, v197
    v_cvt_pk_bf16_f32 v205, 0, v205
    v_pk_mul_f32 v[196:197], v[196:197], v[28:29]
    v_pk_mul_f32 v[204:205], v[204:205], v[30:31]
    v_cvt_pk_bf16_f32 v196, 0, v196
    v_cvt_pk_bf16_f32 v204, 0, v204
    v_cvt_pk_bf16_f32 v197, 0, v197
    v_cvt_pk_bf16_f32 v205, 0, v205
    v_pk_add_f32 v[196:197], v[196:197], v[52:53]
    v_pk_add_f32 v[204:205], v[204:205], v[54:55]
    v_cvt_pk_bf16_f32 v186, v196, v197
    v_cvt_pk_bf16_f32 v187, v204, v205
    buffer_store_dwordx2 v[186:187], v5, s[48:51], 0 offen offset:96
    s_cmp_lg_u32 s68, 0
    s_cbranch_scc1 L_k3_fin
    s_waitcnt vmcnt(4)
    v_perm_b32 v147, v146, v145, s79
    v_perm_b32 v151, v150, v149, s79
    v_perm_b32 v155, v154, v153, s79
    v_perm_b32 v147, v147, v144, s0
    v_perm_b32 v151, v151, v148, s0
    v_perm_b32 v155, v155, v152, s0
    v_pk_add_f32 v[144:145], v[144:145], v[148:149]
    v_pk_add_f32 v[146:147], v[146:147], v[150:151]
    v_pk_add_f32 v[152:153], v[152:153], v[172:173]
    v_pk_add_f32 v[154:155], v[154:155], v[174:175]
    v_pk_add_f32 v[144:145], v[144:145], v[152:153]
    v_pk_add_f32 v[146:147], v[146:147], v[154:155]
    v_cvt_pk_bf16_f32 v194, 0, v144
    v_cvt_pk_bf16_f32 v202, 0, v146
    v_cvt_pk_bf16_f32 v195, 0, v145
    v_cvt_pk_bf16_f32 v203, 0, v147
    v_pk_mul_f32 v[196:197], v[194:195], s[58:59]
    v_pk_mul_f32 v[204:205], v[202:203], s[58:59]
    v_exp_f32 v196, v196
    v_exp_f32 v204, v204
    v_exp_f32 v197, v197
    v_exp_f32 v205, v205
    v_pk_add_f32 v[196:197], v[196:197], s[70:71]
    v_pk_add_f32 v[204:205], v[204:205], s[70:71]
    v_rcp_f32 v196, v196
    v_rcp_f32 v204, v204
    v_rcp_f32 v197, v197
    v_rcp_f32 v205, v205
    v_pk_mul_f32 v[196:197], v[196:197], v[194:195]
    v_pk_mul_f32 v[204:205], v[204:205], v[202:203]
    v_cvt_pk_bf16_f32 v196, 0, v196
    v_cvt_pk_bf16_f32 v204, 0, v204
    v_cvt_pk_bf16_f32 v197, 0, v197
    v_cvt_pk_bf16_f32 v205, 0, v205
    v_pk_mul_f32 v[196:197], v[196:197], v[32:33]
    v_pk_mul_f32 v[204:205], v[204:205], v[34:35]
    v_cvt_pk_bf16_f32 v196, 0, v196
    v_cvt_pk_bf16_f32 v204, 0, v204
    v_cvt_pk_bf16_f32 v197, 0, v197
    v_cvt_pk_bf16_f32 v205, 0, v205
    v_pk_add_f32 v[196:197], v[196:197], v[56:57]
    v_pk_add_f32 v[204:205], v[204:205], v[58:59]
    v_cvt_pk_bf16_f32 v188, v196, v197
    v_cvt_pk_bf16_f32 v189, v204, v205
    buffer_store_dwordx2 v[188:189], v5, s[48:51], 0 offen offset:128
L_k3_fin:
L_k3_done:
L_k1_done:
    s_endpgm
.section .rodata,"a"
.p2align 6
.p2align 6
.amdhsa_kernel recurrent_scan__sliding_local_dilated__geglu_ffn__prompt_kernel
  .amdhsa_next_free_vgpr 512
  .amdhsa_next_free_sgpr 102
  .amdhsa_accum_offset 256
  .amdhsa_group_segment_fixed_size 0
  .amdhsa_kernarg_size 80
  .amdhsa_user_sgpr_count 2
  .amdhsa_user_sgpr_kernarg_segment_ptr 1
  .amdhsa_system_sgpr_workgroup_id_x 1
.end_amdhsa_kernel
```
